```python
import torch

def _softmax(x, axis=-1):
    return torch.softmax(x, dim=axis)
def _gelu(x):
    return torch.nn.functional.gelu(x, approximate="tanh")
def _silu(x):
    return torch.nn.functional.silu(x)
def _sigmoid(x):
    return torch.sigmoid(x)
def _layernorm(x, axis=-1, eps=1e-5):
    m = x.mean(dim=axis, keepdim=True)
    v = x.var(dim=axis, keepdim=True, unbiased=False)
    return (x - m) / torch.sqrt(v + eps)
def _scatter_add(tgt, idx, src, axis=0):
    return tgt.clone().index_add_(axis, idx, src)
def _segment_sum(src, seg, n):
    out = torch.zeros((n,) + src.shape[1:], dtype=src.dtype)
    return out.index_add_(0, seg, src)
def _pad(x, pw):
    flat = tuple(v for pair in reversed(pw) for v in pair)
    return torch.nn.functional.pad(x, flat)

kernel_name = 'sequential_preLN__sliding_block__moe_arch_mod__prompt'

def setup_inputs():

    _w = (lambda a: (lambda t: t.to(torch.bfloat16) if t.is_floating_point() else t)(torch.as_tensor(a)))
    def _A_setup():
        B, S, D = 1, 2048, 640
        return {
            "x": _w((lambda *s: torch.randn(*s, dtype=torch.bfloat16) * 0.05)(B, S, D)),
            "wqkv": _w((lambda *s: torch.randn(*s, dtype=torch.bfloat16) * 0.05)(D, 3 * D)),
            "wo": _w((lambda *s: torch.randn(*s, dtype=torch.bfloat16) * 0.05)(D, D)),
        }
    _A_in = _A_setup()

    def _B_setup():
        B, S, D, F, C = 1, 2048, 640, 1728, 8
        return {
            "x": _w((lambda *s: torch.randn(*s, dtype=torch.bfloat16) * 0.05)(B, S, D)),
            "w_r": _w((lambda *s: torch.randn(*s, dtype=torch.bfloat16) * 0.05)(D)),
            "w_gate": _w((lambda *s: torch.randn(*s, dtype=torch.bfloat16) * 0.05)(D, F)),
            "w_up": _w((lambda *s: torch.randn(*s, dtype=torch.bfloat16) * 0.05)(D, F)),
            "w_down": _w((lambda *s: torch.randn(*s, dtype=torch.bfloat16) * 0.05)(F, D)),
        }
    _B_in = _B_setup()

    return {
        "A_x": _A_in["x"],
        "A_wqkv": _A_in["wqkv"],
        "A_wo": _A_in["wo"],
        "B_x": _B_in["x"],
        "B_w_r": _B_in["w_r"],
        "B_w_gate": _B_in["w_gate"],
        "B_w_up": _B_in["w_up"],
        "B_w_down": _B_in["w_down"],
    }

def reference(A_x, A_wqkv, A_wo, B_x, B_w_r, B_w_gate, B_w_up, B_w_down):
    def _A_ref(x, wqkv, wo):
        B, S, D = x.shape
        H = 32; Dh = D // H; W = 256
        qkv = (lambda x, *d: x.permute(*d))((x @ wqkv).reshape(B, S, 3, H, Dh), 2, 0, 3, 1, 4)
        q, k, v = qkv[0], qkv[1], qkv[2]
        scores = torch.einsum("bhqd,bhkd->bhqk", q, k) * (Dh ** -0.5)
        idx = torch.arange(S)
        mask = (idx[:, None] - idx[None, :] >= 0) & (idx[:, None] - idx[None, :] < W)
        scores = torch.where(mask[None, None], scores, -1e9)
        p = _softmax(scores, axis=-1)
        o = torch.einsum("bhqk,bhkd->bhqd", p, v)
        return (lambda x, *d: x.permute(*d))(o, 0, 2, 1, 3).reshape(B, S, D) @ wo

    def _B_ref(x, w_r, w_gate, w_up, w_down):
        B, S, D = x.shape
        C = 8
        r = x @ w_r
        idx = torch.argsort(-r, axis=-1)[:, :C]
        idx_e = (lambda x, n, axis: torch.repeat_interleave(x, n, dim=axis))(idx.reshape(B, C, 1), D, axis=2)
        x_sel = (lambda x, i, axis: torch.take_along_dim(x, i, dim=axis))(x, idx_e, axis=1)
        g = _silu(x_sel @ w_gate)
        u = x_sel @ w_up
        y = (g * u) @ w_down
        r_sel = _sigmoid((lambda x, i, axis: torch.take_along_dim(x, i, dim=axis))(r, idx, axis=1))
        y = y * r_sel.reshape(B, C, 1)
        b_off = (torch.arange(B) * S).reshape(B, 1)
        flat_idx = (idx + b_off).reshape(B * C)
        zero = (x * 0.0).reshape(B * S, D)
        upd = _scatter_add(zero, flat_idx, y.reshape(B * C, D), axis=0)
        return x + upd.reshape(B, S, D)

    x = A_x
    h = x + _A_ref(_layernorm(x, axis=-1), A_wqkv, A_wo)
    h2 = h + _B_ref(_layernorm(h, axis=-1), B_w_r, B_w_gate, B_w_up, B_w_down)
    return h2
```

```asm
; @launch grid=(256,1,1) block=(512,1,1) lds=163840
.amdgcn_target "amdgcn-amd-amdhsa--gfx950"
.text
.globl sequential_preLN__sliding_block__moe_arch_mod__prompt_kernel
.p2align 8
.type sequential_preLN__sliding_block__moe_arch_mod__prompt_kernel,@function
sequential_preLN__sliding_block__moe_arch_mod__prompt_kernel:
    s_load_dwordx16 s[64:79], s[0:1], 0
    s_load_dwordx4 s[80:83], s[0:1], 64
    s_load_dwordx2 s[84:85], s[0:1], 80
    s_getpc_b64 s[4:5]
CODE_START:
    s_cmp_ge_u32 s2, 256
    s_cbranch_scc1 L_EXIT
    s_lshr_b32 s63, s2, 3
    s_lshl_b32 s3, s63, 7
    v_lshl_add_u32 v4, v0, 12, s3
    v_cmp_gt_u32 vcc, CODE_END-CODE_START, v4
    s_nop 0
    s_and_saveexec_b64 s[6:7], vcc
    s_cbranch_execz L_NOPF
    global_load_dword v250, v4, s[4:5]
L_NOPF:
    s_mov_b64 exec, -1
    v_and_b32 v1, 63, v0
    v_lshrrev_b32 v4, 6, v0
    v_and_b32 v2, 15, v0
    v_readfirstlane_b32 s20, v4
    v_lshrrev_b32 v3, 4, v1
    s_and_b32 s3, s63, 3
    s_lshr_b32 s61, s63, 2
    s_bfe_u32 s60, s2, 0x20001
    s_mul_i32 s4, s3, 5
    s_lshr_b32 s4, s4, 1
    s_and_b32 s5, s2, 1
    s_mul_i32 s5, s5, 0
    s_add_u32 s4, s4, s5
    s_add_u32 s4, s4, s61
    s_and_b32 s5, s60, 0
    s_add_u32 s4, s4, s5
    s_cmp_ge_u32 s4, 10
    s_cselect_b32 s5, 10, 0
    s_sub_u32 s4, s4, s5
    s_cmp_ge_u32 s4, 10
    s_cselect_b32 s5, 10, 0
    s_sub_u32 s4, s4, s5
    s_lshl_b32 s60, s60, 2
    s_add_u32 s60, s60, s3
    s_and_b32 s3, s2, 1
    s_lshl_b32 s3, s3, 3
    s_add_u32 s61, s61, s3
    s_lshl_b32 s28, s4, 7
    s_mul_i32 s29, s4, 245760
    s_and_b32 s26, s20, 3
    s_lshr_b32 s27, s20, 2
    s_lshl_b32 s3, s60, 7
    s_lshl_b32 s4, s26, 3
    s_add_u32 s3, s3, s4
    v_lshrrev_b32 v4, 3, v1
    v_add_u32 v4, s3, v4
    v_mul_u32_u24 v4, 1280, v4
    s_and_b32 s3, s26, 1
    s_lshl_b32 s3, s3, 2
    v_or_b32 v5, s3, v3
    v_and_b32 v6, 7, v1
    v_xor_b32 v5, v5, v6
    v_lshl_add_u32 v112, v5, 4, v4
    s_lshl_b32 s3, s26, 2
    v_add_u32 v4, s3, v3
    v_mul_u32_u24 v4, 3840, v4
    s_lshl_b32 s3, s26, 1
    s_and_b32 s3, s3, 4
    v_or_b32 v5, s3, v3
    v_lshlrev_b32 v5, 1, v5
    v_xor_b32 v5, v5, v2
    v_lshl_add_u32 v4, v5, 4, v4
    s_lshl_b32 s3, s61, 8
    v_add_u32 v113, s3, v4
    s_lshl_b32 s30, s26, 10
    s_waitcnt lgkmcnt(0)
    s_mov_b32 s8, s64
    s_and_b32 s9, s65, 0xffff
    s_mov_b32 s10, 2621440
    s_mov_b32 s11, 0x00020000
    s_mov_b32 s12, s66
    s_and_b32 s13, s67, 0xffff
    s_mov_b32 s14, 2457600
    s_mov_b32 s15, 0x00020000
    s_cmp_eq_u32 s61, 15
    s_cbranch_scc1 L_ND0
    s_cmp_lg_u32 s27, 0
    s_cbranch_scc1 L_LOADER
L_ND0:
    s_mov_b32 s16, s84
    s_and_b32 s17, s85, 0xffff
    s_mov_b32 s18, 18186240
    s_mov_b32 s19, 0x00020000
    s_lshl_b32 s4, s61, 4
    s_add_u32 s4, s4, s60
    s_lshl_b32 s4, s4, 7
    s_add_u32 s59, s4, 13631488
    v_mov_b32 v76, -1
    v_mov_b32 v77, -1
    v_mov_b32 v78, -1
    v_mov_b32 v79, -1
    s_cmp_lg_u32 s20, 0
    s_cbranch_scc1 L_NOCLR
    s_lshl_b32 s3, s2, 10
    s_add_u32 s3, s3, 12582912
    v_lshl_add_u32 v6, v1, 4, s3
    buffer_store_dwordx4 v[76:79], v6, s[16:19], 0 offen sc1
    s_mov_b32 s3, 262144
    buffer_store_dwordx4 v[76:79], v6, s[16:19], s3 offen sc1
    s_mov_b32 s3, 524288
    buffer_store_dwordx4 v[76:79], v6, s[16:19], s3 offen sc1
    s_mov_b32 s3, 786432
    buffer_store_dwordx4 v[76:79], v6, s[16:19], s3 offen sc1
    s_lshl_b32 s6, s2, 7
    s_add_u32 s5, s6, 13664000
    s_add_u32 s6, s6, 13713280
    s_lshl_b32 s7, s2, 6
    s_add_u32 s7, s7, 13696640
    v_mov_b32 v6, s59
    v_mov_b32 v7, s6
    v_cmp_le_u32 vcc, 8, v1
    s_nop 1
    v_cndmask_b32 v6, v6, v7, vcc
    v_mov_b32 v7, s5
    v_cmp_le_u32 vcc, 16, v1
    s_nop 1
    v_cndmask_b32 v6, v6, v7, vcc
    v_mov_b32 v7, s7
    v_cmp_le_u32 vcc, 24, v1
    s_nop 1
    v_cndmask_b32 v6, v6, v7, vcc
    v_lshl_add_u32 v6, v1, 4, v6
    s_mov_b64 exec, 0xfffffff
    buffer_store_dwordx4 v[76:79], v6, s[16:19], 0 offen sc1
    s_mov_b64 exec, -1
    s_cmp_lg_u32 s61, 15
    s_cbranch_scc1 L_NOCLR
    s_lshl_b32 s3, s60, 10
    s_add_u32 s3, s3, 13746176
    v_lshl_add_u32 v6, v1, 4, s3
    buffer_store_dwordx4 v[76:79], v6, s[16:19], 0 offen sc1
L_NOCLR:
    s_cmp_lg_u32 s61, 15
    s_cbranch_scc1 L_PRE
    s_lshl_b32 s3, s60, 7
    s_lshl_b32 s4, s20, 4
    s_add_u32 s3, s3, s4
    v_lshrrev_b32 v4, 3, v1
    v_add_u32 v4, s3, v4
    v_mul_u32_u24 v4, 1280, v4
    v_and_b32 v5, 7, v1
    v_lshl_add_u32 v112, v5, 4, v4
    s_mov_b32 s5, 10240
    buffer_load_dwordx4 v[136:139], v112, s[8:11], 0 offen offset:0
    buffer_load_dwordx4 v[140:143], v112, s[8:11], s5 offen offset:0
    buffer_load_dwordx4 v[144:147], v112, s[8:11], 0 offen offset:128
    buffer_load_dwordx4 v[148:151], v112, s[8:11], s5 offen offset:128
    buffer_load_dwordx4 v[152:155], v112, s[8:11], 0 offen offset:256
    buffer_load_dwordx4 v[156:159], v112, s[8:11], s5 offen offset:256
    buffer_load_dwordx4 v[160:163], v112, s[8:11], 0 offen offset:384
    buffer_load_dwordx4 v[164:167], v112, s[8:11], s5 offen offset:384
    buffer_load_dwordx4 v[168:171], v112, s[8:11], 0 offen offset:512
    buffer_load_dwordx4 v[172:175], v112, s[8:11], s5 offen offset:512
    buffer_load_dwordx4 v[176:179], v112, s[8:11], 0 offen offset:640
    buffer_load_dwordx4 v[180:183], v112, s[8:11], s5 offen offset:640
    buffer_load_dwordx4 v[184:187], v112, s[8:11], 0 offen offset:768
    buffer_load_dwordx4 v[188:191], v112, s[8:11], s5 offen offset:768
    buffer_load_dwordx4 v[192:195], v112, s[8:11], 0 offen offset:896
    buffer_load_dwordx4 v[196:199], v112, s[8:11], s5 offen offset:896
    buffer_load_dwordx4 v[200:203], v112, s[8:11], 0 offen offset:1024
    buffer_load_dwordx4 v[204:207], v112, s[8:11], s5 offen offset:1024
    buffer_load_dwordx4 v[208:211], v112, s[8:11], 0 offen offset:1152
    buffer_load_dwordx4 v[212:215], v112, s[8:11], s5 offen offset:1152
    v_mov_b32 v8, 0x3f803f80
    v_mov_b32 v24, 0
    v_mov_b32 v25, 0
    v_mov_b32 v26, 0
    v_mov_b32 v27, 0
    v_mov_b32 v28, 0
    v_mov_b32 v29, 0
    v_mov_b32 v30, 0
    v_mov_b32 v31, 0
    s_waitcnt vmcnt(19)
    s_cmp_lg_u32 s20, 0
    s_cbranch_scc1 L_NOSIGH
    s_and_b32 s3, s2, 31
    s_lshl_b32 s3, s3, 2
    s_add_u32 s3, s3, 128
    v_mov_b32 v4, s3
    v_mov_b32 v5, 1
    s_lshl_b32 s3, s60, 2
    v_mov_b32 v6, s3
    s_waitcnt vmcnt(63)
    s_mov_b64 exec, 1
    global_store_dword v6, v5, s[82:83] sc1
    global_atomic_add v4, v5, s[82:83] sc1
    s_mov_b64 exec, -1
L_NOSIGH:
    v_dot2_f32_bf16 v24, v136, v8, v24
    v_dot2_f32_bf16 v25, v136, v136, v25
    v_dot2_f32_bf16 v26, v137, v8, v26
    v_dot2_f32_bf16 v27, v137, v137, v27
    v_dot2_f32_bf16 v24, v138, v8, v24
    v_dot2_f32_bf16 v25, v138, v138, v25
    v_dot2_f32_bf16 v26, v139, v8, v26
    v_dot2_f32_bf16 v27, v139, v139, v27
    s_waitcnt vmcnt(18)
    v_dot2_f32_bf16 v28, v140, v8, v28
    v_dot2_f32_bf16 v29, v140, v140, v29
    v_dot2_f32_bf16 v30, v141, v8, v30
    v_dot2_f32_bf16 v31, v141, v141, v31
    v_dot2_f32_bf16 v28, v142, v8, v28
    v_dot2_f32_bf16 v29, v142, v142, v29
    v_dot2_f32_bf16 v30, v143, v8, v30
    v_dot2_f32_bf16 v31, v143, v143, v31
    s_waitcnt vmcnt(17)
    v_dot2_f32_bf16 v24, v144, v8, v24
    v_dot2_f32_bf16 v25, v144, v144, v25
    v_dot2_f32_bf16 v26, v145, v8, v26
    v_dot2_f32_bf16 v27, v145, v145, v27
    v_dot2_f32_bf16 v24, v146, v8, v24
    v_dot2_f32_bf16 v25, v146, v146, v25
    v_dot2_f32_bf16 v26, v147, v8, v26
    v_dot2_f32_bf16 v27, v147, v147, v27
    s_waitcnt vmcnt(16)
    v_dot2_f32_bf16 v28, v148, v8, v28
    v_dot2_f32_bf16 v29, v148, v148, v29
    v_dot2_f32_bf16 v30, v149, v8, v30
    v_dot2_f32_bf16 v31, v149, v149, v31
    v_dot2_f32_bf16 v28, v150, v8, v28
    v_dot2_f32_bf16 v29, v150, v150, v29
    v_dot2_f32_bf16 v30, v151, v8, v30
    v_dot2_f32_bf16 v31, v151, v151, v31
    s_waitcnt vmcnt(15)
    v_dot2_f32_bf16 v24, v152, v8, v24
    v_dot2_f32_bf16 v25, v152, v152, v25
    v_dot2_f32_bf16 v26, v153, v8, v26
    v_dot2_f32_bf16 v27, v153, v153, v27
    v_dot2_f32_bf16 v24, v154, v8, v24
    v_dot2_f32_bf16 v25, v154, v154, v25
    v_dot2_f32_bf16 v26, v155, v8, v26
    v_dot2_f32_bf16 v27, v155, v155, v27
    s_waitcnt vmcnt(14)
    v_dot2_f32_bf16 v28, v156, v8, v28
    v_dot2_f32_bf16 v29, v156, v156, v29
    v_dot2_f32_bf16 v30, v157, v8, v30
    v_dot2_f32_bf16 v31, v157, v157, v31
    v_dot2_f32_bf16 v28, v158, v8, v28
    v_dot2_f32_bf16 v29, v158, v158, v29
    v_dot2_f32_bf16 v30, v159, v8, v30
    v_dot2_f32_bf16 v31, v159, v159, v31
    s_waitcnt vmcnt(13)
    v_dot2_f32_bf16 v24, v160, v8, v24
    v_dot2_f32_bf16 v25, v160, v160, v25
    v_dot2_f32_bf16 v26, v161, v8, v26
    v_dot2_f32_bf16 v27, v161, v161, v27
    v_dot2_f32_bf16 v24, v162, v8, v24
    v_dot2_f32_bf16 v25, v162, v162, v25
    v_dot2_f32_bf16 v26, v163, v8, v26
    v_dot2_f32_bf16 v27, v163, v163, v27
    s_waitcnt vmcnt(12)
    v_dot2_f32_bf16 v28, v164, v8, v28
    v_dot2_f32_bf16 v29, v164, v164, v29
    v_dot2_f32_bf16 v30, v165, v8, v30
    v_dot2_f32_bf16 v31, v165, v165, v31
    v_dot2_f32_bf16 v28, v166, v8, v28
    v_dot2_f32_bf16 v29, v166, v166, v29
    v_dot2_f32_bf16 v30, v167, v8, v30
    v_dot2_f32_bf16 v31, v167, v167, v31
    s_waitcnt vmcnt(11)
    v_dot2_f32_bf16 v24, v168, v8, v24
    v_dot2_f32_bf16 v25, v168, v168, v25
    v_dot2_f32_bf16 v26, v169, v8, v26
    v_dot2_f32_bf16 v27, v169, v169, v27
    v_dot2_f32_bf16 v24, v170, v8, v24
    v_dot2_f32_bf16 v25, v170, v170, v25
    v_dot2_f32_bf16 v26, v171, v8, v26
    v_dot2_f32_bf16 v27, v171, v171, v27
    s_waitcnt vmcnt(10)
    v_dot2_f32_bf16 v28, v172, v8, v28
    v_dot2_f32_bf16 v29, v172, v172, v29
    v_dot2_f32_bf16 v30, v173, v8, v30
    v_dot2_f32_bf16 v31, v173, v173, v31
    v_dot2_f32_bf16 v28, v174, v8, v28
    v_dot2_f32_bf16 v29, v174, v174, v29
    v_dot2_f32_bf16 v30, v175, v8, v30
    v_dot2_f32_bf16 v31, v175, v175, v31
    s_waitcnt vmcnt(9)
    v_dot2_f32_bf16 v24, v176, v8, v24
    v_dot2_f32_bf16 v25, v176, v176, v25
    v_dot2_f32_bf16 v26, v177, v8, v26
    v_dot2_f32_bf16 v27, v177, v177, v27
    v_dot2_f32_bf16 v24, v178, v8, v24
    v_dot2_f32_bf16 v25, v178, v178, v25
    v_dot2_f32_bf16 v26, v179, v8, v26
    v_dot2_f32_bf16 v27, v179, v179, v27
    s_waitcnt vmcnt(8)
    v_dot2_f32_bf16 v28, v180, v8, v28
    v_dot2_f32_bf16 v29, v180, v180, v29
    v_dot2_f32_bf16 v30, v181, v8, v30
    v_dot2_f32_bf16 v31, v181, v181, v31
    v_dot2_f32_bf16 v28, v182, v8, v28
    v_dot2_f32_bf16 v29, v182, v182, v29
    v_dot2_f32_bf16 v30, v183, v8, v30
    v_dot2_f32_bf16 v31, v183, v183, v31
    s_waitcnt vmcnt(7)
    v_dot2_f32_bf16 v24, v184, v8, v24
    v_dot2_f32_bf16 v25, v184, v184, v25
    v_dot2_f32_bf16 v26, v185, v8, v26
    v_dot2_f32_bf16 v27, v185, v185, v27
    v_dot2_f32_bf16 v24, v186, v8, v24
    v_dot2_f32_bf16 v25, v186, v186, v25
    v_dot2_f32_bf16 v26, v187, v8, v26
    v_dot2_f32_bf16 v27, v187, v187, v27
    s_waitcnt vmcnt(6)
    v_dot2_f32_bf16 v28, v188, v8, v28
    v_dot2_f32_bf16 v29, v188, v188, v29
    v_dot2_f32_bf16 v30, v189, v8, v30
    v_dot2_f32_bf16 v31, v189, v189, v31
    v_dot2_f32_bf16 v28, v190, v8, v28
    v_dot2_f32_bf16 v29, v190, v190, v29
    v_dot2_f32_bf16 v30, v191, v8, v30
    v_dot2_f32_bf16 v31, v191, v191, v31
    s_waitcnt vmcnt(5)
    v_dot2_f32_bf16 v24, v192, v8, v24
    v_dot2_f32_bf16 v25, v192, v192, v25
    v_dot2_f32_bf16 v26, v193, v8, v26
    v_dot2_f32_bf16 v27, v193, v193, v27
    v_dot2_f32_bf16 v24, v194, v8, v24
    v_dot2_f32_bf16 v25, v194, v194, v25
    v_dot2_f32_bf16 v26, v195, v8, v26
    v_dot2_f32_bf16 v27, v195, v195, v27
    s_waitcnt vmcnt(4)
    v_dot2_f32_bf16 v28, v196, v8, v28
    v_dot2_f32_bf16 v29, v196, v196, v29
    v_dot2_f32_bf16 v30, v197, v8, v30
    v_dot2_f32_bf16 v31, v197, v197, v31
    v_dot2_f32_bf16 v28, v198, v8, v28
    v_dot2_f32_bf16 v29, v198, v198, v29
    v_dot2_f32_bf16 v30, v199, v8, v30
    v_dot2_f32_bf16 v31, v199, v199, v31
    s_waitcnt vmcnt(3)
    v_dot2_f32_bf16 v24, v200, v8, v24
    v_dot2_f32_bf16 v25, v200, v200, v25
    v_dot2_f32_bf16 v26, v201, v8, v26
    v_dot2_f32_bf16 v27, v201, v201, v27
    v_dot2_f32_bf16 v24, v202, v8, v24
    v_dot2_f32_bf16 v25, v202, v202, v25
    v_dot2_f32_bf16 v26, v203, v8, v26
    v_dot2_f32_bf16 v27, v203, v203, v27
    s_waitcnt vmcnt(2)
    v_dot2_f32_bf16 v28, v204, v8, v28
    v_dot2_f32_bf16 v29, v204, v204, v29
    v_dot2_f32_bf16 v30, v205, v8, v30
    v_dot2_f32_bf16 v31, v205, v205, v31
    v_dot2_f32_bf16 v28, v206, v8, v28
    v_dot2_f32_bf16 v29, v206, v206, v29
    v_dot2_f32_bf16 v30, v207, v8, v30
    v_dot2_f32_bf16 v31, v207, v207, v31
    s_waitcnt vmcnt(1)
    v_dot2_f32_bf16 v24, v208, v8, v24
    v_dot2_f32_bf16 v25, v208, v208, v25
    v_dot2_f32_bf16 v26, v209, v8, v26
    v_dot2_f32_bf16 v27, v209, v209, v27
    v_dot2_f32_bf16 v24, v210, v8, v24
    v_dot2_f32_bf16 v25, v210, v210, v25
    v_dot2_f32_bf16 v26, v211, v8, v26
    v_dot2_f32_bf16 v27, v211, v211, v27
    s_waitcnt vmcnt(0)
    v_dot2_f32_bf16 v28, v212, v8, v28
    v_dot2_f32_bf16 v29, v212, v212, v29
    v_dot2_f32_bf16 v30, v213, v8, v30
    v_dot2_f32_bf16 v31, v213, v213, v31
    v_dot2_f32_bf16 v28, v214, v8, v28
    v_dot2_f32_bf16 v29, v214, v214, v29
    v_dot2_f32_bf16 v30, v215, v8, v30
    v_dot2_f32_bf16 v31, v215, v215, v31
    s_nop 3
    v_add_f32 v24, v24, v26
    v_add_f32 v25, v25, v27
    v_add_f32 v26, v28, v30
    v_add_f32 v27, v29, v31
    v_add_f32_dpp v24, v24, v24 quad_perm:[1,0,3,2] row_mask:0xf bank_mask:0xf
    v_add_f32_dpp v25, v25, v25 quad_perm:[1,0,3,2] row_mask:0xf bank_mask:0xf
    v_add_f32_dpp v26, v26, v26 quad_perm:[1,0,3,2] row_mask:0xf bank_mask:0xf
    v_add_f32_dpp v27, v27, v27 quad_perm:[1,0,3,2] row_mask:0xf bank_mask:0xf
    v_add_f32_dpp v24, v24, v24 quad_perm:[2,3,0,1] row_mask:0xf bank_mask:0xf
    v_add_f32_dpp v25, v25, v25 quad_perm:[2,3,0,1] row_mask:0xf bank_mask:0xf
    v_add_f32_dpp v26, v26, v26 quad_perm:[2,3,0,1] row_mask:0xf bank_mask:0xf
    v_add_f32_dpp v27, v27, v27 quad_perm:[2,3,0,1] row_mask:0xf bank_mask:0xf
    v_add_f32_dpp v24, v24, v24 row_half_mirror row_mask:0xf bank_mask:0xf
    v_add_f32_dpp v25, v25, v25 row_half_mirror row_mask:0xf bank_mask:0xf
    v_add_f32_dpp v26, v26, v26 row_half_mirror row_mask:0xf bank_mask:0xf
    v_add_f32_dpp v27, v27, v27 row_half_mirror row_mask:0xf bank_mask:0xf
    v_and_b32 v6, 1, v1
    v_cmp_eq_u32 s[6:7], 1, v6
    s_nop 1
    v_cndmask_b32 v24, v24, v26, s[6:7]
    v_cndmask_b32 v25, v25, v27, s[6:7]
    v_mul_f32 v24, 0x3acccccd, v24
    v_mul_f32 v25, 0x3acccccd, v25
    v_fma_f32 v25, -v24, v24, v25
    v_max_f32 v25, 0, v25
    v_cvt_pk_bf16_f32 v25, v24, v25
    v_lshlrev_b32 v24, 16, v25
    v_and_b32 v25, 0xffff0000, v25
    v_add_f32 v25, 0x3727c5ac, v25
    v_cvt_pk_bf16_f32 v25, v25, v25
    v_lshlrev_b32 v25, 16, v25
    v_sqrt_f32 v25, v25
    s_nop 0
    v_cvt_pk_bf16_f32 v25, v25, v25
    v_lshlrev_b32 v25, 16, v25
    v_rcp_f32 v25, v25
    v_min_u32 v24, -2, v24
    v_min_u32 v25, -2, v25
    v_lshrrev_b32 v4, 3, v1
    v_lshl_add_u32 v4, v6, 3, v4
    s_lshl_b32 s3, s20, 6
    v_lshl_add_u32 v4, v4, 2, s3
    ds_write2st64_b32 v4, v24, v25 offset0:0 offset1:2
    s_waitcnt lgkmcnt(0)
    s_barrier
    s_cmp_lg_u32 s20, 0
    s_cbranch_scc1 L_HB2
    v_lshlrev_b32 v4, 4, v1
    ds_read_b128 v[24:27], v4
    s_lshl_b32 s3, s60, 10
    s_add_u32 s3, s3, 13746176
    s_waitcnt lgkmcnt(0)
    buffer_store_dwordx4 v[24:27], v4, s[16:19], s3 offen sc1
L_HB2:
    s_mul_i32 s3, s60, 51200
    v_lshl_add_u32 v4, v0, 7, s3
    v_cmp_gt_u32 vcc, 400, v0
    s_nop 0
    s_and_saveexec_b64 s[6:7], vcc
    s_cbranch_execz L_HWT
    global_load_dword v251, v4, s[68:69]
L_HWT:
    s_mov_b64 exec, -1
    v_subrev_u32 v4, 448, v0
    v_cmp_gt_u32 vcc, 10, v4
    v_lshlrev_b32 v4, 7, v4
    s_and_saveexec_b64 s[6:7], vcc
    s_cbranch_execz L_HWR
    global_load_dword v251, v4, s[72:73]
L_HWR:
    s_mov_b64 exec, -1
    s_barrier
L_PRE:
    s_and_b32 s3, s2, 7
    s_lshl_b32 s22, s3, 1
    s_lshr_b32 s4, s63, 4
    s_add_u32 s22, s22, s4
    s_and_b32 s21, s63, 15
    s_lshl_b32 s23, s3, 2
    s_lshr_b32 s5, s63, 3
    s_add_u32 s23, s23, s5
    s_and_b32 s24, s63, 7
    s_min_u32 s4, s3, 5
    s_sub_u32 s25, s23, s4
    s_cmp_eq_u32 s5, 3
    s_cselect_b32 s4, s3, 7
    s_add_u32 s3, s3, 32
    s_cmp_lt_u32 s4, 5
    s_cselect_b32 s25, s3, s25
    v_lshrrev_b32 v4, 1, v2
    v_xor_b32 v4, v4, v3
    v_lshlrev_b32 v4, 4, v4
    v_lshl_add_u32 v4, v2, 7, v4
    s_lshr_b32 s33, s26, 1
    s_lshl_b32 s3, s33, 13
    v_add_u32 v88, s3, v4
    v_xor_b32 v89, 64, v88
    v_bfe_u32 v4, v1, 2, 2
    v_and_b32 v5, 1, v3
    v_lshl_or_b32 v5, v5, 2, v4
    v_lshl_add_u32 v4, v3, 3, v4
    v_lshlrev_b32 v4, 8, v4
    v_and_b32 v6, 3, v1
    v_lshl_add_u32 v4, v6, 3, v4
    v_add_u32 v4, 16384, v4
    s_and_b32 s32, s26, 1
    s_lshl_b32 s32, s32, 2
    s_lshl_b32 s3, s33, 1
    s_add_u32 s32, s32, s3
    v_xor_b32 v6, s32, v5
    v_lshl_add_u32 v90, v6, 5, v4
    v_xor_b32 v91, 32, v90
    v_xor_b32 v92, 64, v90
    v_xor_b32 v93, 0x60, v90
    v_add_u32 v94, 65536, v88
    v_add_u32 v95, 65536, v89
    v_add_u32 v96, 65536, v90
    v_add_u32 v97, 65536, v91
    v_add_u32 v98, 65536, v92
    v_add_u32 v99, 65536, v93
    v_add_u32 v100, 131072, v88
    v_add_u32 v101, 131072, v89
    v_add_u32 v102, 131072, v90
    v_add_u32 v103, 131072, v91
    v_add_u32 v104, 131072, v92
    v_add_u32 v105, 131072, v93
    v_mov_b32 v116, 0x3f803f80
    v_mov_b32 v117, 0x3f803f80
    v_mov_b32 v118, 0x3f803f80
    v_mov_b32 v119, 0x3f803f80
    s_cmp_eq_u32 s61, 15
    s_cbranch_scc1 L_KEEP1
    s_mov_b32 exec_lo, 0xfffefffe
    s_mov_b32 exec_hi, 0xfffefffe
    v_mov_b32 v116, 0
    v_mov_b32 v117, 0
    v_mov_b32 v118, 0
    v_mov_b32 v119, 0
    s_mov_b64 exec, -1
L_KEEP1:
    s_cmp_ge_u32 s61, 10
    s_cselect_b64 s[56:57], -1, 0
    v_lshlrev_b32 v6, 4, v3
    v_lshlrev_b32 v7, 2, v2
    v_cndmask_b32 v8, v6, v7, s[56:57]
    v_cndmask_b32 v9, v7, v6, s[56:57]
    s_lshl_b32 s3, s32, 6
    s_add_u32 s3, s3, 62464
    v_add_u32 v110, s3, v7
    v_add_u32 v111, s3, v8
    v_xor_b32 v114, 0x80, v111
    s_lshl_b32 s3, s33, 8
    s_add_u32 s3, s3, 61440
    v_add_u32 v115, s3, v9
    s_mul_i32 s3, s61, 52
    s_lshr_b32 s3, s3, 8
    s_mul_i32 s4, s3, 5
    s_sub_u32 s34, s61, s4
    s_mul_i32 s37, s3, 2621440
    s_lshl_b32 s4, s60, 2
    s_lshl_b32 s5, s33, 1
    s_add_u32 s4, s4, s5
    s_mul_i32 s4, s4, 2560
    s_add_u32 s37, s37, s4
    s_cmp_eq_u32 s3, 0
    s_cselect_b32 s36, 0x3ea52b5c, 1.0
    v_lshrrev_b32 v5, 1, v3
    v_and_b32 v4, 1, v3
    v_lshl_add_u32 v8, v4, 1, v5
    v_mul_u32_u24 v7, 640, v8
    s_xor_b32 s4, s32, 0
    s_lshl_b32 s4, s4, 1
    s_lshl_b32 s3, s34, 4
    s_add_u32 s3, s3, s4
    v_add_u32 v4, s3, v8
    v_mul_u32_u24 v6, 13108, v4
    v_lshrrev_b32 v6, 16, v6
    v_mul_u32_u24 v6, 161280, v6
    v_lshl_add_u32 v6, v4, 9, v6
    v_lshl_add_u32 v9, v2, 4, v6
    s_xor_b32 s4, s32, 0
    s_lshl_b32 s4, s4, 4
    s_lshl_b32 s3, s34, 7
    s_add_u32 s3, s3, s4
    v_add_u32 v4, s3, v2
    v_mul_u32_u24 v6, 1639, v4
    v_lshrrev_b32 v6, 16, v6
    v_mul_u32_u24 v6, 163200, v6
    v_lshl_add_u32 v6, v4, 4, v6
    v_add_u32 v6, v6, v7
    v_cndmask_b32 v106, v9, v6, s[56:57]
    s_xor_b32 s4, s32, 2
    s_lshl_b32 s4, s4, 1
    s_lshl_b32 s3, s34, 4
    s_add_u32 s3, s3, s4
    v_add_u32 v4, s3, v8
    v_mul_u32_u24 v6, 13108, v4
    v_lshrrev_b32 v6, 16, v6
    v_mul_u32_u24 v6, 161280, v6
    v_lshl_add_u32 v6, v4, 9, v6
    v_lshl_add_u32 v9, v2, 4, v6
    s_xor_b32 s4, s32, 1
    s_lshl_b32 s4, s4, 4
    s_lshl_b32 s3, s34, 7
    s_add_u32 s3, s3, s4
    v_add_u32 v4, s3, v2
    v_mul_u32_u24 v6, 1639, v4
    v_lshrrev_b32 v6, 16, v6
    v_mul_u32_u24 v6, 163200, v6
    v_lshl_add_u32 v6, v4, 4, v6
    v_add_u32 v6, v6, v7
    v_cndmask_b32 v107, v9, v6, s[56:57]
    s_xor_b32 s4, s32, 2
    s_lshl_b32 s4, s4, 4
    s_lshl_b32 s3, s34, 7
    s_add_u32 s3, s3, s4
    v_add_u32 v4, s3, v2
    v_mul_u32_u24 v6, 1639, v4
    v_lshrrev_b32 v6, 16, v6
    v_mul_u32_u24 v6, 163200, v6
    v_lshl_add_u32 v6, v4, 4, v6
    v_add_u32 v6, v6, v7
    v_cndmask_b32 v108, v9, v6, s[56:57]
    s_xor_b32 s4, s32, 3
    s_lshl_b32 s4, s4, 4
    s_lshl_b32 s3, s34, 7
    s_add_u32 s3, s3, s4
    v_add_u32 v4, s3, v2
    v_mul_u32_u24 v6, 1639, v4
    v_lshrrev_b32 v6, 16, v6
    v_mul_u32_u24 v6, 163200, v6
    v_lshl_add_u32 v6, v4, 4, v6
    v_add_u32 v6, v6, v7
    v_cndmask_b32 v109, v9, v6, s[56:57]
    v_mul_u32_u24 v8, 6554, v1
    v_lshrrev_b32 v8, 16, v8
    v_mul_u32_u24 v9, 10, v8
    v_sub_u32 v9, v1, v9
    s_and_b32 s3, s20, 1
    s_lshl_b32 s3, s3, 2
    v_add_u32 v4, s3, v8
    v_mul_u32_u24 v4, 1280, v4
    s_mul_i32 s3, s3, 5
    s_add_u32 s3, s3, 16
    v_add_u32 v5, s3, v8
    v_mul_u32_u24 v5, 1280, v5
    s_mul_i32 s3, s24, 160
    v_lshl_add_u32 v6, v9, 4, s3
    v_add_u32 v22, v4, v6
    v_add_u32 v23, v5, v6
    s_lshl_b32 s3, s21, 2
    s_add_u32 s3, s3, s26
    s_mul_i32 s3, s3, 40960
    s_add_u32 s3, s3, 7864320
    s_lshl_b32 s4, s22, 1
    s_add_u32 s4, s4, s27
    s_lshl_b32 s5, s4, 10
    s_add_u32 s5, s5, s3
    v_lshl_add_u32 v14, v1, 4, s5
    s_lshl_b32 s5, s4, 8
    s_add_u32 s5, s5, s3
    s_add_u32 s5, s5, 32768
    v_lshl_add_u32 v15, v1, 3, s5
    s_mul_i32 s3, s24, 80
    v_lshrrev_b32 v4, 3, v1
    v_add_u32 v4, s3, v4
    v_mul_u32_u24 v4, 3456, v4
    v_and_b32 v5, 7, v1
    v_lshl_add_u32 v4, v5, 4, v4
    s_lshl_b32 s3, s25, 7
    v_add_u32 v86, s3, v4
    s_cmp_ge_u32 s20, 3
    s_cselect_b32 s4, 1, 0
    s_mul_i32 s5, s4, 3
    s_sub_u32 s5, s20, s5
    s_mov_b32 s70, s4
    s_mov_b32 s71, s5
    s_add_u32 s5, s5, s21
    s_sub_u32 s5, s5, 2
    s_max_i32 s5, s5, 0
    s_min_i32 s5, s5, 15
    s_mul_i32 s4, s4, 80
    s_add_u32 s4, s4, 80
    s_add_u32 s4, s4, s5
    v_mov_b32 v4, s4
    v_mov_b32 v5, s21
    v_cmp_gt_u32 vcc, 2, v1
    s_nop 1
    v_cndmask_b32 v4, v5, v4, vcc
    s_mul_i32 s3, s22, 40
    v_and_b32 v7, 1, v1
    v_mul_u32_u24 v7, 39, v7
    v_add_u32 v7, s3, v7
    v_lshrrev_b32 v7, 7, v7
    v_lshl_add_u32 v4, v7, 4, v4
    v_lshlrev_b32 v4, 7, v4
    v_add_u32 v85, 13631488, v4
    v_bfe_u32 v4, v1, 2, 1
    v_lshlrev_b32 v4, 9, v4
    v_and_b32 v5, 3, v1
    v_lshl_add_u32 v4, v5, 13, v4
    s_lshr_b32 s3, s23, 1
    s_and_b32 s4, s3, 3
    s_lshl_b32 s4, s4, 7
    s_lshr_b32 s3, s3, 2
    s_lshl_b32 s3, s3, 11
    s_add_u32 s3, s3, s4
    s_lshl_b32 s4, s27, 10
    s_add_u32 s3, s3, s4
    s_add_u32 s3, s3, 13631520
    v_add_u32 v87, s3, v4
    v_bfe_u32 v4, v1, 2, 1
    v_lshlrev_b32 v4, 11, v4
    v_lshl_add_u32 v4, v5, 7, v4
    s_and_b32 s3, s61, 14
    s_lshl_b32 s3, s3, 11
    s_and_b32 s4, s60, 12
    s_lshl_b32 s4, s4, 7
    s_add_u32 s3, s3, s4
    s_add_u32 s3, s3, 13631520
    v_add_u32 v4, s3, v4
    v_cmp_le_u32 vcc, 8, v1
    s_nop 1
    v_cndmask_b32 v87, v87, v4, vcc
    s_mul_i32 s3, s63, 200
    s_mul_i32 s4, s26, 50
    s_add_u32 s3, s3, s4
    v_add_u32 v4, s3, v1
    v_lshlrev_b32 v83, 7, v4
    v_subrev_u32 v4, 384, v0
    v_lshrrev_b32 v5, 1, v4
    s_mul_i32 s3, s63, 54
    v_add_u32 v5, s3, v5
    v_mul_u32_u24 v5, 1280, v5
    v_and_b32 v4, 1, v4
    v_lshl_add_u32 v5, v4, 7, v5
    s_and_b32 s3, s2, 7
    s_lshl_b32 s3, s3, 8
    v_add_u32 v10, s3, v5
    v_or_b32 v8, 32, v1
    v_lshlrev_b32 v8, 2, v8
    s_lshl_b32 s3, s60, 10
    s_add_u32 s35, s3, 13746176
    s_mov_b32 s44, s68
    s_and_b32 s45, s69, 0xffff
    s_mov_b32 s46, 819200
    s_mov_b32 s47, 0x00020000
    s_lshr_b32 s3, s26, 1
    s_mul_i32 s41, s3, 102400
    s_mul_i32 s40, s3, 10240
    s_and_b32 s3, s20, 1
    s_mul_i32 s3, s3, 1280
    s_add_u32 s40, s40, s3
    s_cmp_eq_u32 s61, 15
    s_cbranch_scc1 L_HELP
    s_barrier
    ds_read_b64_tr_b16 v[144:145], v90 offset:0
    ds_read_b64_tr_b16 v[146:147], v90 offset:1024
    ds_read_b64_tr_b16 v[148:149], v91 offset:0
    ds_read_b64_tr_b16 v[150:151], v91 offset:1024
    ds_read_b128 v[128:131], v88 offset:0
    ds_read_b128 v[132:135], v88 offset:2048
    ds_read_b128 v[136:139], v88 offset:4096
    ds_read_b128 v[140:143], v88 offset:6144
    ds_read_b64_tr_b16 v[152:153], v92 offset:0
    ds_read_b64_tr_b16 v[154:155], v92 offset:1024
    ds_read_b64_tr_b16 v[156:157], v93 offset:0
    ds_read_b64_tr_b16 v[158:159], v93 offset:1024
    s_cmp_ge_u32 s61, 10
    s_cbranch_scc1 L_A1_1
L_A1_0:
    s_waitcnt lgkmcnt(10)
    v_mfma_f32_16x16x32_bf16 v[120:123], v[116:119], v[144:147], 0
    ds_read_b64_tr_b16 v[176:177], v90 offset:8192
    s_waitcnt lgkmcnt(9)
    v_mfma_f32_16x16x32_bf16 v[124:127], v[116:119], v[148:151], 0
    ds_read_b64_tr_b16 v[178:179], v90 offset:9216
    s_waitcnt lgkmcnt(9)
    v_mfma_f32_16x16x32_bf16 v[192:195], v[144:147], v[128:131], 0
    ds_read_b64_tr_b16 v[180:181], v91 offset:8192
    v_mfma_f32_16x16x32_bf16 v[196:199], v[148:151], v[128:131], 0
    ds_read_b64_tr_b16 v[182:183], v91 offset:9216
    s_waitcnt lgkmcnt(10)
    v_mfma_f32_16x16x32_bf16 v[208:211], v[144:147], v[132:135], 0
    ds_read_b128 v[160:163], v89 offset:0
    v_mfma_f32_16x16x32_bf16 v[212:215], v[148:151], v[132:135], 0
    ds_read_b128 v[164:167], v89 offset:2048
    s_waitcnt lgkmcnt(11)
    v_mfma_f32_16x16x32_bf16 v[224:227], v[144:147], v[136:139], 0
    ds_read_b128 v[168:171], v89 offset:4096
    v_mfma_f32_16x16x32_bf16 v[228:231], v[148:151], v[136:139], 0
    ds_read_b128 v[172:175], v89 offset:6144
    s_waitcnt lgkmcnt(12)
    v_mfma_f32_16x16x32_bf16 v[240:243], v[144:147], v[140:143], 0
    ds_read_b64_tr_b16 v[184:185], v92 offset:8192
    v_mfma_f32_16x16x32_bf16 v[244:247], v[148:151], v[140:143], 0
    ds_read_b64_tr_b16 v[186:187], v92 offset:9216
    s_waitcnt lgkmcnt(12)
    v_mfma_f32_16x16x32_bf16 v[200:203], v[152:155], v[128:131], 0
    ds_read_b64_tr_b16 v[188:189], v93 offset:8192
    v_mfma_f32_16x16x32_bf16 v[216:219], v[152:155], v[132:135], 0
    ds_read_b64_tr_b16 v[190:191], v93 offset:9216
    v_mfma_f32_16x16x32_bf16 v[232:235], v[152:155], v[136:139], 0
    v_mfma_f32_16x16x32_bf16 v[248:251], v[152:155], v[140:143], 0
    s_waitcnt lgkmcnt(12)
    v_mfma_f32_16x16x32_bf16 v[204:207], v[156:159], v[128:131], 0
    v_mfma_f32_16x16x32_bf16 v[220:223], v[156:159], v[132:135], 0
    v_mfma_f32_16x16x32_bf16 v[236:239], v[156:159], v[136:139], 0
    v_mfma_f32_16x16x32_bf16 v[252:255], v[156:159], v[140:143], 0
    s_cmp_lg_u32 s20, 0
    s_cbranch_scc1 L_NOSIGC0
    s_and_b32 s3, s2, 31
    s_lshl_b32 s3, s3, 2
    s_add_u32 s3, s3, 128
    v_mov_b32 v4, s3
    v_mov_b32 v5, 1
    s_lshl_b32 s3, s60, 2
    v_mov_b32 v6, s3
    s_waitcnt vmcnt(0)
    s_mov_b64 exec, 1
    global_atomic_add v4, v5, s[82:83] sc1
    s_mov_b64 exec, -1
L_NOSIGC0:
    s_waitcnt lgkmcnt(10)
    v_mfma_f32_16x16x32_bf16 v[120:123], v[116:119], v[176:179], v[120:123]
    s_waitcnt lgkmcnt(8)
    v_mfma_f32_16x16x32_bf16 v[124:127], v[116:119], v[180:183], v[124:127]
    s_barrier
    s_waitcnt lgkmcnt(7)
    v_mfma_f32_16x16x32_bf16 v[192:195], v[176:179], v[160:163], v[192:195]
    ds_read_b64_tr_b16 v[144:145], v90 offset:32768
    v_mfma_f32_16x16x32_bf16 v[196:199], v[180:183], v[160:163], v[196:199]
    ds_read_b64_tr_b16 v[146:147], v90 offset:33792
    s_waitcnt lgkmcnt(8)
    v_mfma_f32_16x16x32_bf16 v[208:211], v[176:179], v[164:167], v[208:211]
    ds_read_b64_tr_b16 v[148:149], v91 offset:32768
    v_mfma_f32_16x16x32_bf16 v[212:215], v[180:183], v[164:167], v[212:215]
    ds_read_b64_tr_b16 v[150:151], v91 offset:33792
    s_waitcnt lgkmcnt(9)
    v_mfma_f32_16x16x32_bf16 v[224:227], v[176:179], v[168:171], v[224:227]
    ds_read_b128 v[128:131], v88 offset:32768
    v_mfma_f32_16x16x32_bf16 v[228:231], v[180:183], v[168:171], v[228:231]
    ds_read_b128 v[132:135], v88 offset:34816
    s_waitcnt lgkmcnt(10)
    v_mfma_f32_16x16x32_bf16 v[240:243], v[176:179], v[172:175], v[240:243]
    ds_read_b128 v[136:139], v88 offset:36864
    v_mfma_f32_16x16x32_bf16 v[244:247], v[180:183], v[172:175], v[244:247]
    ds_read_b128 v[140:143], v88 offset:38912
    s_waitcnt lgkmcnt(10)
    v_mfma_f32_16x16x32_bf16 v[200:203], v[184:187], v[160:163], v[200:203]
    ds_read_b64_tr_b16 v[152:153], v92 offset:32768
    v_mfma_f32_16x16x32_bf16 v[216:219], v[184:187], v[164:167], v[216:219]
    ds_read_b64_tr_b16 v[154:155], v92 offset:33792
    v_mfma_f32_16x16x32_bf16 v[232:235], v[184:187], v[168:171], v[232:235]
    ds_read_b64_tr_b16 v[156:157], v93 offset:32768
    v_mfma_f32_16x16x32_bf16 v[248:251], v[184:187], v[172:175], v[248:251]
    ds_read_b64_tr_b16 v[158:159], v93 offset:33792
    s_waitcnt lgkmcnt(12)
    v_mfma_f32_16x16x32_bf16 v[204:207], v[188:191], v[160:163], v[204:207]
    v_mfma_f32_16x16x32_bf16 v[220:223], v[188:191], v[164:167], v[220:223]
    v_mfma_f32_16x16x32_bf16 v[236:239], v[188:191], v[168:171], v[236:239]
    v_mfma_f32_16x16x32_bf16 v[252:255], v[188:191], v[172:175], v[252:255]
    s_waitcnt lgkmcnt(10)
    v_mfma_f32_16x16x32_bf16 v[120:123], v[116:119], v[144:147], v[120:123]
    ds_read_b64_tr_b16 v[176:177], v90 offset:40960
    s_waitcnt lgkmcnt(9)
    v_mfma_f32_16x16x32_bf16 v[124:127], v[116:119], v[148:151], v[124:127]
    ds_read_b64_tr_b16 v[178:179], v90 offset:41984
    s_waitcnt lgkmcnt(9)
    v_mfma_f32_16x16x32_bf16 v[192:195], v[144:147], v[128:131], v[192:195]
    ds_read_b64_tr_b16 v[180:181], v91 offset:40960
    v_mfma_f32_16x16x32_bf16 v[196:199], v[148:151], v[128:131], v[196:199]
    ds_read_b64_tr_b16 v[182:183], v91 offset:41984
    s_waitcnt lgkmcnt(10)
    v_mfma_f32_16x16x32_bf16 v[208:211], v[144:147], v[132:135], v[208:211]
    ds_read_b128 v[160:163], v89 offset:32768
    v_mfma_f32_16x16x32_bf16 v[212:215], v[148:151], v[132:135], v[212:215]
    ds_read_b128 v[164:167], v89 offset:34816
    s_waitcnt lgkmcnt(11)
    v_mfma_f32_16x16x32_bf16 v[224:227], v[144:147], v[136:139], v[224:227]
    ds_read_b128 v[168:171], v89 offset:36864
    v_mfma_f32_16x16x32_bf16 v[228:231], v[148:151], v[136:139], v[228:231]
    ds_read_b128 v[172:175], v89 offset:38912
    s_waitcnt lgkmcnt(12)
    v_mfma_f32_16x16x32_bf16 v[240:243], v[144:147], v[140:143], v[240:243]
    ds_read_b64_tr_b16 v[184:185], v92 offset:40960
    v_mfma_f32_16x16x32_bf16 v[244:247], v[148:151], v[140:143], v[244:247]
    ds_read_b64_tr_b16 v[186:187], v92 offset:41984
    s_waitcnt lgkmcnt(12)
    v_mfma_f32_16x16x32_bf16 v[200:203], v[152:155], v[128:131], v[200:203]
    ds_read_b64_tr_b16 v[188:189], v93 offset:40960
    v_mfma_f32_16x16x32_bf16 v[216:219], v[152:155], v[132:135], v[216:219]
    ds_read_b64_tr_b16 v[190:191], v93 offset:41984
    v_mfma_f32_16x16x32_bf16 v[232:235], v[152:155], v[136:139], v[232:235]
    v_mfma_f32_16x16x32_bf16 v[248:251], v[152:155], v[140:143], v[248:251]
    s_waitcnt lgkmcnt(12)
    v_mfma_f32_16x16x32_bf16 v[204:207], v[156:159], v[128:131], v[204:207]
    v_mfma_f32_16x16x32_bf16 v[220:223], v[156:159], v[132:135], v[220:223]
    v_mfma_f32_16x16x32_bf16 v[236:239], v[156:159], v[136:139], v[236:239]
    v_mfma_f32_16x16x32_bf16 v[252:255], v[156:159], v[140:143], v[252:255]
    s_waitcnt lgkmcnt(10)
    v_mfma_f32_16x16x32_bf16 v[120:123], v[116:119], v[176:179], v[120:123]
    s_waitcnt lgkmcnt(8)
    v_mfma_f32_16x16x32_bf16 v[124:127], v[116:119], v[180:183], v[124:127]
    s_barrier
    s_waitcnt lgkmcnt(7)
    v_mfma_f32_16x16x32_bf16 v[192:195], v[176:179], v[160:163], v[192:195]
    ds_read_b64_tr_b16 v[144:145], v96 offset:0
    v_mfma_f32_16x16x32_bf16 v[196:199], v[180:183], v[160:163], v[196:199]
    ds_read_b64_tr_b16 v[146:147], v96 offset:1024
    s_waitcnt lgkmcnt(8)
    v_mfma_f32_16x16x32_bf16 v[208:211], v[176:179], v[164:167], v[208:211]
    ds_read_b64_tr_b16 v[148:149], v97 offset:0
    v_mfma_f32_16x16x32_bf16 v[212:215], v[180:183], v[164:167], v[212:215]
    ds_read_b64_tr_b16 v[150:151], v97 offset:1024
    s_waitcnt lgkmcnt(9)
    v_mfma_f32_16x16x32_bf16 v[224:227], v[176:179], v[168:171], v[224:227]
    ds_read_b128 v[128:131], v94 offset:0
    v_mfma_f32_16x16x32_bf16 v[228:231], v[180:183], v[168:171], v[228:231]
    ds_read_b128 v[132:135], v94 offset:2048
    s_waitcnt lgkmcnt(10)
    v_mfma_f32_16x16x32_bf16 v[240:243], v[176:179], v[172:175], v[240:243]
    ds_read_b128 v[136:139], v94 offset:4096
    v_mfma_f32_16x16x32_bf16 v[244:247], v[180:183], v[172:175], v[244:247]
    ds_read_b128 v[140:143], v94 offset:6144
    s_waitcnt lgkmcnt(10)
    v_mfma_f32_16x16x32_bf16 v[200:203], v[184:187], v[160:163], v[200:203]
    ds_read_b64_tr_b16 v[152:153], v98 offset:0
    v_mfma_f32_16x16x32_bf16 v[216:219], v[184:187], v[164:167], v[216:219]
    ds_read_b64_tr_b16 v[154:155], v98 offset:1024
    v_mfma_f32_16x16x32_bf16 v[232:235], v[184:187], v[168:171], v[232:235]
    ds_read_b64_tr_b16 v[156:157], v99 offset:0
    v_mfma_f32_16x16x32_bf16 v[248:251], v[184:187], v[172:175], v[248:251]
    ds_read_b64_tr_b16 v[158:159], v99 offset:1024
    s_waitcnt lgkmcnt(12)
    v_mfma_f32_16x16x32_bf16 v[204:207], v[188:191], v[160:163], v[204:207]
    v_mfma_f32_16x16x32_bf16 v[220:223], v[188:191], v[164:167], v[220:223]
    v_mfma_f32_16x16x32_bf16 v[236:239], v[188:191], v[168:171], v[236:239]
    v_mfma_f32_16x16x32_bf16 v[252:255], v[188:191], v[172:175], v[252:255]
    s_waitcnt lgkmcnt(10)
    v_mfma_f32_16x16x32_bf16 v[120:123], v[116:119], v[144:147], v[120:123]
    ds_read_b64_tr_b16 v[176:177], v96 offset:8192
    s_waitcnt lgkmcnt(9)
    v_mfma_f32_16x16x32_bf16 v[124:127], v[116:119], v[148:151], v[124:127]
    ds_read_b64_tr_b16 v[178:179], v96 offset:9216
    s_waitcnt lgkmcnt(9)
    v_mfma_f32_16x16x32_bf16 v[192:195], v[144:147], v[128:131], v[192:195]
    ds_read_b64_tr_b16 v[180:181], v97 offset:8192
    v_mfma_f32_16x16x32_bf16 v[196:199], v[148:151], v[128:131], v[196:199]
    ds_read_b64_tr_b16 v[182:183], v97 offset:9216
    s_waitcnt lgkmcnt(10)
    v_mfma_f32_16x16x32_bf16 v[208:211], v[144:147], v[132:135], v[208:211]
    ds_read_b128 v[160:163], v95 offset:0
    v_mfma_f32_16x16x32_bf16 v[212:215], v[148:151], v[132:135], v[212:215]
    ds_read_b128 v[164:167], v95 offset:2048
    s_waitcnt lgkmcnt(11)
    v_mfma_f32_16x16x32_bf16 v[224:227], v[144:147], v[136:139], v[224:227]
    ds_read_b128 v[168:171], v95 offset:4096
    v_mfma_f32_16x16x32_bf16 v[228:231], v[148:151], v[136:139], v[228:231]
    ds_read_b128 v[172:175], v95 offset:6144
    s_waitcnt lgkmcnt(12)
    v_mfma_f32_16x16x32_bf16 v[240:243], v[144:147], v[140:143], v[240:243]
    ds_read_b64_tr_b16 v[184:185], v98 offset:8192
    v_mfma_f32_16x16x32_bf16 v[244:247], v[148:151], v[140:143], v[244:247]
    ds_read_b64_tr_b16 v[186:187], v98 offset:9216
    s_waitcnt lgkmcnt(12)
    v_mfma_f32_16x16x32_bf16 v[200:203], v[152:155], v[128:131], v[200:203]
    ds_read_b64_tr_b16 v[188:189], v99 offset:8192
    v_mfma_f32_16x16x32_bf16 v[216:219], v[152:155], v[132:135], v[216:219]
    ds_read_b64_tr_b16 v[190:191], v99 offset:9216
    v_mfma_f32_16x16x32_bf16 v[232:235], v[152:155], v[136:139], v[232:235]
    v_mfma_f32_16x16x32_bf16 v[248:251], v[152:155], v[140:143], v[248:251]
    s_waitcnt lgkmcnt(12)
    v_mfma_f32_16x16x32_bf16 v[204:207], v[156:159], v[128:131], v[204:207]
    v_mfma_f32_16x16x32_bf16 v[220:223], v[156:159], v[132:135], v[220:223]
    v_mfma_f32_16x16x32_bf16 v[236:239], v[156:159], v[136:139], v[236:239]
    v_mfma_f32_16x16x32_bf16 v[252:255], v[156:159], v[140:143], v[252:255]
    s_waitcnt lgkmcnt(10)
    v_mfma_f32_16x16x32_bf16 v[120:123], v[116:119], v[176:179], v[120:123]
    s_waitcnt lgkmcnt(8)
    v_mfma_f32_16x16x32_bf16 v[124:127], v[116:119], v[180:183], v[124:127]
    s_barrier
    s_waitcnt lgkmcnt(7)
    v_mfma_f32_16x16x32_bf16 v[192:195], v[176:179], v[160:163], v[192:195]
    ds_read_b64_tr_b16 v[144:145], v96 offset:32768
    v_mfma_f32_16x16x32_bf16 v[196:199], v[180:183], v[160:163], v[196:199]
    ds_read_b64_tr_b16 v[146:147], v96 offset:33792
    s_waitcnt lgkmcnt(8)
    v_mfma_f32_16x16x32_bf16 v[208:211], v[176:179], v[164:167], v[208:211]
    ds_read_b64_tr_b16 v[148:149], v97 offset:32768
    v_mfma_f32_16x16x32_bf16 v[212:215], v[180:183], v[164:167], v[212:215]
    ds_read_b64_tr_b16 v[150:151], v97 offset:33792
    s_waitcnt lgkmcnt(9)
    v_mfma_f32_16x16x32_bf16 v[224:227], v[176:179], v[168:171], v[224:227]
    ds_read_b128 v[128:131], v94 offset:32768
    v_mfma_f32_16x16x32_bf16 v[228:231], v[180:183], v[168:171], v[228:231]
    ds_read_b128 v[132:135], v94 offset:34816
    s_waitcnt lgkmcnt(10)
    v_mfma_f32_16x16x32_bf16 v[240:243], v[176:179], v[172:175], v[240:243]
    ds_read_b128 v[136:139], v94 offset:36864
    v_mfma_f32_16x16x32_bf16 v[244:247], v[180:183], v[172:175], v[244:247]
    ds_read_b128 v[140:143], v94 offset:38912
    s_waitcnt lgkmcnt(10)
    v_mfma_f32_16x16x32_bf16 v[200:203], v[184:187], v[160:163], v[200:203]
    ds_read_b64_tr_b16 v[152:153], v98 offset:32768
    v_mfma_f32_16x16x32_bf16 v[216:219], v[184:187], v[164:167], v[216:219]
    ds_read_b64_tr_b16 v[154:155], v98 offset:33792
    v_mfma_f32_16x16x32_bf16 v[232:235], v[184:187], v[168:171], v[232:235]
    ds_read_b64_tr_b16 v[156:157], v99 offset:32768
    v_mfma_f32_16x16x32_bf16 v[248:251], v[184:187], v[172:175], v[248:251]
    ds_read_b64_tr_b16 v[158:159], v99 offset:33792
    s_waitcnt lgkmcnt(12)
    v_mfma_f32_16x16x32_bf16 v[204:207], v[188:191], v[160:163], v[204:207]
    v_mfma_f32_16x16x32_bf16 v[220:223], v[188:191], v[164:167], v[220:223]
    v_mfma_f32_16x16x32_bf16 v[236:239], v[188:191], v[168:171], v[236:239]
    v_mfma_f32_16x16x32_bf16 v[252:255], v[188:191], v[172:175], v[252:255]
    s_waitcnt lgkmcnt(10)
    v_mfma_f32_16x16x32_bf16 v[120:123], v[116:119], v[144:147], v[120:123]
    ds_read_b64_tr_b16 v[176:177], v96 offset:40960
    s_waitcnt lgkmcnt(9)
    v_mfma_f32_16x16x32_bf16 v[124:127], v[116:119], v[148:151], v[124:127]
    ds_read_b64_tr_b16 v[178:179], v96 offset:41984
    s_waitcnt lgkmcnt(9)
    v_mfma_f32_16x16x32_bf16 v[192:195], v[144:147], v[128:131], v[192:195]
    ds_read_b64_tr_b16 v[180:181], v97 offset:40960
    v_mfma_f32_16x16x32_bf16 v[196:199], v[148:151], v[128:131], v[196:199]
    ds_read_b64_tr_b16 v[182:183], v97 offset:41984
    s_waitcnt lgkmcnt(10)
    v_mfma_f32_16x16x32_bf16 v[208:211], v[144:147], v[132:135], v[208:211]
    ds_read_b128 v[160:163], v95 offset:32768
    v_mfma_f32_16x16x32_bf16 v[212:215], v[148:151], v[132:135], v[212:215]
    ds_read_b128 v[164:167], v95 offset:34816
    s_waitcnt lgkmcnt(11)
    v_mfma_f32_16x16x32_bf16 v[224:227], v[144:147], v[136:139], v[224:227]
    ds_read_b128 v[168:171], v95 offset:36864
    v_mfma_f32_16x16x32_bf16 v[228:231], v[148:151], v[136:139], v[228:231]
    ds_read_b128 v[172:175], v95 offset:38912
    s_waitcnt lgkmcnt(12)
    v_mfma_f32_16x16x32_bf16 v[240:243], v[144:147], v[140:143], v[240:243]
    ds_read_b64_tr_b16 v[184:185], v98 offset:40960
    v_mfma_f32_16x16x32_bf16 v[244:247], v[148:151], v[140:143], v[244:247]
    ds_read_b64_tr_b16 v[186:187], v98 offset:41984
    s_waitcnt lgkmcnt(12)
    v_mfma_f32_16x16x32_bf16 v[200:203], v[152:155], v[128:131], v[200:203]
    ds_read_b64_tr_b16 v[188:189], v99 offset:40960
    v_mfma_f32_16x16x32_bf16 v[216:219], v[152:155], v[132:135], v[216:219]
    ds_read_b64_tr_b16 v[190:191], v99 offset:41984
    v_mfma_f32_16x16x32_bf16 v[232:235], v[152:155], v[136:139], v[232:235]
    v_mfma_f32_16x16x32_bf16 v[248:251], v[152:155], v[140:143], v[248:251]
    s_waitcnt lgkmcnt(12)
    v_mfma_f32_16x16x32_bf16 v[204:207], v[156:159], v[128:131], v[204:207]
    v_mfma_f32_16x16x32_bf16 v[220:223], v[156:159], v[132:135], v[220:223]
    v_mfma_f32_16x16x32_bf16 v[236:239], v[156:159], v[136:139], v[236:239]
    v_mfma_f32_16x16x32_bf16 v[252:255], v[156:159], v[140:143], v[252:255]
    s_waitcnt lgkmcnt(10)
    v_mfma_f32_16x16x32_bf16 v[120:123], v[116:119], v[176:179], v[120:123]
    s_waitcnt lgkmcnt(8)
    v_mfma_f32_16x16x32_bf16 v[124:127], v[116:119], v[180:183], v[124:127]
    s_barrier
    s_waitcnt lgkmcnt(7)
    v_mfma_f32_16x16x32_bf16 v[192:195], v[176:179], v[160:163], v[192:195]
    ds_read_b64_tr_b16 v[144:145], v102 offset:0
    v_mfma_f32_16x16x32_bf16 v[196:199], v[180:183], v[160:163], v[196:199]
    ds_read_b64_tr_b16 v[146:147], v102 offset:1024
    s_waitcnt lgkmcnt(8)
    v_mfma_f32_16x16x32_bf16 v[208:211], v[176:179], v[164:167], v[208:211]
    ds_read_b64_tr_b16 v[148:149], v103 offset:0
    v_mfma_f32_16x16x32_bf16 v[212:215], v[180:183], v[164:167], v[212:215]
    ds_read_b64_tr_b16 v[150:151], v103 offset:1024
    s_waitcnt lgkmcnt(9)
    v_mfma_f32_16x16x32_bf16 v[224:227], v[176:179], v[168:171], v[224:227]
    ds_read_b128 v[128:131], v100 offset:0
    v_mfma_f32_16x16x32_bf16 v[228:231], v[180:183], v[168:171], v[228:231]
    ds_read_b128 v[132:135], v100 offset:2048
    s_waitcnt lgkmcnt(10)
    v_mfma_f32_16x16x32_bf16 v[240:243], v[176:179], v[172:175], v[240:243]
    ds_read_b128 v[136:139], v100 offset:4096
    v_mfma_f32_16x16x32_bf16 v[244:247], v[180:183], v[172:175], v[244:247]
    ds_read_b128 v[140:143], v100 offset:6144
    s_waitcnt lgkmcnt(10)
    v_mfma_f32_16x16x32_bf16 v[200:203], v[184:187], v[160:163], v[200:203]
    ds_read_b64_tr_b16 v[152:153], v104 offset:0
    v_mfma_f32_16x16x32_bf16 v[216:219], v[184:187], v[164:167], v[216:219]
    ds_read_b64_tr_b16 v[154:155], v104 offset:1024
    v_mfma_f32_16x16x32_bf16 v[232:235], v[184:187], v[168:171], v[232:235]
    ds_read_b64_tr_b16 v[156:157], v105 offset:0
    v_mfma_f32_16x16x32_bf16 v[248:251], v[184:187], v[172:175], v[248:251]
    ds_read_b64_tr_b16 v[158:159], v105 offset:1024
    s_waitcnt lgkmcnt(12)
    v_mfma_f32_16x16x32_bf16 v[204:207], v[188:191], v[160:163], v[204:207]
    v_mfma_f32_16x16x32_bf16 v[220:223], v[188:191], v[164:167], v[220:223]
    v_mfma_f32_16x16x32_bf16 v[236:239], v[188:191], v[168:171], v[236:239]
    v_mfma_f32_16x16x32_bf16 v[252:255], v[188:191], v[172:175], v[252:255]
    s_waitcnt lgkmcnt(10)
    v_mfma_f32_16x16x32_bf16 v[120:123], v[116:119], v[144:147], v[120:123]
    ds_read_b64_tr_b16 v[176:177], v102 offset:8192
    s_waitcnt lgkmcnt(9)
    v_mfma_f32_16x16x32_bf16 v[124:127], v[116:119], v[148:151], v[124:127]
    ds_read_b64_tr_b16 v[178:179], v102 offset:9216
    s_waitcnt lgkmcnt(9)
    v_mfma_f32_16x16x32_bf16 v[192:195], v[144:147], v[128:131], v[192:195]
    ds_read_b64_tr_b16 v[180:181], v103 offset:8192
    v_mfma_f32_16x16x32_bf16 v[196:199], v[148:151], v[128:131], v[196:199]
    ds_read_b64_tr_b16 v[182:183], v103 offset:9216
    s_waitcnt lgkmcnt(10)
    v_mfma_f32_16x16x32_bf16 v[208:211], v[144:147], v[132:135], v[208:211]
    ds_read_b128 v[160:163], v101 offset:0
    v_mfma_f32_16x16x32_bf16 v[212:215], v[148:151], v[132:135], v[212:215]
    ds_read_b128 v[164:167], v101 offset:2048
    s_waitcnt lgkmcnt(11)
    v_mfma_f32_16x16x32_bf16 v[224:227], v[144:147], v[136:139], v[224:227]
    ds_read_b128 v[168:171], v101 offset:4096
    v_mfma_f32_16x16x32_bf16 v[228:231], v[148:151], v[136:139], v[228:231]
    ds_read_b128 v[172:175], v101 offset:6144
    s_waitcnt lgkmcnt(12)
    v_mfma_f32_16x16x32_bf16 v[240:243], v[144:147], v[140:143], v[240:243]
    ds_read_b64_tr_b16 v[184:185], v104 offset:8192
    v_mfma_f32_16x16x32_bf16 v[244:247], v[148:151], v[140:143], v[244:247]
    ds_read_b64_tr_b16 v[186:187], v104 offset:9216
    s_waitcnt lgkmcnt(12)
    v_mfma_f32_16x16x32_bf16 v[200:203], v[152:155], v[128:131], v[200:203]
    ds_read_b64_tr_b16 v[188:189], v105 offset:8192
    v_mfma_f32_16x16x32_bf16 v[216:219], v[152:155], v[132:135], v[216:219]
    ds_read_b64_tr_b16 v[190:191], v105 offset:9216
    v_mfma_f32_16x16x32_bf16 v[232:235], v[152:155], v[136:139], v[232:235]
    v_mfma_f32_16x16x32_bf16 v[248:251], v[152:155], v[140:143], v[248:251]
    s_waitcnt lgkmcnt(12)
    v_mfma_f32_16x16x32_bf16 v[204:207], v[156:159], v[128:131], v[204:207]
    v_mfma_f32_16x16x32_bf16 v[220:223], v[156:159], v[132:135], v[220:223]
    v_mfma_f32_16x16x32_bf16 v[236:239], v[156:159], v[136:139], v[236:239]
    v_mfma_f32_16x16x32_bf16 v[252:255], v[156:159], v[140:143], v[252:255]
    s_waitcnt lgkmcnt(10)
    v_mfma_f32_16x16x32_bf16 v[120:123], v[116:119], v[176:179], v[120:123]
    s_waitcnt lgkmcnt(8)
    v_mfma_f32_16x16x32_bf16 v[124:127], v[116:119], v[180:183], v[124:127]
    s_barrier
    s_waitcnt lgkmcnt(7)
    v_mfma_f32_16x16x32_bf16 v[192:195], v[176:179], v[160:163], v[192:195]
    ds_read_b64_tr_b16 v[144:145], v90 offset:0
    v_mfma_f32_16x16x32_bf16 v[196:199], v[180:183], v[160:163], v[196:199]
    ds_read_b64_tr_b16 v[146:147], v90 offset:1024
    s_waitcnt lgkmcnt(8)
    v_mfma_f32_16x16x32_bf16 v[208:211], v[176:179], v[164:167], v[208:211]
    ds_read_b64_tr_b16 v[148:149], v91 offset:0
    v_mfma_f32_16x16x32_bf16 v[212:215], v[180:183], v[164:167], v[212:215]
    ds_read_b64_tr_b16 v[150:151], v91 offset:1024
    s_waitcnt lgkmcnt(9)
    v_mfma_f32_16x16x32_bf16 v[224:227], v[176:179], v[168:171], v[224:227]
    ds_read_b128 v[128:131], v88 offset:0
    v_mfma_f32_16x16x32_bf16 v[228:231], v[180:183], v[168:171], v[228:231]
    ds_read_b128 v[132:135], v88 offset:2048
    s_waitcnt lgkmcnt(10)
    v_mfma_f32_16x16x32_bf16 v[240:243], v[176:179], v[172:175], v[240:243]
    ds_read_b128 v[136:139], v88 offset:4096
    v_mfma_f32_16x16x32_bf16 v[244:247], v[180:183], v[172:175], v[244:247]
    ds_read_b128 v[140:143], v88 offset:6144
    s_waitcnt lgkmcnt(10)
    v_mfma_f32_16x16x32_bf16 v[200:203], v[184:187], v[160:163], v[200:203]
    ds_read_b64_tr_b16 v[152:153], v92 offset:0
    v_mfma_f32_16x16x32_bf16 v[216:219], v[184:187], v[164:167], v[216:219]
    ds_read_b64_tr_b16 v[154:155], v92 offset:1024
    v_mfma_f32_16x16x32_bf16 v[232:235], v[184:187], v[168:171], v[232:235]
    ds_read_b64_tr_b16 v[156:157], v93 offset:0
    v_mfma_f32_16x16x32_bf16 v[248:251], v[184:187], v[172:175], v[248:251]
    ds_read_b64_tr_b16 v[158:159], v93 offset:1024
    s_waitcnt lgkmcnt(12)
    v_mfma_f32_16x16x32_bf16 v[204:207], v[188:191], v[160:163], v[204:207]
    v_mfma_f32_16x16x32_bf16 v[220:223], v[188:191], v[164:167], v[220:223]
    v_mfma_f32_16x16x32_bf16 v[236:239], v[188:191], v[168:171], v[236:239]
    v_mfma_f32_16x16x32_bf16 v[252:255], v[188:191], v[172:175], v[252:255]
    s_waitcnt lgkmcnt(10)
    v_mfma_f32_16x16x32_bf16 v[120:123], v[116:119], v[144:147], v[120:123]
    ds_read_b64_tr_b16 v[176:177], v90 offset:8192
    s_waitcnt lgkmcnt(9)
    v_mfma_f32_16x16x32_bf16 v[124:127], v[116:119], v[148:151], v[124:127]
    ds_read_b64_tr_b16 v[178:179], v90 offset:9216
    s_waitcnt lgkmcnt(9)
    v_mfma_f32_16x16x32_bf16 v[192:195], v[144:147], v[128:131], v[192:195]
    ds_read_b64_tr_b16 v[180:181], v91 offset:8192
    v_mfma_f32_16x16x32_bf16 v[196:199], v[148:151], v[128:131], v[196:199]
    ds_read_b64_tr_b16 v[182:183], v91 offset:9216
    s_waitcnt lgkmcnt(10)
    v_mfma_f32_16x16x32_bf16 v[208:211], v[144:147], v[132:135], v[208:211]
    ds_read_b128 v[160:163], v89 offset:0
    v_mfma_f32_16x16x32_bf16 v[212:215], v[148:151], v[132:135], v[212:215]
    ds_read_b128 v[164:167], v89 offset:2048
    s_waitcnt lgkmcnt(11)
    v_mfma_f32_16x16x32_bf16 v[224:227], v[144:147], v[136:139], v[224:227]
    ds_read_b128 v[168:171], v89 offset:4096
    v_mfma_f32_16x16x32_bf16 v[228:231], v[148:151], v[136:139], v[228:231]
    ds_read_b128 v[172:175], v89 offset:6144
    s_waitcnt lgkmcnt(12)
    v_mfma_f32_16x16x32_bf16 v[240:243], v[144:147], v[140:143], v[240:243]
    ds_read_b64_tr_b16 v[184:185], v92 offset:8192
    v_mfma_f32_16x16x32_bf16 v[244:247], v[148:151], v[140:143], v[244:247]
    ds_read_b64_tr_b16 v[186:187], v92 offset:9216
    s_waitcnt lgkmcnt(12)
    v_mfma_f32_16x16x32_bf16 v[200:203], v[152:155], v[128:131], v[200:203]
    ds_read_b64_tr_b16 v[188:189], v93 offset:8192
    v_mfma_f32_16x16x32_bf16 v[216:219], v[152:155], v[132:135], v[216:219]
    ds_read_b64_tr_b16 v[190:191], v93 offset:9216
    v_mfma_f32_16x16x32_bf16 v[232:235], v[152:155], v[136:139], v[232:235]
    v_mfma_f32_16x16x32_bf16 v[248:251], v[152:155], v[140:143], v[248:251]
    s_waitcnt lgkmcnt(12)
    v_mfma_f32_16x16x32_bf16 v[204:207], v[156:159], v[128:131], v[204:207]
    v_mfma_f32_16x16x32_bf16 v[220:223], v[156:159], v[132:135], v[220:223]
    v_mfma_f32_16x16x32_bf16 v[236:239], v[156:159], v[136:139], v[236:239]
    v_mfma_f32_16x16x32_bf16 v[252:255], v[156:159], v[140:143], v[252:255]
    s_waitcnt lgkmcnt(10)
    v_mfma_f32_16x16x32_bf16 v[120:123], v[116:119], v[176:179], v[120:123]
    s_waitcnt lgkmcnt(8)
    v_mfma_f32_16x16x32_bf16 v[124:127], v[116:119], v[180:183], v[124:127]
    s_barrier
    s_waitcnt lgkmcnt(7)
    v_mfma_f32_16x16x32_bf16 v[192:195], v[176:179], v[160:163], v[192:195]
    ds_read_b64_tr_b16 v[144:145], v90 offset:32768
    v_mfma_f32_16x16x32_bf16 v[196:199], v[180:183], v[160:163], v[196:199]
    ds_read_b64_tr_b16 v[146:147], v90 offset:33792
    s_waitcnt lgkmcnt(8)
    v_mfma_f32_16x16x32_bf16 v[208:211], v[176:179], v[164:167], v[208:211]
    ds_read_b64_tr_b16 v[148:149], v91 offset:32768
    v_mfma_f32_16x16x32_bf16 v[212:215], v[180:183], v[164:167], v[212:215]
    ds_read_b64_tr_b16 v[150:151], v91 offset:33792
    s_waitcnt lgkmcnt(9)
    v_mfma_f32_16x16x32_bf16 v[224:227], v[176:179], v[168:171], v[224:227]
    ds_read_b128 v[128:131], v88 offset:32768
    v_mfma_f32_16x16x32_bf16 v[228:231], v[180:183], v[168:171], v[228:231]
    ds_read_b128 v[132:135], v88 offset:34816
    s_waitcnt lgkmcnt(10)
    v_mfma_f32_16x16x32_bf16 v[240:243], v[176:179], v[172:175], v[240:243]
    ds_read_b128 v[136:139], v88 offset:36864
    v_mfma_f32_16x16x32_bf16 v[244:247], v[180:183], v[172:175], v[244:247]
    ds_read_b128 v[140:143], v88 offset:38912
    s_waitcnt lgkmcnt(10)
    v_mfma_f32_16x16x32_bf16 v[200:203], v[184:187], v[160:163], v[200:203]
    ds_read_b64_tr_b16 v[152:153], v92 offset:32768
    v_mfma_f32_16x16x32_bf16 v[216:219], v[184:187], v[164:167], v[216:219]
    ds_read_b64_tr_b16 v[154:155], v92 offset:33792
    v_mfma_f32_16x16x32_bf16 v[232:235], v[184:187], v[168:171], v[232:235]
    ds_read_b64_tr_b16 v[156:157], v93 offset:32768
    v_mfma_f32_16x16x32_bf16 v[248:251], v[184:187], v[172:175], v[248:251]
    ds_read_b64_tr_b16 v[158:159], v93 offset:33792
    s_waitcnt lgkmcnt(12)
    v_mfma_f32_16x16x32_bf16 v[204:207], v[188:191], v[160:163], v[204:207]
    v_mfma_f32_16x16x32_bf16 v[220:223], v[188:191], v[164:167], v[220:223]
    v_mfma_f32_16x16x32_bf16 v[236:239], v[188:191], v[168:171], v[236:239]
    v_mfma_f32_16x16x32_bf16 v[252:255], v[188:191], v[172:175], v[252:255]
    s_waitcnt lgkmcnt(10)
    v_mfma_f32_16x16x32_bf16 v[120:123], v[116:119], v[144:147], v[120:123]
    ds_read_b64_tr_b16 v[176:177], v90 offset:40960
    s_waitcnt lgkmcnt(9)
    v_mfma_f32_16x16x32_bf16 v[124:127], v[116:119], v[148:151], v[124:127]
    ds_read_b64_tr_b16 v[178:179], v90 offset:41984
    s_waitcnt lgkmcnt(9)
    v_mfma_f32_16x16x32_bf16 v[192:195], v[144:147], v[128:131], v[192:195]
    ds_read_b64_tr_b16 v[180:181], v91 offset:40960
    v_mfma_f32_16x16x32_bf16 v[196:199], v[148:151], v[128:131], v[196:199]
    ds_read_b64_tr_b16 v[182:183], v91 offset:41984
    s_waitcnt lgkmcnt(10)
    v_mfma_f32_16x16x32_bf16 v[208:211], v[144:147], v[132:135], v[208:211]
    ds_read_b128 v[160:163], v89 offset:32768
    v_mfma_f32_16x16x32_bf16 v[212:215], v[148:151], v[132:135], v[212:215]
    ds_read_b128 v[164:167], v89 offset:34816
    s_waitcnt lgkmcnt(11)
    v_mfma_f32_16x16x32_bf16 v[224:227], v[144:147], v[136:139], v[224:227]
    ds_read_b128 v[168:171], v89 offset:36864
    v_mfma_f32_16x16x32_bf16 v[228:231], v[148:151], v[136:139], v[228:231]
    ds_read_b128 v[172:175], v89 offset:38912
    s_waitcnt lgkmcnt(12)
    v_mfma_f32_16x16x32_bf16 v[240:243], v[144:147], v[140:143], v[240:243]
    ds_read_b64_tr_b16 v[184:185], v92 offset:40960
    v_mfma_f32_16x16x32_bf16 v[244:247], v[148:151], v[140:143], v[244:247]
    ds_read_b64_tr_b16 v[186:187], v92 offset:41984
    s_waitcnt lgkmcnt(12)
    v_mfma_f32_16x16x32_bf16 v[200:203], v[152:155], v[128:131], v[200:203]
    ds_read_b64_tr_b16 v[188:189], v93 offset:40960
    v_mfma_f32_16x16x32_bf16 v[216:219], v[152:155], v[132:135], v[216:219]
    ds_read_b64_tr_b16 v[190:191], v93 offset:41984
    v_mfma_f32_16x16x32_bf16 v[232:235], v[152:155], v[136:139], v[232:235]
    v_mfma_f32_16x16x32_bf16 v[248:251], v[152:155], v[140:143], v[248:251]
    s_waitcnt lgkmcnt(12)
    v_mfma_f32_16x16x32_bf16 v[204:207], v[156:159], v[128:131], v[204:207]
    v_mfma_f32_16x16x32_bf16 v[220:223], v[156:159], v[132:135], v[220:223]
    v_mfma_f32_16x16x32_bf16 v[236:239], v[156:159], v[136:139], v[236:239]
    v_mfma_f32_16x16x32_bf16 v[252:255], v[156:159], v[140:143], v[252:255]
    s_waitcnt lgkmcnt(10)
    v_mfma_f32_16x16x32_bf16 v[120:123], v[116:119], v[176:179], v[120:123]
    s_waitcnt lgkmcnt(8)
    v_mfma_f32_16x16x32_bf16 v[124:127], v[116:119], v[180:183], v[124:127]
    s_barrier
    s_waitcnt lgkmcnt(7)
    v_mfma_f32_16x16x32_bf16 v[192:195], v[176:179], v[160:163], v[192:195]
    ds_read_b64_tr_b16 v[144:145], v96 offset:0
    v_mfma_f32_16x16x32_bf16 v[196:199], v[180:183], v[160:163], v[196:199]
    ds_read_b64_tr_b16 v[146:147], v96 offset:1024
    s_waitcnt lgkmcnt(8)
    v_mfma_f32_16x16x32_bf16 v[208:211], v[176:179], v[164:167], v[208:211]
    ds_read_b64_tr_b16 v[148:149], v97 offset:0
    v_mfma_f32_16x16x32_bf16 v[212:215], v[180:183], v[164:167], v[212:215]
    ds_read_b64_tr_b16 v[150:151], v97 offset:1024
    s_waitcnt lgkmcnt(9)
    v_mfma_f32_16x16x32_bf16 v[224:227], v[176:179], v[168:171], v[224:227]
    ds_read_b128 v[128:131], v94 offset:0
    v_mfma_f32_16x16x32_bf16 v[228:231], v[180:183], v[168:171], v[228:231]
    ds_read_b128 v[132:135], v94 offset:2048
    s_waitcnt lgkmcnt(10)
    v_mfma_f32_16x16x32_bf16 v[240:243], v[176:179], v[172:175], v[240:243]
    ds_read_b128 v[136:139], v94 offset:4096
    v_mfma_f32_16x16x32_bf16 v[244:247], v[180:183], v[172:175], v[244:247]
    ds_read_b128 v[140:143], v94 offset:6144
    s_waitcnt lgkmcnt(10)
    v_mfma_f32_16x16x32_bf16 v[200:203], v[184:187], v[160:163], v[200:203]
    ds_read_b64_tr_b16 v[152:153], v98 offset:0
    v_mfma_f32_16x16x32_bf16 v[216:219], v[184:187], v[164:167], v[216:219]
    ds_read_b64_tr_b16 v[154:155], v98 offset:1024
    v_mfma_f32_16x16x32_bf16 v[232:235], v[184:187], v[168:171], v[232:235]
    ds_read_b64_tr_b16 v[156:157], v99 offset:0
    v_mfma_f32_16x16x32_bf16 v[248:251], v[184:187], v[172:175], v[248:251]
    ds_read_b64_tr_b16 v[158:159], v99 offset:1024
    s_waitcnt lgkmcnt(12)
    v_mfma_f32_16x16x32_bf16 v[204:207], v[188:191], v[160:163], v[204:207]
    v_mfma_f32_16x16x32_bf16 v[220:223], v[188:191], v[164:167], v[220:223]
    v_mfma_f32_16x16x32_bf16 v[236:239], v[188:191], v[168:171], v[236:239]
    v_mfma_f32_16x16x32_bf16 v[252:255], v[188:191], v[172:175], v[252:255]
    s_waitcnt lgkmcnt(10)
    v_mfma_f32_16x16x32_bf16 v[120:123], v[116:119], v[144:147], v[120:123]
    ds_read_b64_tr_b16 v[176:177], v96 offset:8192
    s_waitcnt lgkmcnt(9)
    v_mfma_f32_16x16x32_bf16 v[124:127], v[116:119], v[148:151], v[124:127]
    ds_read_b64_tr_b16 v[178:179], v96 offset:9216
    s_waitcnt lgkmcnt(9)
    v_mfma_f32_16x16x32_bf16 v[192:195], v[144:147], v[128:131], v[192:195]
    ds_read_b64_tr_b16 v[180:181], v97 offset:8192
    v_mfma_f32_16x16x32_bf16 v[196:199], v[148:151], v[128:131], v[196:199]
    ds_read_b64_tr_b16 v[182:183], v97 offset:9216
    s_waitcnt lgkmcnt(10)
    v_mfma_f32_16x16x32_bf16 v[208:211], v[144:147], v[132:135], v[208:211]
    ds_read_b128 v[160:163], v95 offset:0
    v_mfma_f32_16x16x32_bf16 v[212:215], v[148:151], v[132:135], v[212:215]
    ds_read_b128 v[164:167], v95 offset:2048
    s_waitcnt lgkmcnt(11)
    v_mfma_f32_16x16x32_bf16 v[224:227], v[144:147], v[136:139], v[224:227]
    ds_read_b128 v[168:171], v95 offset:4096
    v_mfma_f32_16x16x32_bf16 v[228:231], v[148:151], v[136:139], v[228:231]
    ds_read_b128 v[172:175], v95 offset:6144
    s_waitcnt lgkmcnt(12)
    v_mfma_f32_16x16x32_bf16 v[240:243], v[144:147], v[140:143], v[240:243]
    ds_read_b64_tr_b16 v[184:185], v98 offset:8192
    v_mfma_f32_16x16x32_bf16 v[244:247], v[148:151], v[140:143], v[244:247]
    ds_read_b64_tr_b16 v[186:187], v98 offset:9216
    s_waitcnt lgkmcnt(12)
    v_mfma_f32_16x16x32_bf16 v[200:203], v[152:155], v[128:131], v[200:203]
    ds_read_b64_tr_b16 v[188:189], v99 offset:8192
    v_mfma_f32_16x16x32_bf16 v[216:219], v[152:155], v[132:135], v[216:219]
    ds_read_b64_tr_b16 v[190:191], v99 offset:9216
    v_mfma_f32_16x16x32_bf16 v[232:235], v[152:155], v[136:139], v[232:235]
    v_mfma_f32_16x16x32_bf16 v[248:251], v[152:155], v[140:143], v[248:251]
    s_waitcnt lgkmcnt(12)
    v_mfma_f32_16x16x32_bf16 v[204:207], v[156:159], v[128:131], v[204:207]
    v_mfma_f32_16x16x32_bf16 v[220:223], v[156:159], v[132:135], v[220:223]
    v_mfma_f32_16x16x32_bf16 v[236:239], v[156:159], v[136:139], v[236:239]
    v_mfma_f32_16x16x32_bf16 v[252:255], v[156:159], v[140:143], v[252:255]
    s_waitcnt lgkmcnt(10)
    v_mfma_f32_16x16x32_bf16 v[120:123], v[116:119], v[176:179], v[120:123]
    s_waitcnt lgkmcnt(8)
    v_mfma_f32_16x16x32_bf16 v[124:127], v[116:119], v[180:183], v[124:127]
    s_waitcnt lgkmcnt(7)
    v_mfma_f32_16x16x32_bf16 v[192:195], v[176:179], v[160:163], v[192:195]
    v_mfma_f32_16x16x32_bf16 v[196:199], v[180:183], v[160:163], v[196:199]
    s_waitcnt lgkmcnt(6)
    v_mfma_f32_16x16x32_bf16 v[208:211], v[176:179], v[164:167], v[208:211]
    v_mfma_f32_16x16x32_bf16 v[212:215], v[180:183], v[164:167], v[212:215]
    s_barrier
    s_waitcnt lgkmcnt(5)
    v_mfma_f32_16x16x32_bf16 v[224:227], v[176:179], v[168:171], v[224:227]
    ds_read_b64_tr_b16 v[144:145], v96 offset:32768
    v_mfma_f32_16x16x32_bf16 v[228:231], v[180:183], v[168:171], v[228:231]
    ds_read_b64_tr_b16 v[146:147], v96 offset:33792
    s_waitcnt lgkmcnt(6)
    v_mfma_f32_16x16x32_bf16 v[240:243], v[176:179], v[172:175], v[240:243]
    ds_read_b64_tr_b16 v[148:149], v97 offset:32768
    v_mfma_f32_16x16x32_bf16 v[244:247], v[180:183], v[172:175], v[244:247]
    ds_read_b64_tr_b16 v[150:151], v97 offset:33792
    s_waitcnt lgkmcnt(6)
    v_mfma_f32_16x16x32_bf16 v[200:203], v[184:187], v[160:163], v[200:203]
    ds_read_b128 v[128:131], v94 offset:32768
    v_mfma_f32_16x16x32_bf16 v[216:219], v[184:187], v[164:167], v[216:219]
    ds_read_b128 v[132:135], v94 offset:34816
    v_mfma_f32_16x16x32_bf16 v[232:235], v[184:187], v[168:171], v[232:235]
    ds_read_b128 v[136:139], v94 offset:36864
    v_mfma_f32_16x16x32_bf16 v[248:251], v[184:187], v[172:175], v[248:251]
    ds_read_b128 v[140:143], v94 offset:38912
    s_waitcnt lgkmcnt(8)
    v_mfma_f32_16x16x32_bf16 v[204:207], v[188:191], v[160:163], v[204:207]
    ds_read_b64_tr_b16 v[152:153], v98 offset:32768
    v_mfma_f32_16x16x32_bf16 v[220:223], v[188:191], v[164:167], v[220:223]
    ds_read_b64_tr_b16 v[154:155], v98 offset:33792
    v_mfma_f32_16x16x32_bf16 v[236:239], v[188:191], v[168:171], v[236:239]
    ds_read_b64_tr_b16 v[156:157], v99 offset:32768
    v_mfma_f32_16x16x32_bf16 v[252:255], v[188:191], v[172:175], v[252:255]
    ds_read_b64_tr_b16 v[158:159], v99 offset:33792
    s_waitcnt lgkmcnt(10)
    v_mfma_f32_16x16x32_bf16 v[120:123], v[116:119], v[144:147], v[120:123]
    ds_read_b64_tr_b16 v[176:177], v96 offset:40960
    s_waitcnt lgkmcnt(9)
    v_mfma_f32_16x16x32_bf16 v[124:127], v[116:119], v[148:151], v[124:127]
    ds_read_b64_tr_b16 v[178:179], v96 offset:41984
    s_waitcnt lgkmcnt(9)
    v_mfma_f32_16x16x32_bf16 v[192:195], v[144:147], v[128:131], v[192:195]
    ds_read_b64_tr_b16 v[180:181], v97 offset:40960
    v_mfma_f32_16x16x32_bf16 v[196:199], v[148:151], v[128:131], v[196:199]
    ds_read_b64_tr_b16 v[182:183], v97 offset:41984
    s_waitcnt lgkmcnt(10)
    v_mfma_f32_16x16x32_bf16 v[208:211], v[144:147], v[132:135], v[208:211]
    ds_read_b128 v[160:163], v95 offset:32768
    v_mfma_f32_16x16x32_bf16 v[212:215], v[148:151], v[132:135], v[212:215]
    ds_read_b128 v[164:167], v95 offset:34816
    s_waitcnt lgkmcnt(11)
    v_mfma_f32_16x16x32_bf16 v[224:227], v[144:147], v[136:139], v[224:227]
    ds_read_b128 v[168:171], v95 offset:36864
    v_mfma_f32_16x16x32_bf16 v[228:231], v[148:151], v[136:139], v[228:231]
    ds_read_b128 v[172:175], v95 offset:38912
    s_waitcnt lgkmcnt(12)
    v_mfma_f32_16x16x32_bf16 v[240:243], v[144:147], v[140:143], v[240:243]
    ds_read_b64_tr_b16 v[184:185], v98 offset:40960
    v_mfma_f32_16x16x32_bf16 v[244:247], v[148:151], v[140:143], v[244:247]
    ds_read_b64_tr_b16 v[186:187], v98 offset:41984
    s_waitcnt lgkmcnt(12)
    v_mfma_f32_16x16x32_bf16 v[200:203], v[152:155], v[128:131], v[200:203]
    ds_read_b64_tr_b16 v[188:189], v99 offset:40960
    v_mfma_f32_16x16x32_bf16 v[216:219], v[152:155], v[132:135], v[216:219]
    ds_read_b64_tr_b16 v[190:191], v99 offset:41984
    v_mfma_f32_16x16x32_bf16 v[232:235], v[152:155], v[136:139], v[232:235]
    v_mfma_f32_16x16x32_bf16 v[248:251], v[152:155], v[140:143], v[248:251]
    s_waitcnt lgkmcnt(12)
    v_mfma_f32_16x16x32_bf16 v[204:207], v[156:159], v[128:131], v[204:207]
    v_mfma_f32_16x16x32_bf16 v[220:223], v[156:159], v[132:135], v[220:223]
    v_mfma_f32_16x16x32_bf16 v[236:239], v[156:159], v[136:139], v[236:239]
    v_mfma_f32_16x16x32_bf16 v[252:255], v[156:159], v[140:143], v[252:255]
    s_waitcnt lgkmcnt(10)
    v_mfma_f32_16x16x32_bf16 v[120:123], v[116:119], v[176:179], v[120:123]
    ds_read_b64_tr_b16 v[144:145], v102 offset:0
    s_waitcnt lgkmcnt(9)
    v_mfma_f32_16x16x32_bf16 v[124:127], v[116:119], v[180:183], v[124:127]
    ds_read_b64_tr_b16 v[146:147], v102 offset:1024
    s_waitcnt lgkmcnt(9)
    v_mfma_f32_16x16x32_bf16 v[192:195], v[176:179], v[160:163], v[192:195]
    ds_read_b64_tr_b16 v[148:149], v103 offset:0
    v_mfma_f32_16x16x32_bf16 v[196:199], v[180:183], v[160:163], v[196:199]
    ds_read_b64_tr_b16 v[150:151], v103 offset:1024
    s_waitcnt lgkmcnt(10)
    v_mfma_f32_16x16x32_bf16 v[208:211], v[176:179], v[164:167], v[208:211]
    ds_read_b128 v[128:131], v100 offset:0
    v_mfma_f32_16x16x32_bf16 v[212:215], v[180:183], v[164:167], v[212:215]
    ds_read_b128 v[132:135], v100 offset:2048
    s_waitcnt lgkmcnt(11)
    v_mfma_f32_16x16x32_bf16 v[224:227], v[176:179], v[168:171], v[224:227]
    ds_read_b128 v[136:139], v100 offset:4096
    v_mfma_f32_16x16x32_bf16 v[228:231], v[180:183], v[168:171], v[228:231]
    ds_read_b128 v[140:143], v100 offset:6144
    s_waitcnt lgkmcnt(12)
    v_mfma_f32_16x16x32_bf16 v[240:243], v[176:179], v[172:175], v[240:243]
    ds_read_b64_tr_b16 v[152:153], v104 offset:0
    v_mfma_f32_16x16x32_bf16 v[244:247], v[180:183], v[172:175], v[244:247]
    ds_read_b64_tr_b16 v[154:155], v104 offset:1024
    s_waitcnt lgkmcnt(12)
    v_mfma_f32_16x16x32_bf16 v[200:203], v[184:187], v[160:163], v[200:203]
    ds_read_b64_tr_b16 v[156:157], v105 offset:0
    v_mfma_f32_16x16x32_bf16 v[216:219], v[184:187], v[164:167], v[216:219]
    ds_read_b64_tr_b16 v[158:159], v105 offset:1024
    v_mfma_f32_16x16x32_bf16 v[232:235], v[184:187], v[168:171], v[232:235]
    ds_read_b64_tr_b16 v[64:65], v102 offset:8192
    v_mfma_f32_16x16x32_bf16 v[248:251], v[184:187], v[172:175], v[248:251]
    ds_read_b64_tr_b16 v[66:67], v102 offset:9216
    s_waitcnt lgkmcnt(14)
    v_mfma_f32_16x16x32_bf16 v[204:207], v[188:191], v[160:163], v[204:207]
    ds_read_b64_tr_b16 v[68:69], v103 offset:8192
    v_mfma_f32_16x16x32_bf16 v[220:223], v[188:191], v[164:167], v[220:223]
    ds_read_b64_tr_b16 v[70:71], v103 offset:9216
    v_mfma_f32_16x16x32_bf16 v[236:239], v[188:191], v[168:171], v[236:239]
    v_mfma_f32_16x16x32_bf16 v[252:255], v[188:191], v[172:175], v[252:255]
    s_waitcnt lgkmcnt(14)
    v_mfma_f32_16x16x32_bf16 v[120:123], v[116:119], v[144:147], v[120:123]
    ds_read_b64_tr_b16 v[176:177], v102 offset:8192
    s_waitcnt lgkmcnt(13)
    v_mfma_f32_16x16x32_bf16 v[124:127], v[116:119], v[148:151], v[124:127]
    ds_read_b64_tr_b16 v[178:179], v102 offset:9216
    s_waitcnt lgkmcnt(13)
    v_mfma_f32_16x16x32_bf16 v[192:195], v[144:147], v[128:131], v[192:195]
    ds_read_b64_tr_b16 v[180:181], v103 offset:8192
    v_mfma_f32_16x16x32_bf16 v[196:199], v[148:151], v[128:131], v[196:199]
    ds_read_b64_tr_b16 v[182:183], v103 offset:9216
    s_waitcnt lgkmcnt(14)
    v_mfma_f32_16x16x32_bf16 v[208:211], v[144:147], v[132:135], v[208:211]
    ds_read_b128 v[160:163], v101 offset:0
    v_mfma_f32_16x16x32_bf16 v[212:215], v[148:151], v[132:135], v[212:215]
    ds_read_b128 v[164:167], v101 offset:2048
    s_waitcnt lgkmcnt(15)
    v_mfma_f32_16x16x32_bf16 v[224:227], v[144:147], v[136:139], v[224:227]
    ds_read_b128 v[168:171], v101 offset:4096
    v_mfma_f32_16x16x32_bf16 v[228:231], v[148:151], v[136:139], v[228:231]
    ds_read_b128 v[172:175], v101 offset:6144
    s_waitcnt lgkmcnt(15)
    v_mfma_f32_16x16x32_bf16 v[240:243], v[144:147], v[140:143], v[240:243]
    ds_read_b64_tr_b16 v[184:185], v104 offset:8192
    v_mfma_f32_16x16x32_bf16 v[244:247], v[148:151], v[140:143], v[244:247]
    ds_read_b64_tr_b16 v[186:187], v104 offset:9216
    s_waitcnt lgkmcnt(10)
    v_mfma_f32_16x16x32_bf16 v[120:123], v[116:119], v[64:67], v[120:123]
    ds_read_b64_tr_b16 v[188:189], v105 offset:8192
    v_mfma_f32_16x16x32_bf16 v[124:127], v[116:119], v[68:71], v[124:127]
    ds_read_b64_tr_b16 v[190:191], v105 offset:9216
    v_mfma_f32_16x16x32_bf16 v[200:203], v[152:155], v[128:131], v[200:203]
    v_mfma_f32_16x16x32_bf16 v[216:219], v[152:155], v[132:135], v[216:219]
    v_mfma_f32_16x16x32_bf16 v[232:235], v[152:155], v[136:139], v[232:235]
    v_mfma_f32_16x16x32_bf16 v[248:251], v[152:155], v[140:143], v[248:251]
    v_mfma_f32_16x16x32_bf16 v[204:207], v[156:159], v[128:131], v[204:207]
    v_mfma_f32_16x16x32_bf16 v[220:223], v[156:159], v[132:135], v[220:223]
    v_mfma_f32_16x16x32_bf16 v[236:239], v[156:159], v[136:139], v[236:239]
    v_mfma_f32_16x16x32_bf16 v[252:255], v[156:159], v[140:143], v[252:255]
    s_mov_b64 exec, 0xffff
    ds_write_b32 v110, v120
    ds_write_b32 v110, v124 offset:64
    s_mov_b64 exec, -1
    s_waitcnt lgkmcnt(9)
    v_mfma_f32_16x16x32_bf16 v[192:195], v[176:179], v[160:163], v[192:195]
    v_mfma_f32_16x16x32_bf16 v[196:199], v[180:183], v[160:163], v[196:199]
    s_waitcnt lgkmcnt(0)
    s_barrier
    v_mfma_f32_16x16x32_bf16 v[208:211], v[176:179], v[164:167], v[208:211]
    ds_read_b128 v[24:27], v111 offset:0
    v_mfma_f32_16x16x32_bf16 v[212:215], v[180:183], v[164:167], v[212:215]
    ds_read_b128 v[28:31], v111 offset:64
    v_mfma_f32_16x16x32_bf16 v[224:227], v[176:179], v[168:171], v[224:227]
    ds_read_b128 v[32:35], v114 offset:0
    v_mfma_f32_16x16x32_bf16 v[228:231], v[180:183], v[168:171], v[228:231]
    ds_read_b128 v[36:39], v114 offset:64
    v_mfma_f32_16x16x32_bf16 v[240:243], v[176:179], v[172:175], v[240:243]
    ds_read2_b32 v[40:41], v115 offset0:0 offset1:128
    v_mfma_f32_16x16x32_bf16 v[244:247], v[180:183], v[172:175], v[244:247]
    ds_read2_b32 v[42:43], v115 offset0:16 offset1:144
    v_mfma_f32_16x16x32_bf16 v[200:203], v[184:187], v[160:163], v[200:203]
    ds_read2_b32 v[44:45], v115 offset0:32 offset1:160
    v_mfma_f32_16x16x32_bf16 v[204:207], v[188:191], v[160:163], v[204:207]
    ds_read2_b32 v[46:47], v115 offset0:48 offset1:176
    v_mfma_f32_16x16x32_bf16 v[216:219], v[184:187], v[164:167], v[216:219]
    v_mfma_f32_16x16x32_bf16 v[220:223], v[188:191], v[164:167], v[220:223]
    v_mfma_f32_16x16x32_bf16 v[232:235], v[184:187], v[168:171], v[232:235]
    v_mfma_f32_16x16x32_bf16 v[236:239], v[188:191], v[168:171], v[236:239]
    v_mfma_f32_16x16x32_bf16 v[248:251], v[184:187], v[172:175], v[248:251]
    v_mfma_f32_16x16x32_bf16 v[252:255], v[188:191], v[172:175], v[252:255]
    s_waitcnt lgkmcnt(3)
    v_mul_f32 v48, s36, v41
    v_pk_fma_f32 v[192:193], v[24:25], v[40:41], v[192:193] op_sel_hi:[1,0,1] neg_lo:[1,0,0] neg_hi:[1,0,0]
    v_pk_fma_f32 v[194:195], v[26:27], v[40:41], v[194:195] op_sel_hi:[1,0,1] neg_lo:[1,0,0] neg_hi:[1,0,0]
    v_pk_fma_f32 v[196:197], v[28:29], v[40:41], v[196:197] op_sel_hi:[1,0,1] neg_lo:[1,0,0] neg_hi:[1,0,0]
    v_pk_fma_f32 v[198:199], v[30:31], v[40:41], v[198:199] op_sel_hi:[1,0,1] neg_lo:[1,0,0] neg_hi:[1,0,0]
    v_pk_mul_f32 v[192:193], v[192:193], v[48:49] op_sel_hi:[1,0]
    v_pk_mul_f32 v[194:195], v[194:195], v[48:49] op_sel_hi:[1,0]
    v_pk_mul_f32 v[196:197], v[196:197], v[48:49] op_sel_hi:[1,0]
    v_pk_mul_f32 v[198:199], v[198:199], v[48:49] op_sel_hi:[1,0]
    v_cvt_pk_bf16_f32 v128, v192, v193
    v_cvt_pk_bf16_f32 v129, v194, v195
    v_cvt_pk_bf16_f32 v130, v196, v197
    v_cvt_pk_bf16_f32 v131, v198, v199
    s_nop 0
    v_permlane16_swap_b32 v128, v130
    v_permlane16_swap_b32 v129, v131
    buffer_store_dwordx4 v[128:131], v106, s[16:19], s37 offen offset:0 sc1
    v_pk_fma_f32 v[200:201], v[32:33], v[40:41], v[200:201] op_sel_hi:[1,0,1] neg_lo:[1,0,0] neg_hi:[1,0,0]
    v_pk_fma_f32 v[202:203], v[34:35], v[40:41], v[202:203] op_sel_hi:[1,0,1] neg_lo:[1,0,0] neg_hi:[1,0,0]
    v_pk_fma_f32 v[204:205], v[36:37], v[40:41], v[204:205] op_sel_hi:[1,0,1] neg_lo:[1,0,0] neg_hi:[1,0,0]
    v_pk_fma_f32 v[206:207], v[38:39], v[40:41], v[206:207] op_sel_hi:[1,0,1] neg_lo:[1,0,0] neg_hi:[1,0,0]
    v_pk_mul_f32 v[200:201], v[200:201], v[48:49] op_sel_hi:[1,0]
    v_pk_mul_f32 v[202:203], v[202:203], v[48:49] op_sel_hi:[1,0]
    v_pk_mul_f32 v[204:205], v[204:205], v[48:49] op_sel_hi:[1,0]
    v_pk_mul_f32 v[206:207], v[206:207], v[48:49] op_sel_hi:[1,0]
    v_cvt_pk_bf16_f32 v132, v200, v201
    v_cvt_pk_bf16_f32 v133, v202, v203
    v_cvt_pk_bf16_f32 v134, v204, v205
    v_cvt_pk_bf16_f32 v135, v206, v207
    s_nop 0
    v_permlane16_swap_b32 v132, v134
    v_permlane16_swap_b32 v133, v135
    buffer_store_dwordx4 v[132:135], v107, s[16:19], s37 offen offset:0 sc1
    s_waitcnt lgkmcnt(2)
    v_mul_f32 v50, s36, v43
    v_pk_fma_f32 v[208:209], v[24:25], v[42:43], v[208:209] op_sel_hi:[1,0,1] neg_lo:[1,0,0] neg_hi:[1,0,0]
    v_pk_fma_f32 v[210:211], v[26:27], v[42:43], v[210:211] op_sel_hi:[1,0,1] neg_lo:[1,0,0] neg_hi:[1,0,0]
    v_pk_fma_f32 v[212:213], v[28:29], v[42:43], v[212:213] op_sel_hi:[1,0,1] neg_lo:[1,0,0] neg_hi:[1,0,0]
    v_pk_fma_f32 v[214:215], v[30:31], v[42:43], v[214:215] op_sel_hi:[1,0,1] neg_lo:[1,0,0] neg_hi:[1,0,0]
    v_pk_mul_f32 v[208:209], v[208:209], v[50:51] op_sel_hi:[1,0]
    v_pk_mul_f32 v[210:211], v[210:211], v[50:51] op_sel_hi:[1,0]
    v_pk_mul_f32 v[212:213], v[212:213], v[50:51] op_sel_hi:[1,0]
    v_pk_mul_f32 v[214:215], v[214:215], v[50:51] op_sel_hi:[1,0]
    v_cvt_pk_bf16_f32 v136, v208, v209
    v_cvt_pk_bf16_f32 v137, v210, v211
    v_cvt_pk_bf16_f32 v138, v212, v213
    v_cvt_pk_bf16_f32 v139, v214, v215
    s_nop 0
    v_permlane16_swap_b32 v136, v138
    v_permlane16_swap_b32 v137, v139
    buffer_store_dwordx4 v[136:139], v106, s[16:19], s37 offen offset:256 sc1
    v_pk_fma_f32 v[216:217], v[32:33], v[42:43], v[216:217] op_sel_hi:[1,0,1] neg_lo:[1,0,0] neg_hi:[1,0,0]
    v_pk_fma_f32 v[218:219], v[34:35], v[42:43], v[218:219] op_sel_hi:[1,0,1] neg_lo:[1,0,0] neg_hi:[1,0,0]
    v_pk_fma_f32 v[220:221], v[36:37], v[42:43], v[220:221] op_sel_hi:[1,0,1] neg_lo:[1,0,0] neg_hi:[1,0,0]
    v_pk_fma_f32 v[222:223], v[38:39], v[42:43], v[222:223] op_sel_hi:[1,0,1] neg_lo:[1,0,0] neg_hi:[1,0,0]
    v_pk_mul_f32 v[216:217], v[216:217], v[50:51] op_sel_hi:[1,0]
    v_pk_mul_f32 v[218:219], v[218:219], v[50:51] op_sel_hi:[1,0]
    v_pk_mul_f32 v[220:221], v[220:221], v[50:51] op_sel_hi:[1,0]
    v_pk_mul_f32 v[222:223], v[222:223], v[50:51] op_sel_hi:[1,0]
    v_cvt_pk_bf16_f32 v140, v216, v217
    v_cvt_pk_bf16_f32 v141, v218, v219
    v_cvt_pk_bf16_f32 v142, v220, v221
    v_cvt_pk_bf16_f32 v143, v222, v223
    s_nop 0
    v_permlane16_swap_b32 v140, v142
    v_permlane16_swap_b32 v141, v143
    buffer_store_dwordx4 v[140:143], v107, s[16:19], s37 offen offset:256 sc1
    s_waitcnt lgkmcnt(1)
    v_mul_f32 v52, s36, v45
    v_pk_fma_f32 v[224:225], v[24:25], v[44:45], v[224:225] op_sel_hi:[1,0,1] neg_lo:[1,0,0] neg_hi:[1,0,0]
    v_pk_fma_f32 v[226:227], v[26:27], v[44:45], v[226:227] op_sel_hi:[1,0,1] neg_lo:[1,0,0] neg_hi:[1,0,0]
    v_pk_fma_f32 v[228:229], v[28:29], v[44:45], v[228:229] op_sel_hi:[1,0,1] neg_lo:[1,0,0] neg_hi:[1,0,0]
    v_pk_fma_f32 v[230:231], v[30:31], v[44:45], v[230:231] op_sel_hi:[1,0,1] neg_lo:[1,0,0] neg_hi:[1,0,0]
    v_pk_mul_f32 v[224:225], v[224:225], v[52:53] op_sel_hi:[1,0]
    v_pk_mul_f32 v[226:227], v[226:227], v[52:53] op_sel_hi:[1,0]
    v_pk_mul_f32 v[228:229], v[228:229], v[52:53] op_sel_hi:[1,0]
    v_pk_mul_f32 v[230:231], v[230:231], v[52:53] op_sel_hi:[1,0]
    v_cvt_pk_bf16_f32 v144, v224, v225
    v_cvt_pk_bf16_f32 v145, v226, v227
    v_cvt_pk_bf16_f32 v146, v228, v229
    v_cvt_pk_bf16_f32 v147, v230, v231
    s_nop 0
    v_permlane16_swap_b32 v144, v146
    v_permlane16_swap_b32 v145, v147
    buffer_store_dwordx4 v[144:147], v106, s[16:19], s37 offen offset:2560 sc1
    v_pk_fma_f32 v[232:233], v[32:33], v[44:45], v[232:233] op_sel_hi:[1,0,1] neg_lo:[1,0,0] neg_hi:[1,0,0]
    v_pk_fma_f32 v[234:235], v[34:35], v[44:45], v[234:235] op_sel_hi:[1,0,1] neg_lo:[1,0,0] neg_hi:[1,0,0]
    v_pk_fma_f32 v[236:237], v[36:37], v[44:45], v[236:237] op_sel_hi:[1,0,1] neg_lo:[1,0,0] neg_hi:[1,0,0]
    v_pk_fma_f32 v[238:239], v[38:39], v[44:45], v[238:239] op_sel_hi:[1,0,1] neg_lo:[1,0,0] neg_hi:[1,0,0]
    v_pk_mul_f32 v[232:233], v[232:233], v[52:53] op_sel_hi:[1,0]
    v_pk_mul_f32 v[234:235], v[234:235], v[52:53] op_sel_hi:[1,0]
    v_pk_mul_f32 v[236:237], v[236:237], v[52:53] op_sel_hi:[1,0]
    v_pk_mul_f32 v[238:239], v[238:239], v[52:53] op_sel_hi:[1,0]
    v_cvt_pk_bf16_f32 v148, v232, v233
    v_cvt_pk_bf16_f32 v149, v234, v235
    v_cvt_pk_bf16_f32 v150, v236, v237
    v_cvt_pk_bf16_f32 v151, v238, v239
    s_nop 0
    v_permlane16_swap_b32 v148, v150
    v_permlane16_swap_b32 v149, v151
    buffer_store_dwordx4 v[148:151], v107, s[16:19], s37 offen offset:2560 sc1
    s_waitcnt lgkmcnt(0)
    v_mul_f32 v54, s36, v47
    v_pk_fma_f32 v[240:241], v[24:25], v[46:47], v[240:241] op_sel_hi:[1,0,1] neg_lo:[1,0,0] neg_hi:[1,0,0]
    v_pk_fma_f32 v[242:243], v[26:27], v[46:47], v[242:243] op_sel_hi:[1,0,1] neg_lo:[1,0,0] neg_hi:[1,0,0]
    v_pk_fma_f32 v[244:245], v[28:29], v[46:47], v[244:245] op_sel_hi:[1,0,1] neg_lo:[1,0,0] neg_hi:[1,0,0]
    v_pk_fma_f32 v[246:247], v[30:31], v[46:47], v[246:247] op_sel_hi:[1,0,1] neg_lo:[1,0,0] neg_hi:[1,0,0]
    v_pk_mul_f32 v[240:241], v[240:241], v[54:55] op_sel_hi:[1,0]
    v_pk_mul_f32 v[242:243], v[242:243], v[54:55] op_sel_hi:[1,0]
    v_pk_mul_f32 v[244:245], v[244:245], v[54:55] op_sel_hi:[1,0]
    v_pk_mul_f32 v[246:247], v[246:247], v[54:55] op_sel_hi:[1,0]
    v_cvt_pk_bf16_f32 v152, v240, v241
    v_cvt_pk_bf16_f32 v153, v242, v243
    v_cvt_pk_bf16_f32 v154, v244, v245
    v_cvt_pk_bf16_f32 v155, v246, v247
    s_nop 0
    v_permlane16_swap_b32 v152, v154
    v_permlane16_swap_b32 v153, v155
    buffer_store_dwordx4 v[152:155], v106, s[16:19], s37 offen offset:2816 sc1
    v_pk_fma_f32 v[248:249], v[32:33], v[46:47], v[248:249] op_sel_hi:[1,0,1] neg_lo:[1,0,0] neg_hi:[1,0,0]
    v_pk_fma_f32 v[250:251], v[34:35], v[46:47], v[250:251] op_sel_hi:[1,0,1] neg_lo:[1,0,0] neg_hi:[1,0,0]
    v_pk_fma_f32 v[252:253], v[36:37], v[46:47], v[252:253] op_sel_hi:[1,0,1] neg_lo:[1,0,0] neg_hi:[1,0,0]
    v_pk_fma_f32 v[254:255], v[38:39], v[46:47], v[254:255] op_sel_hi:[1,0,1] neg_lo:[1,0,0] neg_hi:[1,0,0]
    v_pk_mul_f32 v[248:249], v[248:249], v[54:55] op_sel_hi:[1,0]
    v_pk_mul_f32 v[250:251], v[250:251], v[54:55] op_sel_hi:[1,0]
    v_pk_mul_f32 v[252:253], v[252:253], v[54:55] op_sel_hi:[1,0]
    v_pk_mul_f32 v[254:255], v[254:255], v[54:55] op_sel_hi:[1,0]
    v_cvt_pk_bf16_f32 v156, v248, v249
    v_cvt_pk_bf16_f32 v157, v250, v251
    v_cvt_pk_bf16_f32 v158, v252, v253
    v_cvt_pk_bf16_f32 v159, v254, v255
    s_nop 0
    v_permlane16_swap_b32 v156, v158
    v_permlane16_swap_b32 v157, v159
    buffer_store_dwordx4 v[156:159], v107, s[16:19], s37 offen offset:2816 sc1
    s_branch L_HOP
L_A1_1:
    s_waitcnt lgkmcnt(10)
    v_mfma_f32_16x16x32_bf16 v[120:123], v[116:119], v[144:147], 0
    ds_read_b64_tr_b16 v[176:177], v90 offset:8192
    s_waitcnt lgkmcnt(9)
    v_mfma_f32_16x16x32_bf16 v[124:127], v[116:119], v[148:151], 0
    ds_read_b64_tr_b16 v[178:179], v90 offset:9216
    s_waitcnt lgkmcnt(9)
    v_mfma_f32_16x16x32_bf16 v[192:195], v[128:131], v[144:147], 0
    ds_read_b64_tr_b16 v[180:181], v91 offset:8192
    v_mfma_f32_16x16x32_bf16 v[196:199], v[128:131], v[148:151], 0
    ds_read_b64_tr_b16 v[182:183], v91 offset:9216
    s_waitcnt lgkmcnt(10)
    v_mfma_f32_16x16x32_bf16 v[208:211], v[132:135], v[144:147], 0
    ds_read_b128 v[160:163], v89 offset:0
    v_mfma_f32_16x16x32_bf16 v[212:215], v[132:135], v[148:151], 0
    ds_read_b128 v[164:167], v89 offset:2048
    s_waitcnt lgkmcnt(11)
    v_mfma_f32_16x16x32_bf16 v[224:227], v[136:139], v[144:147], 0
    ds_read_b128 v[168:171], v89 offset:4096
    v_mfma_f32_16x16x32_bf16 v[228:231], v[136:139], v[148:151], 0
    ds_read_b128 v[172:175], v89 offset:6144
    s_waitcnt lgkmcnt(12)
    v_mfma_f32_16x16x32_bf16 v[240:243], v[140:143], v[144:147], 0
    ds_read_b64_tr_b16 v[184:185], v92 offset:8192
    v_mfma_f32_16x16x32_bf16 v[244:247], v[140:143], v[148:151], 0
    ds_read_b64_tr_b16 v[186:187], v92 offset:9216
    s_waitcnt lgkmcnt(12)
    v_mfma_f32_16x16x32_bf16 v[200:203], v[128:131], v[152:155], 0
    ds_read_b64_tr_b16 v[188:189], v93 offset:8192
    v_mfma_f32_16x16x32_bf16 v[216:219], v[132:135], v[152:155], 0
    ds_read_b64_tr_b16 v[190:191], v93 offset:9216
    v_mfma_f32_16x16x32_bf16 v[232:235], v[136:139], v[152:155], 0
    v_mfma_f32_16x16x32_bf16 v[248:251], v[140:143], v[152:155], 0
    s_waitcnt lgkmcnt(12)
    v_mfma_f32_16x16x32_bf16 v[204:207], v[128:131], v[156:159], 0
    v_mfma_f32_16x16x32_bf16 v[220:223], v[132:135], v[156:159], 0
    v_mfma_f32_16x16x32_bf16 v[236:239], v[136:139], v[156:159], 0
    v_mfma_f32_16x16x32_bf16 v[252:255], v[140:143], v[156:159], 0
    s_cmp_lg_u32 s20, 0
    s_cbranch_scc1 L_NOSIGC1
    s_and_b32 s3, s2, 31
    s_lshl_b32 s3, s3, 2
    s_add_u32 s3, s3, 128
    v_mov_b32 v4, s3
    v_mov_b32 v5, 1
    s_lshl_b32 s3, s60, 2
    v_mov_b32 v6, s3
    s_waitcnt vmcnt(0)
    s_mov_b64 exec, 1
    global_atomic_add v4, v5, s[82:83] sc1
    s_mov_b64 exec, -1
L_NOSIGC1:
    s_waitcnt lgkmcnt(10)
    v_mfma_f32_16x16x32_bf16 v[120:123], v[116:119], v[176:179], v[120:123]
    s_waitcnt lgkmcnt(8)
    v_mfma_f32_16x16x32_bf16 v[124:127], v[116:119], v[180:183], v[124:127]
    s_barrier
    s_waitcnt lgkmcnt(7)
    v_mfma_f32_16x16x32_bf16 v[192:195], v[160:163], v[176:179], v[192:195]
    ds_read_b64_tr_b16 v[144:145], v90 offset:32768
    v_mfma_f32_16x16x32_bf16 v[196:199], v[160:163], v[180:183], v[196:199]
    ds_read_b64_tr_b16 v[146:147], v90 offset:33792
    s_waitcnt lgkmcnt(8)
    v_mfma_f32_16x16x32_bf16 v[208:211], v[164:167], v[176:179], v[208:211]
    ds_read_b64_tr_b16 v[148:149], v91 offset:32768
    v_mfma_f32_16x16x32_bf16 v[212:215], v[164:167], v[180:183], v[212:215]
    ds_read_b64_tr_b16 v[150:151], v91 offset:33792
    s_waitcnt lgkmcnt(9)
    v_mfma_f32_16x16x32_bf16 v[224:227], v[168:171], v[176:179], v[224:227]
    ds_read_b128 v[128:131], v88 offset:32768
    v_mfma_f32_16x16x32_bf16 v[228:231], v[168:171], v[180:183], v[228:231]
    ds_read_b128 v[132:135], v88 offset:34816
    s_waitcnt lgkmcnt(10)
    v_mfma_f32_16x16x32_bf16 v[240:243], v[172:175], v[176:179], v[240:243]
    ds_read_b128 v[136:139], v88 offset:36864
    v_mfma_f32_16x16x32_bf16 v[244:247], v[172:175], v[180:183], v[244:247]
    ds_read_b128 v[140:143], v88 offset:38912
    s_waitcnt lgkmcnt(10)
    v_mfma_f32_16x16x32_bf16 v[200:203], v[160:163], v[184:187], v[200:203]
    ds_read_b64_tr_b16 v[152:153], v92 offset:32768
    v_mfma_f32_16x16x32_bf16 v[216:219], v[164:167], v[184:187], v[216:219]
    ds_read_b64_tr_b16 v[154:155], v92 offset:33792
    v_mfma_f32_16x16x32_bf16 v[232:235], v[168:171], v[184:187], v[232:235]
    ds_read_b64_tr_b16 v[156:157], v93 offset:32768
    v_mfma_f32_16x16x32_bf16 v[248:251], v[172:175], v[184:187], v[248:251]
    ds_read_b64_tr_b16 v[158:159], v93 offset:33792
    s_waitcnt lgkmcnt(12)
    v_mfma_f32_16x16x32_bf16 v[204:207], v[160:163], v[188:191], v[204:207]
    v_mfma_f32_16x16x32_bf16 v[220:223], v[164:167], v[188:191], v[220:223]
    v_mfma_f32_16x16x32_bf16 v[236:239], v[168:171], v[188:191], v[236:239]
    v_mfma_f32_16x16x32_bf16 v[252:255], v[172:175], v[188:191], v[252:255]
    s_waitcnt lgkmcnt(10)
    v_mfma_f32_16x16x32_bf16 v[120:123], v[116:119], v[144:147], v[120:123]
    ds_read_b64_tr_b16 v[176:177], v90 offset:40960
    s_waitcnt lgkmcnt(9)
    v_mfma_f32_16x16x32_bf16 v[124:127], v[116:119], v[148:151], v[124:127]
    ds_read_b64_tr_b16 v[178:179], v90 offset:41984
    s_waitcnt lgkmcnt(9)
    v_mfma_f32_16x16x32_bf16 v[192:195], v[128:131], v[144:147], v[192:195]
    ds_read_b64_tr_b16 v[180:181], v91 offset:40960
    v_mfma_f32_16x16x32_bf16 v[196:199], v[128:131], v[148:151], v[196:199]
    ds_read_b64_tr_b16 v[182:183], v91 offset:41984
    s_waitcnt lgkmcnt(10)
    v_mfma_f32_16x16x32_bf16 v[208:211], v[132:135], v[144:147], v[208:211]
    ds_read_b128 v[160:163], v89 offset:32768
    v_mfma_f32_16x16x32_bf16 v[212:215], v[132:135], v[148:151], v[212:215]
    ds_read_b128 v[164:167], v89 offset:34816
    s_waitcnt lgkmcnt(11)
    v_mfma_f32_16x16x32_bf16 v[224:227], v[136:139], v[144:147], v[224:227]
    ds_read_b128 v[168:171], v89 offset:36864
    v_mfma_f32_16x16x32_bf16 v[228:231], v[136:139], v[148:151], v[228:231]
    ds_read_b128 v[172:175], v89 offset:38912
    s_waitcnt lgkmcnt(12)
    v_mfma_f32_16x16x32_bf16 v[240:243], v[140:143], v[144:147], v[240:243]
    ds_read_b64_tr_b16 v[184:185], v92 offset:40960
    v_mfma_f32_16x16x32_bf16 v[244:247], v[140:143], v[148:151], v[244:247]
    ds_read_b64_tr_b16 v[186:187], v92 offset:41984
    s_waitcnt lgkmcnt(12)
    v_mfma_f32_16x16x32_bf16 v[200:203], v[128:131], v[152:155], v[200:203]
    ds_read_b64_tr_b16 v[188:189], v93 offset:40960
    v_mfma_f32_16x16x32_bf16 v[216:219], v[132:135], v[152:155], v[216:219]
    ds_read_b64_tr_b16 v[190:191], v93 offset:41984
    v_mfma_f32_16x16x32_bf16 v[232:235], v[136:139], v[152:155], v[232:235]
    v_mfma_f32_16x16x32_bf16 v[248:251], v[140:143], v[152:155], v[248:251]
    s_waitcnt lgkmcnt(12)
    v_mfma_f32_16x16x32_bf16 v[204:207], v[128:131], v[156:159], v[204:207]
    v_mfma_f32_16x16x32_bf16 v[220:223], v[132:135], v[156:159], v[220:223]
    v_mfma_f32_16x16x32_bf16 v[236:239], v[136:139], v[156:159], v[236:239]
    v_mfma_f32_16x16x32_bf16 v[252:255], v[140:143], v[156:159], v[252:255]
    s_waitcnt lgkmcnt(10)
    v_mfma_f32_16x16x32_bf16 v[120:123], v[116:119], v[176:179], v[120:123]
    s_waitcnt lgkmcnt(8)
    v_mfma_f32_16x16x32_bf16 v[124:127], v[116:119], v[180:183], v[124:127]
    s_barrier
    s_waitcnt lgkmcnt(7)
    v_mfma_f32_16x16x32_bf16 v[192:195], v[160:163], v[176:179], v[192:195]
    ds_read_b64_tr_b16 v[144:145], v96 offset:0
    v_mfma_f32_16x16x32_bf16 v[196:199], v[160:163], v[180:183], v[196:199]
    ds_read_b64_tr_b16 v[146:147], v96 offset:1024
    s_waitcnt lgkmcnt(8)
    v_mfma_f32_16x16x32_bf16 v[208:211], v[164:167], v[176:179], v[208:211]
    ds_read_b64_tr_b16 v[148:149], v97 offset:0
    v_mfma_f32_16x16x32_bf16 v[212:215], v[164:167], v[180:183], v[212:215]
    ds_read_b64_tr_b16 v[150:151], v97 offset:1024
    s_waitcnt lgkmcnt(9)
    v_mfma_f32_16x16x32_bf16 v[224:227], v[168:171], v[176:179], v[224:227]
    ds_read_b128 v[128:131], v94 offset:0
    v_mfma_f32_16x16x32_bf16 v[228:231], v[168:171], v[180:183], v[228:231]
    ds_read_b128 v[132:135], v94 offset:2048
    s_waitcnt lgkmcnt(10)
    v_mfma_f32_16x16x32_bf16 v[240:243], v[172:175], v[176:179], v[240:243]
    ds_read_b128 v[136:139], v94 offset:4096
    v_mfma_f32_16x16x32_bf16 v[244:247], v[172:175], v[180:183], v[244:247]
    ds_read_b128 v[140:143], v94 offset:6144
    s_waitcnt lgkmcnt(10)
    v_mfma_f32_16x16x32_bf16 v[200:203], v[160:163], v[184:187], v[200:203]
    ds_read_b64_tr_b16 v[152:153], v98 offset:0
    v_mfma_f32_16x16x32_bf16 v[216:219], v[164:167], v[184:187], v[216:219]
    ds_read_b64_tr_b16 v[154:155], v98 offset:1024
    v_mfma_f32_16x16x32_bf16 v[232:235], v[168:171], v[184:187], v[232:235]
    ds_read_b64_tr_b16 v[156:157], v99 offset:0
    v_mfma_f32_16x16x32_bf16 v[248:251], v[172:175], v[184:187], v[248:251]
    ds_read_b64_tr_b16 v[158:159], v99 offset:1024
    s_waitcnt lgkmcnt(12)
    v_mfma_f32_16x16x32_bf16 v[204:207], v[160:163], v[188:191], v[204:207]
    v_mfma_f32_16x16x32_bf16 v[220:223], v[164:167], v[188:191], v[220:223]
    v_mfma_f32_16x16x32_bf16 v[236:239], v[168:171], v[188:191], v[236:239]
    v_mfma_f32_16x16x32_bf16 v[252:255], v[172:175], v[188:191], v[252:255]
    s_waitcnt lgkmcnt(10)
    v_mfma_f32_16x16x32_bf16 v[120:123], v[116:119], v[144:147], v[120:123]
    ds_read_b64_tr_b16 v[176:177], v96 offset:8192
    s_waitcnt lgkmcnt(9)
    v_mfma_f32_16x16x32_bf16 v[124:127], v[116:119], v[148:151], v[124:127]
    ds_read_b64_tr_b16 v[178:179], v96 offset:9216
    s_waitcnt lgkmcnt(9)
    v_mfma_f32_16x16x32_bf16 v[192:195], v[128:131], v[144:147], v[192:195]
    ds_read_b64_tr_b16 v[180:181], v97 offset:8192
    v_mfma_f32_16x16x32_bf16 v[196:199], v[128:131], v[148:151], v[196:199]
    ds_read_b64_tr_b16 v[182:183], v97 offset:9216
    s_waitcnt lgkmcnt(10)
    v_mfma_f32_16x16x32_bf16 v[208:211], v[132:135], v[144:147], v[208:211]
    ds_read_b128 v[160:163], v95 offset:0
    v_mfma_f32_16x16x32_bf16 v[212:215], v[132:135], v[148:151], v[212:215]
    ds_read_b128 v[164:167], v95 offset:2048
    s_waitcnt lgkmcnt(11)
    v_mfma_f32_16x16x32_bf16 v[224:227], v[136:139], v[144:147], v[224:227]
    ds_read_b128 v[168:171], v95 offset:4096
    v_mfma_f32_16x16x32_bf16 v[228:231], v[136:139], v[148:151], v[228:231]
    ds_read_b128 v[172:175], v95 offset:6144
    s_waitcnt lgkmcnt(12)
    v_mfma_f32_16x16x32_bf16 v[240:243], v[140:143], v[144:147], v[240:243]
    ds_read_b64_tr_b16 v[184:185], v98 offset:8192
    v_mfma_f32_16x16x32_bf16 v[244:247], v[140:143], v[148:151], v[244:247]
    ds_read_b64_tr_b16 v[186:187], v98 offset:9216
    s_waitcnt lgkmcnt(12)
    v_mfma_f32_16x16x32_bf16 v[200:203], v[128:131], v[152:155], v[200:203]
    ds_read_b64_tr_b16 v[188:189], v99 offset:8192
    v_mfma_f32_16x16x32_bf16 v[216:219], v[132:135], v[152:155], v[216:219]
    ds_read_b64_tr_b16 v[190:191], v99 offset:9216
    v_mfma_f32_16x16x32_bf16 v[232:235], v[136:139], v[152:155], v[232:235]
    v_mfma_f32_16x16x32_bf16 v[248:251], v[140:143], v[152:155], v[248:251]
    s_waitcnt lgkmcnt(12)
    v_mfma_f32_16x16x32_bf16 v[204:207], v[128:131], v[156:159], v[204:207]
    v_mfma_f32_16x16x32_bf16 v[220:223], v[132:135], v[156:159], v[220:223]
    v_mfma_f32_16x16x32_bf16 v[236:239], v[136:139], v[156:159], v[236:239]
    v_mfma_f32_16x16x32_bf16 v[252:255], v[140:143], v[156:159], v[252:255]
    s_waitcnt lgkmcnt(10)
    v_mfma_f32_16x16x32_bf16 v[120:123], v[116:119], v[176:179], v[120:123]
    s_waitcnt lgkmcnt(8)
    v_mfma_f32_16x16x32_bf16 v[124:127], v[116:119], v[180:183], v[124:127]
    s_barrier
    s_waitcnt lgkmcnt(7)
    v_mfma_f32_16x16x32_bf16 v[192:195], v[160:163], v[176:179], v[192:195]
    ds_read_b64_tr_b16 v[144:145], v96 offset:32768
    v_mfma_f32_16x16x32_bf16 v[196:199], v[160:163], v[180:183], v[196:199]
    ds_read_b64_tr_b16 v[146:147], v96 offset:33792
    s_waitcnt lgkmcnt(8)
    v_mfma_f32_16x16x32_bf16 v[208:211], v[164:167], v[176:179], v[208:211]
    ds_read_b64_tr_b16 v[148:149], v97 offset:32768
    v_mfma_f32_16x16x32_bf16 v[212:215], v[164:167], v[180:183], v[212:215]
    ds_read_b64_tr_b16 v[150:151], v97 offset:33792
    s_waitcnt lgkmcnt(9)
    v_mfma_f32_16x16x32_bf16 v[224:227], v[168:171], v[176:179], v[224:227]
    ds_read_b128 v[128:131], v94 offset:32768
    v_mfma_f32_16x16x32_bf16 v[228:231], v[168:171], v[180:183], v[228:231]
    ds_read_b128 v[132:135], v94 offset:34816
    s_waitcnt lgkmcnt(10)
    v_mfma_f32_16x16x32_bf16 v[240:243], v[172:175], v[176:179], v[240:243]
    ds_read_b128 v[136:139], v94 offset:36864
    v_mfma_f32_16x16x32_bf16 v[244:247], v[172:175], v[180:183], v[244:247]
    ds_read_b128 v[140:143], v94 offset:38912
    s_waitcnt lgkmcnt(10)
    v_mfma_f32_16x16x32_bf16 v[200:203], v[160:163], v[184:187], v[200:203]
    ds_read_b64_tr_b16 v[152:153], v98 offset:32768
    v_mfma_f32_16x16x32_bf16 v[216:219], v[164:167], v[184:187], v[216:219]
    ds_read_b64_tr_b16 v[154:155], v98 offset:33792
    v_mfma_f32_16x16x32_bf16 v[232:235], v[168:171], v[184:187], v[232:235]
    ds_read_b64_tr_b16 v[156:157], v99 offset:32768
    v_mfma_f32_16x16x32_bf16 v[248:251], v[172:175], v[184:187], v[248:251]
    ds_read_b64_tr_b16 v[158:159], v99 offset:33792
    s_waitcnt lgkmcnt(12)
    v_mfma_f32_16x16x32_bf16 v[204:207], v[160:163], v[188:191], v[204:207]
    v_mfma_f32_16x16x32_bf16 v[220:223], v[164:167], v[188:191], v[220:223]
    v_mfma_f32_16x16x32_bf16 v[236:239], v[168:171], v[188:191], v[236:239]
    v_mfma_f32_16x16x32_bf16 v[252:255], v[172:175], v[188:191], v[252:255]
    s_waitcnt lgkmcnt(10)
    v_mfma_f32_16x16x32_bf16 v[120:123], v[116:119], v[144:147], v[120:123]
    ds_read_b64_tr_b16 v[176:177], v96 offset:40960
    s_waitcnt lgkmcnt(9)
    v_mfma_f32_16x16x32_bf16 v[124:127], v[116:119], v[148:151], v[124:127]
    ds_read_b64_tr_b16 v[178:179], v96 offset:41984
    s_waitcnt lgkmcnt(9)
    v_mfma_f32_16x16x32_bf16 v[192:195], v[128:131], v[144:147], v[192:195]
    ds_read_b64_tr_b16 v[180:181], v97 offset:40960
    v_mfma_f32_16x16x32_bf16 v[196:199], v[128:131], v[148:151], v[196:199]
    ds_read_b64_tr_b16 v[182:183], v97 offset:41984
    s_waitcnt lgkmcnt(10)
    v_mfma_f32_16x16x32_bf16 v[208:211], v[132:135], v[144:147], v[208:211]
    ds_read_b128 v[160:163], v95 offset:32768
    v_mfma_f32_16x16x32_bf16 v[212:215], v[132:135], v[148:151], v[212:215]
    ds_read_b128 v[164:167], v95 offset:34816
    s_waitcnt lgkmcnt(11)
    v_mfma_f32_16x16x32_bf16 v[224:227], v[136:139], v[144:147], v[224:227]
    ds_read_b128 v[168:171], v95 offset:36864
    v_mfma_f32_16x16x32_bf16 v[228:231], v[136:139], v[148:151], v[228:231]
    ds_read_b128 v[172:175], v95 offset:38912
    s_waitcnt lgkmcnt(12)
    v_mfma_f32_16x16x32_bf16 v[240:243], v[140:143], v[144:147], v[240:243]
    ds_read_b64_tr_b16 v[184:185], v98 offset:40960
    v_mfma_f32_16x16x32_bf16 v[244:247], v[140:143], v[148:151], v[244:247]
    ds_read_b64_tr_b16 v[186:187], v98 offset:41984
    s_waitcnt lgkmcnt(12)
    v_mfma_f32_16x16x32_bf16 v[200:203], v[128:131], v[152:155], v[200:203]
    ds_read_b64_tr_b16 v[188:189], v99 offset:40960
    v_mfma_f32_16x16x32_bf16 v[216:219], v[132:135], v[152:155], v[216:219]
    ds_read_b64_tr_b16 v[190:191], v99 offset:41984
    v_mfma_f32_16x16x32_bf16 v[232:235], v[136:139], v[152:155], v[232:235]
    v_mfma_f32_16x16x32_bf16 v[248:251], v[140:143], v[152:155], v[248:251]
    s_waitcnt lgkmcnt(12)
    v_mfma_f32_16x16x32_bf16 v[204:207], v[128:131], v[156:159], v[204:207]
    v_mfma_f32_16x16x32_bf16 v[220:223], v[132:135], v[156:159], v[220:223]
    v_mfma_f32_16x16x32_bf16 v[236:239], v[136:139], v[156:159], v[236:239]
    v_mfma_f32_16x16x32_bf16 v[252:255], v[140:143], v[156:159], v[252:255]
    s_waitcnt lgkmcnt(10)
    v_mfma_f32_16x16x32_bf16 v[120:123], v[116:119], v[176:179], v[120:123]
    s_waitcnt lgkmcnt(8)
    v_mfma_f32_16x16x32_bf16 v[124:127], v[116:119], v[180:183], v[124:127]
    s_barrier
    s_waitcnt lgkmcnt(7)
    v_mfma_f32_16x16x32_bf16 v[192:195], v[160:163], v[176:179], v[192:195]
    ds_read_b64_tr_b16 v[144:145], v102 offset:0
    v_mfma_f32_16x16x32_bf16 v[196:199], v[160:163], v[180:183], v[196:199]
    ds_read_b64_tr_b16 v[146:147], v102 offset:1024
    s_waitcnt lgkmcnt(8)
    v_mfma_f32_16x16x32_bf16 v[208:211], v[164:167], v[176:179], v[208:211]
    ds_read_b64_tr_b16 v[148:149], v103 offset:0
    v_mfma_f32_16x16x32_bf16 v[212:215], v[164:167], v[180:183], v[212:215]
    ds_read_b64_tr_b16 v[150:151], v103 offset:1024
    s_waitcnt lgkmcnt(9)
    v_mfma_f32_16x16x32_bf16 v[224:227], v[168:171], v[176:179], v[224:227]
    ds_read_b128 v[128:131], v100 offset:0
    v_mfma_f32_16x16x32_bf16 v[228:231], v[168:171], v[180:183], v[228:231]
    ds_read_b128 v[132:135], v100 offset:2048
    s_waitcnt lgkmcnt(10)
    v_mfma_f32_16x16x32_bf16 v[240:243], v[172:175], v[176:179], v[240:243]
    ds_read_b128 v[136:139], v100 offset:4096
    v_mfma_f32_16x16x32_bf16 v[244:247], v[172:175], v[180:183], v[244:247]
    ds_read_b128 v[140:143], v100 offset:6144
    s_waitcnt lgkmcnt(10)
    v_mfma_f32_16x16x32_bf16 v[200:203], v[160:163], v[184:187], v[200:203]
    ds_read_b64_tr_b16 v[152:153], v104 offset:0
    v_mfma_f32_16x16x32_bf16 v[216:219], v[164:167], v[184:187], v[216:219]
    ds_read_b64_tr_b16 v[154:155], v104 offset:1024
    v_mfma_f32_16x16x32_bf16 v[232:235], v[168:171], v[184:187], v[232:235]
    ds_read_b64_tr_b16 v[156:157], v105 offset:0
    v_mfma_f32_16x16x32_bf16 v[248:251], v[172:175], v[184:187], v[248:251]
    ds_read_b64_tr_b16 v[158:159], v105 offset:1024
    s_waitcnt lgkmcnt(12)
    v_mfma_f32_16x16x32_bf16 v[204:207], v[160:163], v[188:191], v[204:207]
    v_mfma_f32_16x16x32_bf16 v[220:223], v[164:167], v[188:191], v[220:223]
    v_mfma_f32_16x16x32_bf16 v[236:239], v[168:171], v[188:191], v[236:239]
    v_mfma_f32_16x16x32_bf16 v[252:255], v[172:175], v[188:191], v[252:255]
    s_waitcnt lgkmcnt(10)
    v_mfma_f32_16x16x32_bf16 v[120:123], v[116:119], v[144:147], v[120:123]
    ds_read_b64_tr_b16 v[176:177], v102 offset:8192
    s_waitcnt lgkmcnt(9)
    v_mfma_f32_16x16x32_bf16 v[124:127], v[116:119], v[148:151], v[124:127]
    ds_read_b64_tr_b16 v[178:179], v102 offset:9216
    s_waitcnt lgkmcnt(9)
    v_mfma_f32_16x16x32_bf16 v[192:195], v[128:131], v[144:147], v[192:195]
    ds_read_b64_tr_b16 v[180:181], v103 offset:8192
    v_mfma_f32_16x16x32_bf16 v[196:199], v[128:131], v[148:151], v[196:199]
    ds_read_b64_tr_b16 v[182:183], v103 offset:9216
    s_waitcnt lgkmcnt(10)
    v_mfma_f32_16x16x32_bf16 v[208:211], v[132:135], v[144:147], v[208:211]
    ds_read_b128 v[160:163], v101 offset:0
    v_mfma_f32_16x16x32_bf16 v[212:215], v[132:135], v[148:151], v[212:215]
    ds_read_b128 v[164:167], v101 offset:2048
    s_waitcnt lgkmcnt(11)
    v_mfma_f32_16x16x32_bf16 v[224:227], v[136:139], v[144:147], v[224:227]
    ds_read_b128 v[168:171], v101 offset:4096
    v_mfma_f32_16x16x32_bf16 v[228:231], v[136:139], v[148:151], v[228:231]
    ds_read_b128 v[172:175], v101 offset:6144
    s_waitcnt lgkmcnt(12)
    v_mfma_f32_16x16x32_bf16 v[240:243], v[140:143], v[144:147], v[240:243]
    ds_read_b64_tr_b16 v[184:185], v104 offset:8192
    v_mfma_f32_16x16x32_bf16 v[244:247], v[140:143], v[148:151], v[244:247]
    ds_read_b64_tr_b16 v[186:187], v104 offset:9216
    s_waitcnt lgkmcnt(12)
    v_mfma_f32_16x16x32_bf16 v[200:203], v[128:131], v[152:155], v[200:203]
    ds_read_b64_tr_b16 v[188:189], v105 offset:8192
    v_mfma_f32_16x16x32_bf16 v[216:219], v[132:135], v[152:155], v[216:219]
    ds_read_b64_tr_b16 v[190:191], v105 offset:9216
    v_mfma_f32_16x16x32_bf16 v[232:235], v[136:139], v[152:155], v[232:235]
    v_mfma_f32_16x16x32_bf16 v[248:251], v[140:143], v[152:155], v[248:251]
    s_waitcnt lgkmcnt(12)
    v_mfma_f32_16x16x32_bf16 v[204:207], v[128:131], v[156:159], v[204:207]
    v_mfma_f32_16x16x32_bf16 v[220:223], v[132:135], v[156:159], v[220:223]
    v_mfma_f32_16x16x32_bf16 v[236:239], v[136:139], v[156:159], v[236:239]
    v_mfma_f32_16x16x32_bf16 v[252:255], v[140:143], v[156:159], v[252:255]
    s_waitcnt lgkmcnt(10)
    v_mfma_f32_16x16x32_bf16 v[120:123], v[116:119], v[176:179], v[120:123]
    s_waitcnt lgkmcnt(8)
    v_mfma_f32_16x16x32_bf16 v[124:127], v[116:119], v[180:183], v[124:127]
    s_barrier
    s_waitcnt lgkmcnt(7)
    v_mfma_f32_16x16x32_bf16 v[192:195], v[160:163], v[176:179], v[192:195]
    ds_read_b64_tr_b16 v[144:145], v90 offset:0
    v_mfma_f32_16x16x32_bf16 v[196:199], v[160:163], v[180:183], v[196:199]
    ds_read_b64_tr_b16 v[146:147], v90 offset:1024
    s_waitcnt lgkmcnt(8)
    v_mfma_f32_16x16x32_bf16 v[208:211], v[164:167], v[176:179], v[208:211]
    ds_read_b64_tr_b16 v[148:149], v91 offset:0
    v_mfma_f32_16x16x32_bf16 v[212:215], v[164:167], v[180:183], v[212:215]
    ds_read_b64_tr_b16 v[150:151], v91 offset:1024
    s_waitcnt lgkmcnt(9)
    v_mfma_f32_16x16x32_bf16 v[224:227], v[168:171], v[176:179], v[224:227]
    ds_read_b128 v[128:131], v88 offset:0
    v_mfma_f32_16x16x32_bf16 v[228:231], v[168:171], v[180:183], v[228:231]
    ds_read_b128 v[132:135], v88 offset:2048
    s_waitcnt lgkmcnt(10)
    v_mfma_f32_16x16x32_bf16 v[240:243], v[172:175], v[176:179], v[240:243]
    ds_read_b128 v[136:139], v88 offset:4096
    v_mfma_f32_16x16x32_bf16 v[244:247], v[172:175], v[180:183], v[244:247]
    ds_read_b128 v[140:143], v88 offset:6144
    s_waitcnt lgkmcnt(10)
    v_mfma_f32_16x16x32_bf16 v[200:203], v[160:163], v[184:187], v[200:203]
    ds_read_b64_tr_b16 v[152:153], v92 offset:0
    v_mfma_f32_16x16x32_bf16 v[216:219], v[164:167], v[184:187], v[216:219]
    ds_read_b64_tr_b16 v[154:155], v92 offset:1024
    v_mfma_f32_16x16x32_bf16 v[232:235], v[168:171], v[184:187], v[232:235]
    ds_read_b64_tr_b16 v[156:157], v93 offset:0
    v_mfma_f32_16x16x32_bf16 v[248:251], v[172:175], v[184:187], v[248:251]
    ds_read_b64_tr_b16 v[158:159], v93 offset:1024
    s_waitcnt lgkmcnt(12)
    v_mfma_f32_16x16x32_bf16 v[204:207], v[160:163], v[188:191], v[204:207]
    v_mfma_f32_16x16x32_bf16 v[220:223], v[164:167], v[188:191], v[220:223]
    v_mfma_f32_16x16x32_bf16 v[236:239], v[168:171], v[188:191], v[236:239]
    v_mfma_f32_16x16x32_bf16 v[252:255], v[172:175], v[188:191], v[252:255]
    s_waitcnt lgkmcnt(10)
    v_mfma_f32_16x16x32_bf16 v[120:123], v[116:119], v[144:147], v[120:123]
    ds_read_b64_tr_b16 v[176:177], v90 offset:8192
    s_waitcnt lgkmcnt(9)
    v_mfma_f32_16x16x32_bf16 v[124:127], v[116:119], v[148:151], v[124:127]
    ds_read_b64_tr_b16 v[178:179], v90 offset:9216
    s_waitcnt lgkmcnt(9)
    v_mfma_f32_16x16x32_bf16 v[192:195], v[128:131], v[144:147], v[192:195]
    ds_read_b64_tr_b16 v[180:181], v91 offset:8192
    v_mfma_f32_16x16x32_bf16 v[196:199], v[128:131], v[148:151], v[196:199]
    ds_read_b64_tr_b16 v[182:183], v91 offset:9216
    s_waitcnt lgkmcnt(10)
    v_mfma_f32_16x16x32_bf16 v[208:211], v[132:135], v[144:147], v[208:211]
    ds_read_b128 v[160:163], v89 offset:0
    v_mfma_f32_16x16x32_bf16 v[212:215], v[132:135], v[148:151], v[212:215]
    ds_read_b128 v[164:167], v89 offset:2048
    s_waitcnt lgkmcnt(11)
    v_mfma_f32_16x16x32_bf16 v[224:227], v[136:139], v[144:147], v[224:227]
    ds_read_b128 v[168:171], v89 offset:4096
    v_mfma_f32_16x16x32_bf16 v[228:231], v[136:139], v[148:151], v[228:231]
    ds_read_b128 v[172:175], v89 offset:6144
    s_waitcnt lgkmcnt(12)
    v_mfma_f32_16x16x32_bf16 v[240:243], v[140:143], v[144:147], v[240:243]
    ds_read_b64_tr_b16 v[184:185], v92 offset:8192
    v_mfma_f32_16x16x32_bf16 v[244:247], v[140:143], v[148:151], v[244:247]
    ds_read_b64_tr_b16 v[186:187], v92 offset:9216
    s_waitcnt lgkmcnt(12)
    v_mfma_f32_16x16x32_bf16 v[200:203], v[128:131], v[152:155], v[200:203]
    ds_read_b64_tr_b16 v[188:189], v93 offset:8192
    v_mfma_f32_16x16x32_bf16 v[216:219], v[132:135], v[152:155], v[216:219]
    ds_read_b64_tr_b16 v[190:191], v93 offset:9216
    v_mfma_f32_16x16x32_bf16 v[232:235], v[136:139], v[152:155], v[232:235]
    v_mfma_f32_16x16x32_bf16 v[248:251], v[140:143], v[152:155], v[248:251]
    s_waitcnt lgkmcnt(12)
    v_mfma_f32_16x16x32_bf16 v[204:207], v[128:131], v[156:159], v[204:207]
    v_mfma_f32_16x16x32_bf16 v[220:223], v[132:135], v[156:159], v[220:223]
    v_mfma_f32_16x16x32_bf16 v[236:239], v[136:139], v[156:159], v[236:239]
    v_mfma_f32_16x16x32_bf16 v[252:255], v[140:143], v[156:159], v[252:255]
    s_waitcnt lgkmcnt(10)
    v_mfma_f32_16x16x32_bf16 v[120:123], v[116:119], v[176:179], v[120:123]
    s_waitcnt lgkmcnt(8)
    v_mfma_f32_16x16x32_bf16 v[124:127], v[116:119], v[180:183], v[124:127]
    s_barrier
    s_waitcnt lgkmcnt(7)
    v_mfma_f32_16x16x32_bf16 v[192:195], v[160:163], v[176:179], v[192:195]
    ds_read_b64_tr_b16 v[144:145], v90 offset:32768
    v_mfma_f32_16x16x32_bf16 v[196:199], v[160:163], v[180:183], v[196:199]
    ds_read_b64_tr_b16 v[146:147], v90 offset:33792
    s_waitcnt lgkmcnt(8)
    v_mfma_f32_16x16x32_bf16 v[208:211], v[164:167], v[176:179], v[208:211]
    ds_read_b64_tr_b16 v[148:149], v91 offset:32768
    v_mfma_f32_16x16x32_bf16 v[212:215], v[164:167], v[180:183], v[212:215]
    ds_read_b64_tr_b16 v[150:151], v91 offset:33792
    s_waitcnt lgkmcnt(9)
    v_mfma_f32_16x16x32_bf16 v[224:227], v[168:171], v[176:179], v[224:227]
    ds_read_b128 v[128:131], v88 offset:32768
    v_mfma_f32_16x16x32_bf16 v[228:231], v[168:171], v[180:183], v[228:231]
    ds_read_b128 v[132:135], v88 offset:34816
    s_waitcnt lgkmcnt(10)
    v_mfma_f32_16x16x32_bf16 v[240:243], v[172:175], v[176:179], v[240:243]
    ds_read_b128 v[136:139], v88 offset:36864
    v_mfma_f32_16x16x32_bf16 v[244:247], v[172:175], v[180:183], v[244:247]
    ds_read_b128 v[140:143], v88 offset:38912
    s_waitcnt lgkmcnt(10)
    v_mfma_f32_16x16x32_bf16 v[200:203], v[160:163], v[184:187], v[200:203]
    ds_read_b64_tr_b16 v[152:153], v92 offset:32768
    v_mfma_f32_16x16x32_bf16 v[216:219], v[164:167], v[184:187], v[216:219]
    ds_read_b64_tr_b16 v[154:155], v92 offset:33792
    v_mfma_f32_16x16x32_bf16 v[232:235], v[168:171], v[184:187], v[232:235]
    ds_read_b64_tr_b16 v[156:157], v93 offset:32768
    v_mfma_f32_16x16x32_bf16 v[248:251], v[172:175], v[184:187], v[248:251]
    ds_read_b64_tr_b16 v[158:159], v93 offset:33792
    s_waitcnt lgkmcnt(12)
    v_mfma_f32_16x16x32_bf16 v[204:207], v[160:163], v[188:191], v[204:207]
    v_mfma_f32_16x16x32_bf16 v[220:223], v[164:167], v[188:191], v[220:223]
    v_mfma_f32_16x16x32_bf16 v[236:239], v[168:171], v[188:191], v[236:239]
    v_mfma_f32_16x16x32_bf16 v[252:255], v[172:175], v[188:191], v[252:255]
    s_waitcnt lgkmcnt(10)
    v_mfma_f32_16x16x32_bf16 v[120:123], v[116:119], v[144:147], v[120:123]
    ds_read_b64_tr_b16 v[176:177], v90 offset:40960
    s_waitcnt lgkmcnt(9)
    v_mfma_f32_16x16x32_bf16 v[124:127], v[116:119], v[148:151], v[124:127]
    ds_read_b64_tr_b16 v[178:179], v90 offset:41984
    s_waitcnt lgkmcnt(9)
    v_mfma_f32_16x16x32_bf16 v[192:195], v[128:131], v[144:147], v[192:195]
    ds_read_b64_tr_b16 v[180:181], v91 offset:40960
    v_mfma_f32_16x16x32_bf16 v[196:199], v[128:131], v[148:151], v[196:199]
    ds_read_b64_tr_b16 v[182:183], v91 offset:41984
    s_waitcnt lgkmcnt(10)
    v_mfma_f32_16x16x32_bf16 v[208:211], v[132:135], v[144:147], v[208:211]
    ds_read_b128 v[160:163], v89 offset:32768
    v_mfma_f32_16x16x32_bf16 v[212:215], v[132:135], v[148:151], v[212:215]
    ds_read_b128 v[164:167], v89 offset:34816
    s_waitcnt lgkmcnt(11)
    v_mfma_f32_16x16x32_bf16 v[224:227], v[136:139], v[144:147], v[224:227]
    ds_read_b128 v[168:171], v89 offset:36864
    v_mfma_f32_16x16x32_bf16 v[228:231], v[136:139], v[148:151], v[228:231]
    ds_read_b128 v[172:175], v89 offset:38912
    s_waitcnt lgkmcnt(12)
    v_mfma_f32_16x16x32_bf16 v[240:243], v[140:143], v[144:147], v[240:243]
    ds_read_b64_tr_b16 v[184:185], v92 offset:40960
    v_mfma_f32_16x16x32_bf16 v[244:247], v[140:143], v[148:151], v[244:247]
    ds_read_b64_tr_b16 v[186:187], v92 offset:41984
    s_waitcnt lgkmcnt(12)
    v_mfma_f32_16x16x32_bf16 v[200:203], v[128:131], v[152:155], v[200:203]
    ds_read_b64_tr_b16 v[188:189], v93 offset:40960
    v_mfma_f32_16x16x32_bf16 v[216:219], v[132:135], v[152:155], v[216:219]
    ds_read_b64_tr_b16 v[190:191], v93 offset:41984
    v_mfma_f32_16x16x32_bf16 v[232:235], v[136:139], v[152:155], v[232:235]
    v_mfma_f32_16x16x32_bf16 v[248:251], v[140:143], v[152:155], v[248:251]
    s_waitcnt lgkmcnt(12)
    v_mfma_f32_16x16x32_bf16 v[204:207], v[128:131], v[156:159], v[204:207]
    v_mfma_f32_16x16x32_bf16 v[220:223], v[132:135], v[156:159], v[220:223]
    v_mfma_f32_16x16x32_bf16 v[236:239], v[136:139], v[156:159], v[236:239]
    v_mfma_f32_16x16x32_bf16 v[252:255], v[140:143], v[156:159], v[252:255]
    s_waitcnt lgkmcnt(10)
    v_mfma_f32_16x16x32_bf16 v[120:123], v[116:119], v[176:179], v[120:123]
    s_waitcnt lgkmcnt(8)
    v_mfma_f32_16x16x32_bf16 v[124:127], v[116:119], v[180:183], v[124:127]
    s_barrier
    s_waitcnt lgkmcnt(7)
    v_mfma_f32_16x16x32_bf16 v[192:195], v[160:163], v[176:179], v[192:195]
    ds_read_b64_tr_b16 v[144:145], v96 offset:0
    v_mfma_f32_16x16x32_bf16 v[196:199], v[160:163], v[180:183], v[196:199]
    ds_read_b64_tr_b16 v[146:147], v96 offset:1024
    s_waitcnt lgkmcnt(8)
    v_mfma_f32_16x16x32_bf16 v[208:211], v[164:167], v[176:179], v[208:211]
    ds_read_b64_tr_b16 v[148:149], v97 offset:0
    v_mfma_f32_16x16x32_bf16 v[212:215], v[164:167], v[180:183], v[212:215]
    ds_read_b64_tr_b16 v[150:151], v97 offset:1024
    s_waitcnt lgkmcnt(9)
    v_mfma_f32_16x16x32_bf16 v[224:227], v[168:171], v[176:179], v[224:227]
    ds_read_b128 v[128:131], v94 offset:0
    v_mfma_f32_16x16x32_bf16 v[228:231], v[168:171], v[180:183], v[228:231]
    ds_read_b128 v[132:135], v94 offset:2048
    s_waitcnt lgkmcnt(10)
    v_mfma_f32_16x16x32_bf16 v[240:243], v[172:175], v[176:179], v[240:243]
    ds_read_b128 v[136:139], v94 offset:4096
    v_mfma_f32_16x16x32_bf16 v[244:247], v[172:175], v[180:183], v[244:247]
    ds_read_b128 v[140:143], v94 offset:6144
    s_waitcnt lgkmcnt(10)
    v_mfma_f32_16x16x32_bf16 v[200:203], v[160:163], v[184:187], v[200:203]
    ds_read_b64_tr_b16 v[152:153], v98 offset:0
    v_mfma_f32_16x16x32_bf16 v[216:219], v[164:167], v[184:187], v[216:219]
    ds_read_b64_tr_b16 v[154:155], v98 offset:1024
    v_mfma_f32_16x16x32_bf16 v[232:235], v[168:171], v[184:187], v[232:235]
    ds_read_b64_tr_b16 v[156:157], v99 offset:0
    v_mfma_f32_16x16x32_bf16 v[248:251], v[172:175], v[184:187], v[248:251]
    ds_read_b64_tr_b16 v[158:159], v99 offset:1024
    s_waitcnt lgkmcnt(12)
    v_mfma_f32_16x16x32_bf16 v[204:207], v[160:163], v[188:191], v[204:207]
    v_mfma_f32_16x16x32_bf16 v[220:223], v[164:167], v[188:191], v[220:223]
    v_mfma_f32_16x16x32_bf16 v[236:239], v[168:171], v[188:191], v[236:239]
    v_mfma_f32_16x16x32_bf16 v[252:255], v[172:175], v[188:191], v[252:255]
    s_waitcnt lgkmcnt(10)
    v_mfma_f32_16x16x32_bf16 v[120:123], v[116:119], v[144:147], v[120:123]
    ds_read_b64_tr_b16 v[176:177], v96 offset:8192
    s_waitcnt lgkmcnt(9)
    v_mfma_f32_16x16x32_bf16 v[124:127], v[116:119], v[148:151], v[124:127]
    ds_read_b64_tr_b16 v[178:179], v96 offset:9216
    s_waitcnt lgkmcnt(9)
    v_mfma_f32_16x16x32_bf16 v[192:195], v[128:131], v[144:147], v[192:195]
    ds_read_b64_tr_b16 v[180:181], v97 offset:8192
    v_mfma_f32_16x16x32_bf16 v[196:199], v[128:131], v[148:151], v[196:199]
    ds_read_b64_tr_b16 v[182:183], v97 offset:9216
    s_waitcnt lgkmcnt(10)
    v_mfma_f32_16x16x32_bf16 v[208:211], v[132:135], v[144:147], v[208:211]
    ds_read_b128 v[160:163], v95 offset:0
    v_mfma_f32_16x16x32_bf16 v[212:215], v[132:135], v[148:151], v[212:215]
    ds_read_b128 v[164:167], v95 offset:2048
    s_waitcnt lgkmcnt(11)
    v_mfma_f32_16x16x32_bf16 v[224:227], v[136:139], v[144:147], v[224:227]
    ds_read_b128 v[168:171], v95 offset:4096
    v_mfma_f32_16x16x32_bf16 v[228:231], v[136:139], v[148:151], v[228:231]
    ds_read_b128 v[172:175], v95 offset:6144
    s_waitcnt lgkmcnt(12)
    v_mfma_f32_16x16x32_bf16 v[240:243], v[140:143], v[144:147], v[240:243]
    ds_read_b64_tr_b16 v[184:185], v98 offset:8192
    v_mfma_f32_16x16x32_bf16 v[244:247], v[140:143], v[148:151], v[244:247]
    ds_read_b64_tr_b16 v[186:187], v98 offset:9216
    s_waitcnt lgkmcnt(12)
    v_mfma_f32_16x16x32_bf16 v[200:203], v[128:131], v[152:155], v[200:203]
    ds_read_b64_tr_b16 v[188:189], v99 offset:8192
    v_mfma_f32_16x16x32_bf16 v[216:219], v[132:135], v[152:155], v[216:219]
    ds_read_b64_tr_b16 v[190:191], v99 offset:9216
    v_mfma_f32_16x16x32_bf16 v[232:235], v[136:139], v[152:155], v[232:235]
    v_mfma_f32_16x16x32_bf16 v[248:251], v[140:143], v[152:155], v[248:251]
    s_waitcnt lgkmcnt(12)
    v_mfma_f32_16x16x32_bf16 v[204:207], v[128:131], v[156:159], v[204:207]
    v_mfma_f32_16x16x32_bf16 v[220:223], v[132:135], v[156:159], v[220:223]
    v_mfma_f32_16x16x32_bf16 v[236:239], v[136:139], v[156:159], v[236:239]
    v_mfma_f32_16x16x32_bf16 v[252:255], v[140:143], v[156:159], v[252:255]
    s_waitcnt lgkmcnt(10)
    v_mfma_f32_16x16x32_bf16 v[120:123], v[116:119], v[176:179], v[120:123]
    s_waitcnt lgkmcnt(8)
    v_mfma_f32_16x16x32_bf16 v[124:127], v[116:119], v[180:183], v[124:127]
    s_waitcnt lgkmcnt(7)
    v_mfma_f32_16x16x32_bf16 v[192:195], v[160:163], v[176:179], v[192:195]
    v_mfma_f32_16x16x32_bf16 v[196:199], v[160:163], v[180:183], v[196:199]
    s_waitcnt lgkmcnt(6)
    v_mfma_f32_16x16x32_bf16 v[208:211], v[164:167], v[176:179], v[208:211]
    v_mfma_f32_16x16x32_bf16 v[212:215], v[164:167], v[180:183], v[212:215]
    s_barrier
    s_waitcnt lgkmcnt(5)
    v_mfma_f32_16x16x32_bf16 v[224:227], v[168:171], v[176:179], v[224:227]
    ds_read_b64_tr_b16 v[144:145], v96 offset:32768
    v_mfma_f32_16x16x32_bf16 v[228:231], v[168:171], v[180:183], v[228:231]
    ds_read_b64_tr_b16 v[146:147], v96 offset:33792
    s_waitcnt lgkmcnt(6)
    v_mfma_f32_16x16x32_bf16 v[240:243], v[172:175], v[176:179], v[240:243]
    ds_read_b64_tr_b16 v[148:149], v97 offset:32768
    v_mfma_f32_16x16x32_bf16 v[244:247], v[172:175], v[180:183], v[244:247]
    ds_read_b64_tr_b16 v[150:151], v97 offset:33792
    s_waitcnt lgkmcnt(6)
    v_mfma_f32_16x16x32_bf16 v[200:203], v[160:163], v[184:187], v[200:203]
    ds_read_b128 v[128:131], v94 offset:32768
    v_mfma_f32_16x16x32_bf16 v[216:219], v[164:167], v[184:187], v[216:219]
    ds_read_b128 v[132:135], v94 offset:34816
    v_mfma_f32_16x16x32_bf16 v[232:235], v[168:171], v[184:187], v[232:235]
    ds_read_b128 v[136:139], v94 offset:36864
    v_mfma_f32_16x16x32_bf16 v[248:251], v[172:175], v[184:187], v[248:251]
    ds_read_b128 v[140:143], v94 offset:38912
    s_waitcnt lgkmcnt(8)
    v_mfma_f32_16x16x32_bf16 v[204:207], v[160:163], v[188:191], v[204:207]
    ds_read_b64_tr_b16 v[152:153], v98 offset:32768
    v_mfma_f32_16x16x32_bf16 v[220:223], v[164:167], v[188:191], v[220:223]
    ds_read_b64_tr_b16 v[154:155], v98 offset:33792
    v_mfma_f32_16x16x32_bf16 v[236:239], v[168:171], v[188:191], v[236:239]
    ds_read_b64_tr_b16 v[156:157], v99 offset:32768
    v_mfma_f32_16x16x32_bf16 v[252:255], v[172:175], v[188:191], v[252:255]
    ds_read_b64_tr_b16 v[158:159], v99 offset:33792
    s_waitcnt lgkmcnt(10)
    v_mfma_f32_16x16x32_bf16 v[120:123], v[116:119], v[144:147], v[120:123]
    ds_read_b64_tr_b16 v[176:177], v96 offset:40960
    s_waitcnt lgkmcnt(9)
    v_mfma_f32_16x16x32_bf16 v[124:127], v[116:119], v[148:151], v[124:127]
    ds_read_b64_tr_b16 v[178:179], v96 offset:41984
    s_waitcnt lgkmcnt(9)
    v_mfma_f32_16x16x32_bf16 v[192:195], v[128:131], v[144:147], v[192:195]
    ds_read_b64_tr_b16 v[180:181], v97 offset:40960
    v_mfma_f32_16x16x32_bf16 v[196:199], v[128:131], v[148:151], v[196:199]
    ds_read_b64_tr_b16 v[182:183], v97 offset:41984
    s_waitcnt lgkmcnt(10)
    v_mfma_f32_16x16x32_bf16 v[208:211], v[132:135], v[144:147], v[208:211]
    ds_read_b128 v[160:163], v95 offset:32768
    v_mfma_f32_16x16x32_bf16 v[212:215], v[132:135], v[148:151], v[212:215]
    ds_read_b128 v[164:167], v95 offset:34816
    s_waitcnt lgkmcnt(11)
    v_mfma_f32_16x16x32_bf16 v[224:227], v[136:139], v[144:147], v[224:227]
    ds_read_b128 v[168:171], v95 offset:36864
    v_mfma_f32_16x16x32_bf16 v[228:231], v[136:139], v[148:151], v[228:231]
    ds_read_b128 v[172:175], v95 offset:38912
    s_waitcnt lgkmcnt(12)
    v_mfma_f32_16x16x32_bf16 v[240:243], v[140:143], v[144:147], v[240:243]
    ds_read_b64_tr_b16 v[184:185], v98 offset:40960
    v_mfma_f32_16x16x32_bf16 v[244:247], v[140:143], v[148:151], v[244:247]
    ds_read_b64_tr_b16 v[186:187], v98 offset:41984
    s_waitcnt lgkmcnt(12)
    v_mfma_f32_16x16x32_bf16 v[200:203], v[128:131], v[152:155], v[200:203]
    ds_read_b64_tr_b16 v[188:189], v99 offset:40960
    v_mfma_f32_16x16x32_bf16 v[216:219], v[132:135], v[152:155], v[216:219]
    ds_read_b64_tr_b16 v[190:191], v99 offset:41984
    v_mfma_f32_16x16x32_bf16 v[232:235], v[136:139], v[152:155], v[232:235]
    v_mfma_f32_16x16x32_bf16 v[248:251], v[140:143], v[152:155], v[248:251]
    s_waitcnt lgkmcnt(12)
    v_mfma_f32_16x16x32_bf16 v[204:207], v[128:131], v[156:159], v[204:207]
    v_mfma_f32_16x16x32_bf16 v[220:223], v[132:135], v[156:159], v[220:223]
    v_mfma_f32_16x16x32_bf16 v[236:239], v[136:139], v[156:159], v[236:239]
    v_mfma_f32_16x16x32_bf16 v[252:255], v[140:143], v[156:159], v[252:255]
    s_waitcnt lgkmcnt(10)
    v_mfma_f32_16x16x32_bf16 v[120:123], v[116:119], v[176:179], v[120:123]
    ds_read_b64_tr_b16 v[144:145], v102 offset:0
    s_waitcnt lgkmcnt(9)
    v_mfma_f32_16x16x32_bf16 v[124:127], v[116:119], v[180:183], v[124:127]
    ds_read_b64_tr_b16 v[146:147], v102 offset:1024
    s_waitcnt lgkmcnt(9)
    v_mfma_f32_16x16x32_bf16 v[192:195], v[160:163], v[176:179], v[192:195]
    ds_read_b64_tr_b16 v[148:149], v103 offset:0
    v_mfma_f32_16x16x32_bf16 v[196:199], v[160:163], v[180:183], v[196:199]
    ds_read_b64_tr_b16 v[150:151], v103 offset:1024
    s_waitcnt lgkmcnt(10)
    v_mfma_f32_16x16x32_bf16 v[208:211], v[164:167], v[176:179], v[208:211]
    ds_read_b128 v[128:131], v100 offset:0
    v_mfma_f32_16x16x32_bf16 v[212:215], v[164:167], v[180:183], v[212:215]
    ds_read_b128 v[132:135], v100 offset:2048
    s_waitcnt lgkmcnt(11)
    v_mfma_f32_16x16x32_bf16 v[224:227], v[168:171], v[176:179], v[224:227]
    ds_read_b128 v[136:139], v100 offset:4096
    v_mfma_f32_16x16x32_bf16 v[228:231], v[168:171], v[180:183], v[228:231]
    ds_read_b128 v[140:143], v100 offset:6144
    s_waitcnt lgkmcnt(12)
    v_mfma_f32_16x16x32_bf16 v[240:243], v[172:175], v[176:179], v[240:243]
    ds_read_b64_tr_b16 v[152:153], v104 offset:0
    v_mfma_f32_16x16x32_bf16 v[244:247], v[172:175], v[180:183], v[244:247]
    ds_read_b64_tr_b16 v[154:155], v104 offset:1024
    s_waitcnt lgkmcnt(12)
    v_mfma_f32_16x16x32_bf16 v[200:203], v[160:163], v[184:187], v[200:203]
    ds_read_b64_tr_b16 v[156:157], v105 offset:0
    v_mfma_f32_16x16x32_bf16 v[216:219], v[164:167], v[184:187], v[216:219]
    ds_read_b64_tr_b16 v[158:159], v105 offset:1024
    v_mfma_f32_16x16x32_bf16 v[232:235], v[168:171], v[184:187], v[232:235]
    ds_read_b64_tr_b16 v[64:65], v102 offset:8192
    v_mfma_f32_16x16x32_bf16 v[248:251], v[172:175], v[184:187], v[248:251]
    ds_read_b64_tr_b16 v[66:67], v102 offset:9216
    s_waitcnt lgkmcnt(14)
    v_mfma_f32_16x16x32_bf16 v[204:207], v[160:163], v[188:191], v[204:207]
    ds_read_b64_tr_b16 v[68:69], v103 offset:8192
    v_mfma_f32_16x16x32_bf16 v[220:223], v[164:167], v[188:191], v[220:223]
    ds_read_b64_tr_b16 v[70:71], v103 offset:9216
    v_mfma_f32_16x16x32_bf16 v[236:239], v[168:171], v[188:191], v[236:239]
    v_mfma_f32_16x16x32_bf16 v[252:255], v[172:175], v[188:191], v[252:255]
    s_waitcnt lgkmcnt(14)
    v_mfma_f32_16x16x32_bf16 v[120:123], v[116:119], v[144:147], v[120:123]
    ds_read_b64_tr_b16 v[176:177], v102 offset:8192
    s_waitcnt lgkmcnt(13)
    v_mfma_f32_16x16x32_bf16 v[124:127], v[116:119], v[148:151], v[124:127]
    ds_read_b64_tr_b16 v[178:179], v102 offset:9216
    s_waitcnt lgkmcnt(13)
    v_mfma_f32_16x16x32_bf16 v[192:195], v[128:131], v[144:147], v[192:195]
    ds_read_b64_tr_b16 v[180:181], v103 offset:8192
    v_mfma_f32_16x16x32_bf16 v[196:199], v[128:131], v[148:151], v[196:199]
    ds_read_b64_tr_b16 v[182:183], v103 offset:9216
    s_waitcnt lgkmcnt(14)
    v_mfma_f32_16x16x32_bf16 v[208:211], v[132:135], v[144:147], v[208:211]
    ds_read_b128 v[160:163], v101 offset:0
    v_mfma_f32_16x16x32_bf16 v[212:215], v[132:135], v[148:151], v[212:215]
    ds_read_b128 v[164:167], v101 offset:2048
    s_waitcnt lgkmcnt(15)
    v_mfma_f32_16x16x32_bf16 v[224:227], v[136:139], v[144:147], v[224:227]
    ds_read_b128 v[168:171], v101 offset:4096
    v_mfma_f32_16x16x32_bf16 v[228:231], v[136:139], v[148:151], v[228:231]
    ds_read_b128 v[172:175], v101 offset:6144
    s_waitcnt lgkmcnt(15)
    v_mfma_f32_16x16x32_bf16 v[240:243], v[140:143], v[144:147], v[240:243]
    ds_read_b64_tr_b16 v[184:185], v104 offset:8192
    v_mfma_f32_16x16x32_bf16 v[244:247], v[140:143], v[148:151], v[244:247]
    ds_read_b64_tr_b16 v[186:187], v104 offset:9216
    s_waitcnt lgkmcnt(10)
    v_mfma_f32_16x16x32_bf16 v[120:123], v[116:119], v[64:67], v[120:123]
    ds_read_b64_tr_b16 v[188:189], v105 offset:8192
    v_mfma_f32_16x16x32_bf16 v[124:127], v[116:119], v[68:71], v[124:127]
    ds_read_b64_tr_b16 v[190:191], v105 offset:9216
    v_mfma_f32_16x16x32_bf16 v[200:203], v[128:131], v[152:155], v[200:203]
    v_mfma_f32_16x16x32_bf16 v[216:219], v[132:135], v[152:155], v[216:219]
    v_mfma_f32_16x16x32_bf16 v[232:235], v[136:139], v[152:155], v[232:235]
    v_mfma_f32_16x16x32_bf16 v[248:251], v[140:143], v[152:155], v[248:251]
    v_mfma_f32_16x16x32_bf16 v[204:207], v[128:131], v[156:159], v[204:207]
    v_mfma_f32_16x16x32_bf16 v[220:223], v[132:135], v[156:159], v[220:223]
    v_mfma_f32_16x16x32_bf16 v[236:239], v[136:139], v[156:159], v[236:239]
    v_mfma_f32_16x16x32_bf16 v[252:255], v[140:143], v[156:159], v[252:255]
    s_mov_b64 exec, 0xffff
    ds_write_b32 v110, v120
    ds_write_b32 v110, v124 offset:64
    s_mov_b64 exec, -1
    s_waitcnt lgkmcnt(9)
    v_mfma_f32_16x16x32_bf16 v[192:195], v[160:163], v[176:179], v[192:195]
    v_mfma_f32_16x16x32_bf16 v[196:199], v[160:163], v[180:183], v[196:199]
    s_waitcnt lgkmcnt(0)
    s_barrier
    v_mfma_f32_16x16x32_bf16 v[208:211], v[164:167], v[176:179], v[208:211]
    ds_read_b32 v24, v111 offset:0
    v_mfma_f32_16x16x32_bf16 v[212:215], v[164:167], v[180:183], v[212:215]
    ds_read_b32 v26, v111 offset:64
    v_mfma_f32_16x16x32_bf16 v[224:227], v[168:171], v[176:179], v[224:227]
    ds_read_b32 v28, v114 offset:0
    v_mfma_f32_16x16x32_bf16 v[228:231], v[168:171], v[180:183], v[228:231]
    ds_read_b32 v30, v114 offset:64
    v_mfma_f32_16x16x32_bf16 v[240:243], v[172:175], v[176:179], v[240:243]
    ds_read_b128 v[32:35], v115 offset:0
    v_mfma_f32_16x16x32_bf16 v[244:247], v[172:175], v[180:183], v[244:247]
    ds_read_b128 v[36:39], v115 offset:512
    v_mfma_f32_16x16x32_bf16 v[200:203], v[160:163], v[184:187], v[200:203]
    ds_read_b128 v[40:43], v115 offset:64
    v_mfma_f32_16x16x32_bf16 v[204:207], v[160:163], v[188:191], v[204:207]
    ds_read_b128 v[44:47], v115 offset:576
    v_mfma_f32_16x16x32_bf16 v[216:219], v[164:167], v[184:187], v[216:219]
    ds_read_b128 v[48:51], v115 offset:128
    v_mfma_f32_16x16x32_bf16 v[220:223], v[164:167], v[188:191], v[220:223]
    ds_read_b128 v[52:55], v115 offset:640
    v_mfma_f32_16x16x32_bf16 v[232:235], v[168:171], v[184:187], v[232:235]
    ds_read_b128 v[56:59], v115 offset:192
    v_mfma_f32_16x16x32_bf16 v[236:239], v[168:171], v[188:191], v[236:239]
    ds_read_b128 v[60:63], v115 offset:704
    v_mfma_f32_16x16x32_bf16 v[248:251], v[172:175], v[184:187], v[248:251]
    v_mfma_f32_16x16x32_bf16 v[252:255], v[172:175], v[188:191], v[252:255]
    s_waitcnt lgkmcnt(4)
    v_pk_fma_f32 v[192:193], v[32:33], v[24:25], v[192:193] op_sel_hi:[1,0,1] neg_lo:[1,0,0] neg_hi:[1,0,0]
    v_pk_fma_f32 v[194:195], v[34:35], v[24:25], v[194:195] op_sel_hi:[1,0,1] neg_lo:[1,0,0] neg_hi:[1,0,0]
    v_pk_fma_f32 v[208:209], v[40:41], v[24:25], v[208:209] op_sel_hi:[1,0,1] neg_lo:[1,0,0] neg_hi:[1,0,0]
    v_pk_fma_f32 v[210:211], v[42:43], v[24:25], v[210:211] op_sel_hi:[1,0,1] neg_lo:[1,0,0] neg_hi:[1,0,0]
    v_pk_mul_f32 v[192:193], v[192:193], v[36:37]
    v_pk_mul_f32 v[194:195], v[194:195], v[38:39]
    v_pk_mul_f32 v[208:209], v[208:209], v[44:45]
    v_pk_mul_f32 v[210:211], v[210:211], v[46:47]
    v_cvt_pk_bf16_f32 v128, v192, v193
    v_cvt_pk_bf16_f32 v129, v194, v195
    v_cvt_pk_bf16_f32 v130, v208, v209
    v_cvt_pk_bf16_f32 v131, v210, v211
    s_nop 0
    v_permlane16_swap_b32 v128, v130
    v_permlane16_swap_b32 v129, v131
    buffer_store_dwordx4 v[128:131], v106, s[16:19], s37 offen offset:0 sc1
    v_pk_fma_f32 v[196:197], v[32:33], v[26:27], v[196:197] op_sel_hi:[1,0,1] neg_lo:[1,0,0] neg_hi:[1,0,0]
    v_pk_fma_f32 v[198:199], v[34:35], v[26:27], v[198:199] op_sel_hi:[1,0,1] neg_lo:[1,0,0] neg_hi:[1,0,0]
    v_pk_fma_f32 v[212:213], v[40:41], v[26:27], v[212:213] op_sel_hi:[1,0,1] neg_lo:[1,0,0] neg_hi:[1,0,0]
    v_pk_fma_f32 v[214:215], v[42:43], v[26:27], v[214:215] op_sel_hi:[1,0,1] neg_lo:[1,0,0] neg_hi:[1,0,0]
    v_pk_mul_f32 v[196:197], v[196:197], v[36:37]
    v_pk_mul_f32 v[198:199], v[198:199], v[38:39]
    v_pk_mul_f32 v[212:213], v[212:213], v[44:45]
    v_pk_mul_f32 v[214:215], v[214:215], v[46:47]
    v_cvt_pk_bf16_f32 v132, v196, v197
    v_cvt_pk_bf16_f32 v133, v198, v199
    v_cvt_pk_bf16_f32 v134, v212, v213
    v_cvt_pk_bf16_f32 v135, v214, v215
    s_nop 0
    v_permlane16_swap_b32 v132, v134
    v_permlane16_swap_b32 v133, v135
    buffer_store_dwordx4 v[132:135], v107, s[16:19], s37 offen offset:0 sc1
    v_pk_fma_f32 v[200:201], v[32:33], v[28:29], v[200:201] op_sel_hi:[1,0,1] neg_lo:[1,0,0] neg_hi:[1,0,0]
    v_pk_fma_f32 v[202:203], v[34:35], v[28:29], v[202:203] op_sel_hi:[1,0,1] neg_lo:[1,0,0] neg_hi:[1,0,0]
    v_pk_fma_f32 v[216:217], v[40:41], v[28:29], v[216:217] op_sel_hi:[1,0,1] neg_lo:[1,0,0] neg_hi:[1,0,0]
    v_pk_fma_f32 v[218:219], v[42:43], v[28:29], v[218:219] op_sel_hi:[1,0,1] neg_lo:[1,0,0] neg_hi:[1,0,0]
    v_pk_mul_f32 v[200:201], v[200:201], v[36:37]
    v_pk_mul_f32 v[202:203], v[202:203], v[38:39]
    v_pk_mul_f32 v[216:217], v[216:217], v[44:45]
    v_pk_mul_f32 v[218:219], v[218:219], v[46:47]
    v_cvt_pk_bf16_f32 v136, v200, v201
    v_cvt_pk_bf16_f32 v137, v202, v203
    v_cvt_pk_bf16_f32 v138, v216, v217
    v_cvt_pk_bf16_f32 v139, v218, v219
    s_nop 0
    v_permlane16_swap_b32 v136, v138
    v_permlane16_swap_b32 v137, v139
    buffer_store_dwordx4 v[136:139], v108, s[16:19], s37 offen offset:0 sc1
    v_pk_fma_f32 v[204:205], v[32:33], v[30:31], v[204:205] op_sel_hi:[1,0,1] neg_lo:[1,0,0] neg_hi:[1,0,0]
    v_pk_fma_f32 v[206:207], v[34:35], v[30:31], v[206:207] op_sel_hi:[1,0,1] neg_lo:[1,0,0] neg_hi:[1,0,0]
    v_pk_fma_f32 v[220:221], v[40:41], v[30:31], v[220:221] op_sel_hi:[1,0,1] neg_lo:[1,0,0] neg_hi:[1,0,0]
    v_pk_fma_f32 v[222:223], v[42:43], v[30:31], v[222:223] op_sel_hi:[1,0,1] neg_lo:[1,0,0] neg_hi:[1,0,0]
    v_pk_mul_f32 v[204:205], v[204:205], v[36:37]
    v_pk_mul_f32 v[206:207], v[206:207], v[38:39]
    v_pk_mul_f32 v[220:221], v[220:221], v[44:45]
    v_pk_mul_f32 v[222:223], v[222:223], v[46:47]
    v_cvt_pk_bf16_f32 v140, v204, v205
    v_cvt_pk_bf16_f32 v141, v206, v207
    v_cvt_pk_bf16_f32 v142, v220, v221
    v_cvt_pk_bf16_f32 v143, v222, v223
    s_nop 0
    v_permlane16_swap_b32 v140, v142
    v_permlane16_swap_b32 v141, v143
    buffer_store_dwordx4 v[140:143], v109, s[16:19], s37 offen offset:0 sc1
    s_waitcnt lgkmcnt(0)
    v_pk_fma_f32 v[224:225], v[48:49], v[24:25], v[224:225] op_sel_hi:[1,0,1] neg_lo:[1,0,0] neg_hi:[1,0,0]
    v_pk_fma_f32 v[226:227], v[50:51], v[24:25], v[226:227] op_sel_hi:[1,0,1] neg_lo:[1,0,0] neg_hi:[1,0,0]
    v_pk_fma_f32 v[240:241], v[56:57], v[24:25], v[240:241] op_sel_hi:[1,0,1] neg_lo:[1,0,0] neg_hi:[1,0,0]
    v_pk_fma_f32 v[242:243], v[58:59], v[24:25], v[242:243] op_sel_hi:[1,0,1] neg_lo:[1,0,0] neg_hi:[1,0,0]
    v_pk_mul_f32 v[224:225], v[224:225], v[52:53]
    v_pk_mul_f32 v[226:227], v[226:227], v[54:55]
    v_pk_mul_f32 v[240:241], v[240:241], v[60:61]
    v_pk_mul_f32 v[242:243], v[242:243], v[62:63]
    v_cvt_pk_bf16_f32 v144, v224, v225
    v_cvt_pk_bf16_f32 v145, v226, v227
    v_cvt_pk_bf16_f32 v146, v240, v241
    v_cvt_pk_bf16_f32 v147, v242, v243
    s_nop 0
    v_permlane16_swap_b32 v144, v146
    v_permlane16_swap_b32 v145, v147
    buffer_store_dwordx4 v[144:147], v106, s[16:19], s37 offen offset:2560 sc1
    v_pk_fma_f32 v[228:229], v[48:49], v[26:27], v[228:229] op_sel_hi:[1,0,1] neg_lo:[1,0,0] neg_hi:[1,0,0]
    v_pk_fma_f32 v[230:231], v[50:51], v[26:27], v[230:231] op_sel_hi:[1,0,1] neg_lo:[1,0,0] neg_hi:[1,0,0]
    v_pk_fma_f32 v[244:245], v[56:57], v[26:27], v[244:245] op_sel_hi:[1,0,1] neg_lo:[1,0,0] neg_hi:[1,0,0]
    v_pk_fma_f32 v[246:247], v[58:59], v[26:27], v[246:247] op_sel_hi:[1,0,1] neg_lo:[1,0,0] neg_hi:[1,0,0]
    v_pk_mul_f32 v[228:229], v[228:229], v[52:53]
    v_pk_mul_f32 v[230:231], v[230:231], v[54:55]
    v_pk_mul_f32 v[244:245], v[244:245], v[60:61]
    v_pk_mul_f32 v[246:247], v[246:247], v[62:63]
    v_cvt_pk_bf16_f32 v148, v228, v229
    v_cvt_pk_bf16_f32 v149, v230, v231
    v_cvt_pk_bf16_f32 v150, v244, v245
    v_cvt_pk_bf16_f32 v151, v246, v247
    s_nop 0
    v_permlane16_swap_b32 v148, v150
    v_permlane16_swap_b32 v149, v151
    buffer_store_dwordx4 v[148:151], v107, s[16:19], s37 offen offset:2560 sc1
    v_pk_fma_f32 v[232:233], v[48:49], v[28:29], v[232:233] op_sel_hi:[1,0,1] neg_lo:[1,0,0] neg_hi:[1,0,0]
    v_pk_fma_f32 v[234:235], v[50:51], v[28:29], v[234:235] op_sel_hi:[1,0,1] neg_lo:[1,0,0] neg_hi:[1,0,0]
    v_pk_fma_f32 v[248:249], v[56:57], v[28:29], v[248:249] op_sel_hi:[1,0,1] neg_lo:[1,0,0] neg_hi:[1,0,0]
    v_pk_fma_f32 v[250:251], v[58:59], v[28:29], v[250:251] op_sel_hi:[1,0,1] neg_lo:[1,0,0] neg_hi:[1,0,0]
    v_pk_mul_f32 v[232:233], v[232:233], v[52:53]
    v_pk_mul_f32 v[234:235], v[234:235], v[54:55]
    v_pk_mul_f32 v[248:249], v[248:249], v[60:61]
    v_pk_mul_f32 v[250:251], v[250:251], v[62:63]
    v_cvt_pk_bf16_f32 v152, v232, v233
    v_cvt_pk_bf16_f32 v153, v234, v235
    v_cvt_pk_bf16_f32 v154, v248, v249
    v_cvt_pk_bf16_f32 v155, v250, v251
    s_nop 0
    v_permlane16_swap_b32 v152, v154
    v_permlane16_swap_b32 v153, v155
    buffer_store_dwordx4 v[152:155], v108, s[16:19], s37 offen offset:2560 sc1
    v_pk_fma_f32 v[236:237], v[48:49], v[30:31], v[236:237] op_sel_hi:[1,0,1] neg_lo:[1,0,0] neg_hi:[1,0,0]
    v_pk_fma_f32 v[238:239], v[50:51], v[30:31], v[238:239] op_sel_hi:[1,0,1] neg_lo:[1,0,0] neg_hi:[1,0,0]
    v_pk_fma_f32 v[252:253], v[56:57], v[30:31], v[252:253] op_sel_hi:[1,0,1] neg_lo:[1,0,0] neg_hi:[1,0,0]
    v_pk_fma_f32 v[254:255], v[58:59], v[30:31], v[254:255] op_sel_hi:[1,0,1] neg_lo:[1,0,0] neg_hi:[1,0,0]
    v_pk_mul_f32 v[236:237], v[236:237], v[52:53]
    v_pk_mul_f32 v[238:239], v[238:239], v[54:55]
    v_pk_mul_f32 v[252:253], v[252:253], v[60:61]
    v_pk_mul_f32 v[254:255], v[254:255], v[62:63]
    v_cvt_pk_bf16_f32 v156, v236, v237
    v_cvt_pk_bf16_f32 v157, v238, v239
    v_cvt_pk_bf16_f32 v158, v252, v253
    v_cvt_pk_bf16_f32 v159, v254, v255
    s_nop 0
    v_permlane16_swap_b32 v156, v158
    v_permlane16_swap_b32 v157, v159
    buffer_store_dwordx4 v[156:159], v109, s[16:19], s37 offen offset:2560 sc1
    s_branch L_HOP
L_LOADER:
    s_add_u32 m0, s30, 0
    s_add_u32 s31, s28, 0
    buffer_load_dwordx4 v112, s[8:11], s31 offen lds
    s_add_u32 m0, s30, 16384
    s_add_u32 s31, s29, 0
    buffer_load_dwordx4 v113, s[12:15], s31 offen lds
    s_add_u32 m0, s30, 4096
    s_add_u32 s31, s28, 40960
    buffer_load_dwordx4 v112, s[8:11], s31 offen lds
    s_add_u32 m0, s30, 20480
    s_add_u32 s31, s29, 61440
    buffer_load_dwordx4 v113, s[12:15], s31 offen lds
    s_add_u32 m0, s30, 8192
    s_add_u32 s31, s28, 81920
    buffer_load_dwordx4 v112, s[8:11], s31 offen lds
    s_add_u32 m0, s30, 24576
    s_add_u32 s31, s29, 122880
    buffer_load_dwordx4 v113, s[12:15], s31 offen lds
    s_add_u32 m0, s30, 12288
    s_add_u32 s31, s28, 122880
    buffer_load_dwordx4 v112, s[8:11], s31 offen lds
    s_add_u32 m0, s30, 28672
    s_add_u32 s31, s29, 184320
    buffer_load_dwordx4 v113, s[12:15], s31 offen lds
    s_add_u32 s28, s28, 128
    s_add_u32 s29, s29, 245760
    s_cmp_ge_u32 s28, 1280
    s_cselect_b32 s28, 0, s28
    s_cselect_b32 s29, 0, s29
    s_add_u32 m0, s30, 32768
    s_add_u32 s31, s28, 0
    buffer_load_dwordx4 v112, s[8:11], s31 offen lds
    s_add_u32 m0, s30, 49152
    s_add_u32 s31, s29, 0
    buffer_load_dwordx4 v113, s[12:15], s31 offen lds
    s_add_u32 m0, s30, 36864
    s_add_u32 s31, s28, 40960
    buffer_load_dwordx4 v112, s[8:11], s31 offen lds
    s_add_u32 m0, s30, 53248
    s_add_u32 s31, s29, 61440
    buffer_load_dwordx4 v113, s[12:15], s31 offen lds
    s_add_u32 m0, s30, 40960
    s_add_u32 s31, s28, 81920
    buffer_load_dwordx4 v112, s[8:11], s31 offen lds
    s_add_u32 m0, s30, 57344
    s_add_u32 s31, s29, 122880
    buffer_load_dwordx4 v113, s[12:15], s31 offen lds
    s_add_u32 m0, s30, 45056
    s_add_u32 s31, s28, 122880
    buffer_load_dwordx4 v112, s[8:11], s31 offen lds
    s_add_u32 m0, s30, 61440
    s_add_u32 s31, s29, 184320
    buffer_load_dwordx4 v113, s[12:15], s31 offen lds
    s_add_u32 s28, s28, 128
    s_add_u32 s29, s29, 245760
    s_cmp_ge_u32 s28, 1280
    s_cselect_b32 s28, 0, s28
    s_cselect_b32 s29, 0, s29
    s_mov_b32 s16, s84
    s_and_b32 s17, s85, 0xffff
    s_mov_b32 s18, 18186240
    s_mov_b32 s19, 0x00020000
    s_lshl_b32 s4, s61, 4
    s_add_u32 s4, s4, s60
    s_lshl_b32 s4, s4, 7
    s_add_u32 s59, s4, 13631488
    s_lshl_b32 s3, s60, 10
    s_add_u32 s35, s3, 13746176
    v_lshlrev_b32 v26, 4, v1
    v_lshlrev_b32 v7, 4, v1
    s_lshl_b32 s3, s60, 2
    v_mov_b32 v24, s3
    v_mov_b32 v25, 0
    s_waitcnt vmcnt(8)
    s_barrier
    s_add_u32 m0, s30, 65536
    s_add_u32 s31, s28, 0
    buffer_load_dwordx4 v112, s[8:11], s31 offen lds
    s_add_u32 m0, s30, 81920
    s_add_u32 s31, s29, 0
    buffer_load_dwordx4 v113, s[12:15], s31 offen lds
    s_add_u32 m0, s30, 69632
    s_add_u32 s31, s28, 40960
    buffer_load_dwordx4 v112, s[8:11], s31 offen lds
    s_add_u32 m0, s30, 86016
    s_add_u32 s31, s29, 61440
    buffer_load_dwordx4 v113, s[12:15], s31 offen lds
    s_add_u32 m0, s30, 73728
    s_add_u32 s31, s28, 81920
    buffer_load_dwordx4 v112, s[8:11], s31 offen lds
    s_add_u32 m0, s30, 90112
    s_add_u32 s31, s29, 122880
    buffer_load_dwordx4 v113, s[12:15], s31 offen lds
    s_add_u32 m0, s30, 77824
    s_add_u32 s31, s28, 122880
    buffer_load_dwordx4 v112, s[8:11], s31 offen lds
    s_add_u32 m0, s30, 94208
    s_add_u32 s31, s29, 184320
    buffer_load_dwordx4 v113, s[12:15], s31 offen lds
    s_add_u32 s28, s28, 128
    s_add_u32 s29, s29, 245760
    s_cmp_ge_u32 s28, 1280
    s_cselect_b32 s28, 0, s28
    s_cselect_b32 s29, 0, s29
    s_waitcnt vmcnt(8)
    s_barrier
    s_add_u32 m0, s30, 98304
    s_add_u32 s31, s28, 0
    buffer_load_dwordx4 v112, s[8:11], s31 offen lds
    s_add_u32 m0, s30, 114688
    s_add_u32 s31, s29, 0
    buffer_load_dwordx4 v113, s[12:15], s31 offen lds
    s_add_u32 m0, s30, 102400
    s_add_u32 s31, s28, 40960
    buffer_load_dwordx4 v112, s[8:11], s31 offen lds
    s_add_u32 m0, s30, 118784
    s_add_u32 s31, s29, 61440
    buffer_load_dwordx4 v113, s[12:15], s31 offen lds
    s_add_u32 m0, s30, 106496
    s_add_u32 s31, s28, 81920
    buffer_load_dwordx4 v112, s[8:11], s31 offen lds
    s_add_u32 m0, s30, 122880
    s_add_u32 s31, s29, 122880
    buffer_load_dwordx4 v113, s[12:15], s31 offen lds
    s_add_u32 m0, s30, 110592
    s_add_u32 s31, s28, 122880
    buffer_load_dwordx4 v112, s[8:11], s31 offen lds
    s_add_u32 m0, s30, 126976
    s_add_u32 s31, s29, 184320
    buffer_load_dwordx4 v113, s[12:15], s31 offen lds
    s_add_u32 s28, s28, 128
    s_add_u32 s29, s29, 245760
    s_cmp_ge_u32 s28, 1280
    s_cselect_b32 s28, 0, s28
    s_cselect_b32 s29, 0, s29
    s_waitcnt vmcnt(8)
    s_barrier
    s_add_u32 m0, s30, 131072
    s_add_u32 s31, s28, 0
    buffer_load_dwordx4 v112, s[8:11], s31 offen lds
    s_add_u32 m0, s30, 147456
    s_add_u32 s31, s29, 0
    buffer_load_dwordx4 v113, s[12:15], s31 offen lds
    s_add_u32 m0, s30, 135168
    s_add_u32 s31, s28, 40960
    buffer_load_dwordx4 v112, s[8:11], s31 offen lds
    s_add_u32 m0, s30, 151552
    s_add_u32 s31, s29, 61440
    buffer_load_dwordx4 v113, s[12:15], s31 offen lds
    s_add_u32 m0, s30, 139264
    s_add_u32 s31, s28, 81920
    buffer_load_dwordx4 v112, s[8:11], s31 offen lds
    s_add_u32 m0, s30, 155648
    s_add_u32 s31, s29, 122880
    buffer_load_dwordx4 v113, s[12:15], s31 offen lds
    s_add_u32 m0, s30, 143360
    s_add_u32 s31, s28, 122880
    buffer_load_dwordx4 v112, s[8:11], s31 offen lds
    s_add_u32 m0, s30, 159744
    s_add_u32 s31, s29, 184320
    buffer_load_dwordx4 v113, s[12:15], s31 offen lds
    s_add_u32 s28, s28, 128
    s_add_u32 s29, s29, 245760
    s_cmp_ge_u32 s28, 1280
    s_cselect_b32 s28, 0, s28
    s_cselect_b32 s29, 0, s29
    s_waitcnt vmcnt(8)
    s_barrier
    s_add_u32 m0, s30, 0
    s_add_u32 s31, s28, 0
    buffer_load_dwordx4 v112, s[8:11], s31 offen lds
    s_add_u32 m0, s30, 16384
    s_add_u32 s31, s29, 0
    buffer_load_dwordx4 v113, s[12:15], s31 offen lds
    s_add_u32 m0, s30, 4096
    s_add_u32 s31, s28, 40960
    buffer_load_dwordx4 v112, s[8:11], s31 offen lds
    s_add_u32 m0, s30, 20480
    s_add_u32 s31, s29, 61440
    buffer_load_dwordx4 v113, s[12:15], s31 offen lds
    s_add_u32 m0, s30, 8192
    s_add_u32 s31, s28, 81920
    buffer_load_dwordx4 v112, s[8:11], s31 offen lds
    s_add_u32 m0, s30, 24576
    s_add_u32 s31, s29, 122880
    buffer_load_dwordx4 v113, s[12:15], s31 offen lds
    s_add_u32 m0, s30, 12288
    s_add_u32 s31, s28, 122880
    buffer_load_dwordx4 v112, s[8:11], s31 offen lds
    s_add_u32 m0, s30, 28672
    s_add_u32 s31, s29, 184320
    buffer_load_dwordx4 v113, s[12:15], s31 offen lds
    s_add_u32 s28, s28, 128
    s_add_u32 s29, s29, 245760
    s_cmp_ge_u32 s28, 1280
    s_cselect_b32 s28, 0, s28
    s_cselect_b32 s29, 0, s29
    s_waitcnt vmcnt(8)
    s_barrier
    s_add_u32 m0, s30, 32768
    s_add_u32 s31, s28, 0
    buffer_load_dwordx4 v112, s[8:11], s31 offen lds
    s_add_u32 m0, s30, 49152
    s_add_u32 s31, s29, 0
    buffer_load_dwordx4 v113, s[12:15], s31 offen lds
    s_add_u32 m0, s30, 36864
    s_add_u32 s31, s28, 40960
    buffer_load_dwordx4 v112, s[8:11], s31 offen lds
    s_add_u32 m0, s30, 53248
    s_add_u32 s31, s29, 61440
    buffer_load_dwordx4 v113, s[12:15], s31 offen lds
    s_add_u32 m0, s30, 40960
    s_add_u32 s31, s28, 81920
    buffer_load_dwordx4 v112, s[8:11], s31 offen lds
    s_add_u32 m0, s30, 57344
    s_add_u32 s31, s29, 122880
    buffer_load_dwordx4 v113, s[12:15], s31 offen lds
    s_add_u32 m0, s30, 45056
    s_add_u32 s31, s28, 122880
    buffer_load_dwordx4 v112, s[8:11], s31 offen lds
    s_add_u32 m0, s30, 61440
    s_add_u32 s31, s29, 184320
    buffer_load_dwordx4 v113, s[12:15], s31 offen lds
    s_add_u32 s28, s28, 128
    s_add_u32 s29, s29, 245760
    s_cmp_ge_u32 s28, 1280
    s_cselect_b32 s28, 0, s28
    s_cselect_b32 s29, 0, s29
    s_waitcnt vmcnt(8)
    s_barrier
    s_add_u32 m0, s30, 65536
    s_add_u32 s31, s28, 0
    buffer_load_dwordx4 v112, s[8:11], s31 offen lds
    s_add_u32 m0, s30, 81920
    s_add_u32 s31, s29, 0
    buffer_load_dwordx4 v113, s[12:15], s31 offen lds
    s_add_u32 m0, s30, 69632
    s_add_u32 s31, s28, 40960
    buffer_load_dwordx4 v112, s[8:11], s31 offen lds
    s_add_u32 m0, s30, 86016
    s_add_u32 s31, s29, 61440
    buffer_load_dwordx4 v113, s[12:15], s31 offen lds
    s_add_u32 m0, s30, 73728
    s_add_u32 s31, s28, 81920
    buffer_load_dwordx4 v112, s[8:11], s31 offen lds
    s_add_u32 m0, s30, 90112
    s_add_u32 s31, s29, 122880
    buffer_load_dwordx4 v113, s[12:15], s31 offen lds
    s_add_u32 m0, s30, 77824
    s_add_u32 s31, s28, 122880
    buffer_load_dwordx4 v112, s[8:11], s31 offen lds
    s_add_u32 m0, s30, 94208
    s_add_u32 s31, s29, 184320
    buffer_load_dwordx4 v113, s[12:15], s31 offen lds
    s_add_u32 s28, s28, 128
    s_add_u32 s29, s29, 245760
    s_cmp_ge_u32 s28, 1280
    s_cselect_b32 s28, 0, s28
    s_cselect_b32 s29, 0, s29
    s_waitcnt vmcnt(8)
    s_barrier
    s_add_u32 m0, s30, 98304
    s_add_u32 s31, s28, 0
    buffer_load_dwordx4 v112, s[8:11], s31 offen lds
    s_add_u32 m0, s30, 114688
    s_add_u32 s31, s29, 0
    buffer_load_dwordx4 v113, s[12:15], s31 offen lds
    s_add_u32 m0, s30, 102400
    s_add_u32 s31, s28, 40960
    buffer_load_dwordx4 v112, s[8:11], s31 offen lds
    s_add_u32 m0, s30, 118784
    s_add_u32 s31, s29, 61440
    buffer_load_dwordx4 v113, s[12:15], s31 offen lds
    s_add_u32 m0, s30, 106496
    s_add_u32 s31, s28, 81920
    buffer_load_dwordx4 v112, s[8:11], s31 offen lds
    s_add_u32 m0, s30, 122880
    s_add_u32 s31, s29, 122880
    buffer_load_dwordx4 v113, s[12:15], s31 offen lds
    s_add_u32 m0, s30, 110592
    s_add_u32 s31, s28, 122880
    buffer_load_dwordx4 v112, s[8:11], s31 offen lds
    s_add_u32 m0, s30, 126976
    s_add_u32 s31, s29, 184320
    buffer_load_dwordx4 v113, s[12:15], s31 offen lds
    s_add_u32 s28, s28, 128
    s_add_u32 s29, s29, 245760
    s_cmp_ge_u32 s28, 1280
    s_cselect_b32 s28, 0, s28
    s_cselect_b32 s29, 0, s29
    s_waitcnt vmcnt(8)
    s_barrier
    s_add_u32 m0, s30, 131072
    s_add_u32 s31, s28, 0
    buffer_load_dwordx4 v112, s[8:11], s31 offen lds
    s_add_u32 m0, s30, 147456
    s_add_u32 s31, s29, 0
    buffer_load_dwordx4 v113, s[12:15], s31 offen lds
    s_add_u32 m0, s30, 135168
    s_add_u32 s31, s28, 40960
    buffer_load_dwordx4 v112, s[8:11], s31 offen lds
    s_add_u32 m0, s30, 151552
    s_add_u32 s31, s29, 61440
    buffer_load_dwordx4 v113, s[12:15], s31 offen lds
    s_add_u32 m0, s30, 139264
    s_add_u32 s31, s28, 81920
    buffer_load_dwordx4 v112, s[8:11], s31 offen lds
    s_add_u32 m0, s30, 155648
    s_add_u32 s31, s29, 122880
    buffer_load_dwordx4 v113, s[12:15], s31 offen lds
    s_add_u32 m0, s30, 143360
    s_add_u32 s31, s28, 122880
    buffer_load_dwordx4 v112, s[8:11], s31 offen lds
    s_add_u32 m0, s30, 159744
    s_add_u32 s31, s29, 184320
    buffer_load_dwordx4 v113, s[12:15], s31 offen lds
    s_add_u32 s28, s28, 128
    s_add_u32 s29, s29, 245760
    s_cmp_ge_u32 s28, 1280
    s_cselect_b32 s28, 0, s28
    s_cselect_b32 s29, 0, s29
    s_mov_b64 exec, 1
    global_load_dword v25, v24, s[82:83] sc1
    s_mov_b64 exec, -1
    s_waitcnt vmcnt(1)
    s_barrier
    s_waitcnt vmcnt(0)
    s_cmp_lg_u32 s20, 7
    s_cbranch_scc1 L_ST
    s_mov_b64 exec, 1
    v_cmp_ne_u32 vcc, 1, v25
    s_cbranch_vccz L_HF_OK
    s_mov_b32 s3, 0
L_HF:
    s_add_u32 s3, s3, 1
    s_cmp_gt_u32 s3, 2097152
    s_cbranch_scc1 L_END
    global_load_dword v25, v24, s[82:83] sc1
    s_waitcnt vmcnt(0)
    v_cmp_ne_u32 vcc, 1, v25
    s_cbranch_vccz L_HF_OK
    s_sleep 2
    s_branch L_HF
L_HF_OK:
    s_mov_b64 exec, -1
    buffer_load_dwordx4 v[244:247], v26, s[16:19], s35 offen sc1
L_ST:
    s_and_b32 s3, s2, 7
    s_lshl_b32 s22, s3, 1
    s_lshr_b32 s4, s63, 4
    s_add_u32 s22, s22, s4
    s_and_b32 s21, s63, 15
    s_lshl_b32 s23, s3, 2
    s_lshr_b32 s5, s63, 3
    s_add_u32 s23, s23, s5
    s_and_b32 s24, s63, 7
    s_min_u32 s4, s3, 5
    s_sub_u32 s25, s23, s4
    s_cmp_eq_u32 s5, 3
    s_cselect_b32 s4, s3, 7
    s_add_u32 s3, s3, 32
    s_cmp_lt_u32 s4, 5
    s_cselect_b32 s25, s3, s25
    v_mul_u32_u24 v8, 6554, v1
    v_lshrrev_b32 v8, 16, v8
    v_mul_u32_u24 v9, 10, v8
    v_sub_u32 v9, v1, v9
    s_and_b32 s3, s20, 1
    s_lshl_b32 s3, s3, 2
    v_add_u32 v4, s3, v8
    v_mul_u32_u24 v4, 1280, v4
    s_mul_i32 s3, s3, 5
    s_add_u32 s3, s3, 16
    v_add_u32 v5, s3, v8
    v_mul_u32_u24 v5, 1280, v5
    s_mul_i32 s3, s24, 160
    v_lshl_add_u32 v6, v9, 4, s3
    v_add_u32 v22, v4, v6
    v_add_u32 v23, v5, v6
    s_lshl_b32 s3, s21, 2
    s_add_u32 s3, s3, s26
    s_mul_i32 s3, s3, 40960
    s_add_u32 s3, s3, 7864320
    s_lshl_b32 s4, s22, 1
    s_add_u32 s4, s4, s27
    s_lshl_b32 s5, s4, 10
    s_add_u32 s5, s5, s3
    v_lshl_add_u32 v14, v1, 4, s5
    s_lshl_b32 s5, s4, 8
    s_add_u32 s5, s5, s3
    s_add_u32 s5, s5, 32768
    v_lshl_add_u32 v15, v1, 3, s5
    s_mul_i32 s3, s24, 80
    v_lshrrev_b32 v4, 3, v1
    v_add_u32 v4, s3, v4
    v_mul_u32_u24 v4, 3456, v4
    v_and_b32 v5, 7, v1
    v_lshl_add_u32 v4, v5, 4, v4
    s_lshl_b32 s3, s25, 7
    v_add_u32 v86, s3, v4
    s_cmp_ge_u32 s20, 3
    s_cselect_b32 s4, 1, 0
    s_mul_i32 s5, s4, 3
    s_sub_u32 s5, s20, s5
    s_mov_b32 s70, s4
    s_mov_b32 s71, s5
    s_add_u32 s5, s5, s21
    s_sub_u32 s5, s5, 2
    s_max_i32 s5, s5, 0
    s_min_i32 s5, s5, 15
    s_mul_i32 s4, s4, 80
    s_add_u32 s4, s4, 80
    s_add_u32 s4, s4, s5
    v_mov_b32 v4, s4
    v_mov_b32 v5, s21
    v_cmp_gt_u32 vcc, 2, v1
    s_nop 1
    v_cndmask_b32 v4, v5, v4, vcc
    s_mul_i32 s3, s22, 40
    v_and_b32 v7, 1, v1
    v_mul_u32_u24 v7, 39, v7
    v_add_u32 v7, s3, v7
    v_lshrrev_b32 v7, 7, v7
    v_lshl_add_u32 v4, v7, 4, v4
    v_lshlrev_b32 v4, 7, v4
    v_add_u32 v85, 13631488, v4
    v_bfe_u32 v4, v1, 2, 1
    v_lshlrev_b32 v4, 9, v4
    v_and_b32 v5, 3, v1
    v_lshl_add_u32 v4, v5, 13, v4
    s_lshr_b32 s3, s23, 1
    s_and_b32 s4, s3, 3
    s_lshl_b32 s4, s4, 7
    s_lshr_b32 s3, s3, 2
    s_lshl_b32 s3, s3, 11
    s_add_u32 s3, s3, s4
    s_lshl_b32 s4, s27, 10
    s_add_u32 s3, s3, s4
    s_add_u32 s3, s3, 13631520
    v_add_u32 v87, s3, v4
    v_bfe_u32 v4, v1, 2, 1
    v_lshlrev_b32 v4, 11, v4
    v_lshl_add_u32 v4, v5, 7, v4
    s_and_b32 s3, s61, 14
    s_lshl_b32 s3, s3, 11
    s_and_b32 s4, s60, 12
    s_lshl_b32 s4, s4, 7
    s_add_u32 s3, s3, s4
    s_add_u32 s3, s3, 13631520
    v_add_u32 v4, s3, v4
    v_cmp_le_u32 vcc, 8, v1
    s_nop 1
    v_cndmask_b32 v87, v87, v4, vcc
    s_mul_i32 s3, s63, 200
    s_mul_i32 s4, s26, 50
    s_add_u32 s3, s3, s4
    v_add_u32 v4, s3, v1
    v_lshlrev_b32 v83, 7, v4
    v_subrev_u32 v4, 384, v0
    v_lshrrev_b32 v5, 1, v4
    s_mul_i32 s3, s63, 54
    v_add_u32 v5, s3, v5
    v_mul_u32_u24 v5, 1280, v5
    v_and_b32 v4, 1, v4
    v_lshl_add_u32 v5, v4, 7, v5
    s_and_b32 s3, s2, 7
    s_lshl_b32 s3, s3, 8
    v_add_u32 v10, s3, v5
    v_or_b32 v8, 32, v1
    v_lshlrev_b32 v8, 2, v8
    s_lshl_b32 s3, s60, 10
    s_add_u32 s35, s3, 13746176
    s_mov_b32 s44, s68
    s_and_b32 s45, s69, 0xffff
    s_mov_b32 s46, 819200
    s_mov_b32 s47, 0x00020000
    s_lshr_b32 s3, s26, 1
    s_mul_i32 s41, s3, 102400
    s_mul_i32 s40, s3, 10240
    s_and_b32 s3, s20, 1
    s_mul_i32 s3, s3, 1280
    s_add_u32 s40, s40, s3
    s_cmp_lg_u32 s20, 7
    s_cbranch_scc1 L_SW
    s_waitcnt vmcnt(0)
    v_max3_u32 v4, v244, v245, v246
    v_max_u32 v4, v4, v247
    v_cmp_eq_u32 vcc, -1, v4
    s_cbranch_vccz L_SP_OK
    s_mov_b32 s3, 0
L_SP:
    s_add_u32 s3, s3, 1
    s_cmp_gt_u32 s3, 2097152
    s_cbranch_scc1 L_END
    buffer_load_dwordx4 v[244:247], v26, s[16:19], s35 offen sc1
    s_waitcnt vmcnt(0)
    v_max3_u32 v4, v244, v245, v246
    v_max_u32 v4, v4, v247
    v_cmp_eq_u32 vcc, -1, v4
    s_cbranch_vccz L_SP_OK
    s_sleep 2
    s_branch L_SP
L_SP_OK:
    v_add_u32 v7, 61440, v26
    ds_write_b128 v7, v[244:247]
    s_waitcnt lgkmcnt(0)
L_SW:
    s_barrier
    s_cmp_lg_u32 s20, 7
    s_cbranch_scc1 L_LTAIL
    v_mov_b32 v9, 0
    v_cmp_gt_u32 vcc, 8, v9
    s_cbranch_vccz L_CLR_OK
    s_mov_b32 s3, 0
L_CLR:
    s_add_u32 s3, s3, 1
    s_cmp_gt_u32 s3, 2097152
    s_cbranch_scc1 L_END
    global_load_dword v9, v8, s[82:83] sc1
    s_waitcnt vmcnt(0)
    v_cmp_gt_u32 vcc, 8, v9
    s_cbranch_vccz L_CLR_OK
    s_sleep 2
    s_branch L_CLR
L_CLR_OK:
L_LTAIL:
    s_branch L_HOP
L_HELP:
    s_cmp_eq_u32 s27, 0
    s_cbranch_scc1 L_HOP
    v_mov_b32 v9, 0
    v_cmp_gt_u32 vcc, 8, v9
    s_cbranch_vccz L_CLRS_OK
    s_mov_b32 s3, 0
L_CLRS:
    s_add_u32 s3, s3, 1
    s_cmp_gt_u32 s3, 2097152
    s_cbranch_scc1 L_END
    global_load_dword v9, v8, s[82:83] sc1
    s_waitcnt vmcnt(0)
    v_cmp_gt_u32 vcc, 8, v9
    s_cbranch_vccz L_CLRS_OK
    s_sleep 20
    s_branch L_CLRS
L_CLRS_OK:
    s_branch L_LTAIL
L_HOP:
    s_mov_b32 s8, s68
    s_and_b32 s9, s69, 0xffff
    s_mov_b32 s10, 819200
    s_mov_b32 s11, 0x00020000
    s_and_b32 s31, s20, 1
    s_mul_i32 s31, s31, 1280
    s_mov_b32 s101, s59
    v_and_b32 v2, 31, v0
    v_lshrrev_b32 v3, 5, v1
    s_mul_i32 s3, s22, 163840
    s_lshl_b32 s4, s21, 2
    s_add_u32 s5, s4, s26
    s_mul_i32 s5, s5, 2560
    s_add_u32 s5, s5, s3
    v_lshl_add_u32 v4, v2, 4, s5
    s_mul_i32 s5, s27, 1536
    v_lshl_add_u32 v5, v3, 9, v4
    v_add_u32 v80, s5, v5
    s_lshl_b32 s5, s27, 3
    v_add_u32 v81, s5, v4
    v_mov_b32 v20, 0
    v_mov_b32 v21, 0
    s_sub_u32 s4, s4, 8
    s_mul_i32 s4, s4, 2560
    s_mul_i32 s5, s71, 10240
    s_add_u32 s4, s4, s5
    v_lshl_add_u32 v82, v1, 4, s4
    s_mul_i32 s6, s70, 30720
    s_add_u32 s71, s5, s6
    s_add_u32 s71, s71, 102400
    s_mul_i32 s6, s70, 2621440
    s_add_u32 s3, s3, s6
    s_add_u32 s3, s3, 2621440
    s_add_u32 s4, s84, s3
    s_addc_u32 s5, s85, 0
    s_mov_b32 s12, s4
    s_and_b32 s13, s5, 0xffff
    s_mov_b32 s14, 163840
    s_mov_b32 s15, 0x00020000
    v_and_b32 v4, 0x13, v2
    v_and_b32 v5, 4, v2
    v_lshl_or_b32 v4, v5, 1, v4
    v_and_b32 v5, 8, v2
    v_lshrrev_b32 v5, 1, v5
    v_or_b32 v4, v4, v5
    s_mul_i32 s3, s26, 2560
    s_add_u32 s3, s3, 102400
    s_mul_i32 s4, s27, 1536
    s_add_u32 s4, s4, s3
    v_lshlrev_b32 v5, 4, v4
    v_lshl_add_u32 v11, v3, 9, v5
    v_add_u32 v11, s4, v11
    s_lshl_b32 s4, s27, 3
    s_add_u32 s4, s4, s3
    s_add_u32 s4, s4, 1024
    v_add_u32 v12, s4, v5
    v_cmp_gt_u32 vcc, 20, v2
    s_nop 1
    v_cndmask_b32 v5, 0, v5, vcc
    v_mul_u32_u24 v6, 640, v3
    s_mul_i32 s4, s27, 320
    s_add_u32 s4, s4, s3
    s_add_u32 s4, s4, 30720
    v_add3_u32 v13, v5, v6, s4
    v_lshlrev_b32 v4, 3, v3
    v_sub_u32 v4, v2, v4
    v_mov_b32 v5, 0xffff
    v_mov_b32 v6, 0xffff0000
    v_cmp_gt_i32 s[32:33], 0, v4
    v_cmp_gt_i32 s[34:35], 1, v4
    v_cmp_gt_i32 s[36:37], 2, v4
    v_cmp_gt_i32 s[38:39], 3, v4
    v_cmp_gt_i32 s[40:41], 4, v4
    v_cmp_gt_i32 s[42:43], 5, v4
    v_cmp_gt_i32 s[44:45], 6, v4
    v_cmp_gt_i32 s[46:47], 7, v4
    v_cmp_gt_i32 s[48:49], 16, v4
    v_cmp_gt_i32 s[50:51], 17, v4
    v_cmp_gt_i32 s[52:53], 18, v4
    v_cmp_gt_i32 s[54:55], 19, v4
    v_cmp_gt_i32 s[56:57], 20, v4
    v_cmp_gt_i32 s[58:59], 21, v4
    v_cmp_gt_i32 s[60:61], 22, v4
    v_cmp_gt_i32 s[62:63], 23, v4
    v_cndmask_b32 v7, 0, v5, s[32:33]
    v_cndmask_b32 v8, 0, v6, s[34:35]
    v_or_b32 v88, v7, v8
    v_cndmask_b32 v7, 0, v5, s[36:37]
    v_cndmask_b32 v8, 0, v6, s[38:39]
    v_or_b32 v89, v7, v8
    v_cndmask_b32 v7, 0, v5, s[40:41]
    v_cndmask_b32 v8, 0, v6, s[42:43]
    v_or_b32 v90, v7, v8
    v_cndmask_b32 v7, 0, v5, s[44:45]
    v_cndmask_b32 v8, 0, v6, s[46:47]
    v_or_b32 v91, v7, v8
    v_cndmask_b32 v7, 0, v5, s[48:49]
    v_cndmask_b32 v8, 0, v6, s[50:51]
    v_or_b32 v92, v7, v8
    v_cndmask_b32 v7, 0, v5, s[52:53]
    v_cndmask_b32 v8, 0, v6, s[54:55]
    v_or_b32 v93, v7, v8
    v_cndmask_b32 v7, 0, v5, s[56:57]
    v_cndmask_b32 v8, 0, v6, s[58:59]
    v_or_b32 v94, v7, v8
    v_cndmask_b32 v7, 0, v5, s[60:61]
    v_cndmask_b32 v8, 0, v6, s[62:63]
    v_or_b32 v95, v7, v8
    v_mov_b32 v24, 0
    s_mov_b32 exec_lo, 0x11000000
    s_mov_b32 exec_hi, 0x11000000
    v_mov_b32 v24, 0x3f803f80
    s_mov_b64 exec, -1
    v_mov_b32 v25, v24
    v_mov_b32 v26, v24
    v_mov_b32 v27, v24
    v_mov_b32 v28, v24
    v_mov_b32 v29, v24
    v_mov_b32 v30, v24
    v_mov_b32 v31, v24
    v_mov_b32 v32, v24
    v_mov_b32 v33, v24
    v_mov_b32 v34, v24
    v_mov_b32 v35, v24
    v_mov_b32 v36, v24
    v_mov_b32 v37, v24
    v_mov_b32 v38, v24
    v_mov_b32 v39, v24
    v_mov_b32 v40, v24
    v_mov_b32 v41, v24
    v_mov_b32 v42, v24
    v_mov_b32 v43, v24
    v_mov_b32 v44, v24
    v_mov_b32 v45, v24
    v_mov_b32 v46, v24
    v_mov_b32 v47, v24
    v_mov_b32 v48, v24
    v_mov_b32 v49, v24
    v_mov_b32 v50, v24
    v_mov_b32 v51, v24
    v_mov_b32 v52, v24
    v_mov_b32 v53, v24
    v_mov_b32 v54, v24
    v_mov_b32 v55, v24
    s_lshl_b32 s3, s21, 2
    s_add_u32 s3, s3, s26
    s_sub_i32 s30, 8, s3
    s_mov_b32 s28, 0xfffff
    s_mov_b32 s29, 0xfffff
    s_lshr_b32 s4, s20, 1
    v_mov_b32 v6, s101
    v_mov_b32 v7, 1
    s_cmp_lg_u32 s4, 0
    s_cbranch_scc1 L_PR0
    s_mov_b64 exec, -1
    s_waitcnt vmcnt(0)
    s_branch L_PRD
L_PR0:
    s_cmp_lg_u32 s4, 1
    s_cbranch_scc1 L_PR1
    s_mov_b64 exec, -1
    s_waitcnt vmcnt(0)
    s_branch L_PRD
L_PR1:
    s_cmp_lg_u32 s4, 2
    s_cbranch_scc1 L_PR2
    s_mov_b32 exec_hi, 0xff
    s_add_u32 m0, s31, 40960
    s_mov_b32 s3, 0
    buffer_load_dwordx4 v23, s[8:11], s3 offen lds
    s_add_u32 m0, s31, 41600
    s_mov_b32 s3, 51200
    buffer_load_dwordx4 v23, s[8:11], s3 offen lds
    s_add_u32 m0, s31, 43520
    s_mov_b32 s3, 102400
    buffer_load_dwordx4 v23, s[8:11], s3 offen lds
    s_add_u32 m0, s31, 44160
    s_mov_b32 s3, 153600
    buffer_load_dwordx4 v23, s[8:11], s3 offen lds
    s_add_u32 m0, s31, 46080
    s_mov_b32 s3, 204800
    buffer_load_dwordx4 v23, s[8:11], s3 offen lds
    s_add_u32 m0, s31, 46720
    s_mov_b32 s3, 256000
    buffer_load_dwordx4 v23, s[8:11], s3 offen lds
    s_add_u32 m0, s31, 48640
    s_mov_b32 s3, 307200
    buffer_load_dwordx4 v23, s[8:11], s3 offen lds
    s_add_u32 m0, s31, 49280
    s_mov_b32 s3, 358400
    buffer_load_dwordx4 v23, s[8:11], s3 offen lds
    s_mov_b64 exec, -1
    s_waitcnt vmcnt(63)
    s_branch L_PRD
L_PR2:
    s_mov_b32 exec_hi, 0xff
    s_add_u32 m0, s31, 51200
    s_mov_b32 s3, 409600
    buffer_load_dwordx4 v22, s[8:11], s3 offen lds
    s_add_u32 m0, s31, 51840
    s_mov_b32 s3, 419840
    buffer_load_dwordx4 v22, s[8:11], s3 offen lds
    s_add_u32 m0, s31, 53760
    s_mov_b32 s3, 435200
    buffer_load_dwordx4 v22, s[8:11], s3 offen lds
    s_add_u32 m0, s31, 54400
    s_mov_b32 s3, 445440
    buffer_load_dwordx4 v22, s[8:11], s3 offen lds
    s_add_u32 m0, s31, 56320
    s_mov_b32 s3, 460800
    buffer_load_dwordx4 v22, s[8:11], s3 offen lds
    s_add_u32 m0, s31, 56960
    s_mov_b32 s3, 471040
    buffer_load_dwordx4 v22, s[8:11], s3 offen lds
    s_add_u32 m0, s31, 58880
    s_mov_b32 s3, 486400
    buffer_load_dwordx4 v22, s[8:11], s3 offen lds
    s_add_u32 m0, s31, 59520
    s_mov_b32 s3, 496640
    buffer_load_dwordx4 v22, s[8:11], s3 offen lds
    s_mov_b64 exec, -1
    s_waitcnt vmcnt(63)
L_PRD:
    s_barrier
    s_cmp_lg_u32 s20, 7
    s_cbranch_scc1 L_NOF1
    s_mov_b64 exec, 1
    buffer_store_dword v7, v6, s[16:19], 0 offen sc1
    s_mov_b64 exec, -1
L_NOF1:
    s_cmp_lg_u32 s4, 0
    s_cbranch_scc1 L_PO0
    s_mov_b32 exec_hi, 0xff
    s_add_u32 m0, s31, 0
    s_mov_b32 s3, 0
    buffer_load_dwordx4 v22, s[8:11], s3 offen lds
    s_add_u32 m0, s31, 640
    s_mov_b32 s3, 10240
    buffer_load_dwordx4 v22, s[8:11], s3 offen lds
    s_add_u32 m0, s31, 2560
    s_mov_b32 s3, 25600
    buffer_load_dwordx4 v22, s[8:11], s3 offen lds
    s_add_u32 m0, s31, 3200
    s_mov_b32 s3, 35840
    buffer_load_dwordx4 v22, s[8:11], s3 offen lds
    s_add_u32 m0, s31, 5120
    s_mov_b32 s3, 51200
    buffer_load_dwordx4 v22, s[8:11], s3 offen lds
    s_add_u32 m0, s31, 5760
    s_mov_b32 s3, 61440
    buffer_load_dwordx4 v22, s[8:11], s3 offen lds
    s_add_u32 m0, s31, 7680
    s_mov_b32 s3, 76800
    buffer_load_dwordx4 v22, s[8:11], s3 offen lds
    s_add_u32 m0, s31, 8320
    s_mov_b32 s3, 87040
    buffer_load_dwordx4 v22, s[8:11], s3 offen lds
    s_mov_b64 exec, -1
L_PO0:
    s_cmp_lg_u32 s4, 1
    s_cbranch_scc1 L_PO1
    s_mov_b32 exec_hi, 0xff
    s_add_u32 m0, s31, 10240
    s_mov_b32 s3, 102400
    buffer_load_dwordx4 v22, s[8:11], s3 offen lds
    s_add_u32 m0, s31, 10880
    s_mov_b32 s3, 112640
    buffer_load_dwordx4 v22, s[8:11], s3 offen lds
    s_add_u32 m0, s31, 12800
    s_mov_b32 s3, 128000
    buffer_load_dwordx4 v22, s[8:11], s3 offen lds
    s_add_u32 m0, s31, 13440
    s_mov_b32 s3, 138240
    buffer_load_dwordx4 v22, s[8:11], s3 offen lds
    s_add_u32 m0, s31, 15360
    s_mov_b32 s3, 153600
    buffer_load_dwordx4 v22, s[8:11], s3 offen lds
    s_add_u32 m0, s31, 16000
    s_mov_b32 s3, 163840
    buffer_load_dwordx4 v22, s[8:11], s3 offen lds
    s_add_u32 m0, s31, 17920
    s_mov_b32 s3, 179200
    buffer_load_dwordx4 v22, s[8:11], s3 offen lds
    s_add_u32 m0, s31, 18560
    s_mov_b32 s3, 189440
    buffer_load_dwordx4 v22, s[8:11], s3 offen lds
    s_mov_b64 exec, -1
L_PO1:
    s_cmp_lg_u32 s4, 2
    s_cbranch_scc1 L_PO2
    s_mov_b32 exec_hi, 0xff
    s_add_u32 m0, s31, 20480
    s_mov_b32 s3, 204800
    buffer_load_dwordx4 v22, s[8:11], s3 offen lds
    s_add_u32 m0, s31, 21120
    s_mov_b32 s3, 215040
    buffer_load_dwordx4 v22, s[8:11], s3 offen lds
    s_add_u32 m0, s31, 23040
    s_mov_b32 s3, 230400
    buffer_load_dwordx4 v22, s[8:11], s3 offen lds
    s_add_u32 m0, s31, 23680
    s_mov_b32 s3, 240640
    buffer_load_dwordx4 v22, s[8:11], s3 offen lds
    s_add_u32 m0, s31, 25600
    s_mov_b32 s3, 256000
    buffer_load_dwordx4 v22, s[8:11], s3 offen lds
    s_add_u32 m0, s31, 26240
    s_mov_b32 s3, 266240
    buffer_load_dwordx4 v22, s[8:11], s3 offen lds
    s_add_u32 m0, s31, 28160
    s_mov_b32 s3, 281600
    buffer_load_dwordx4 v22, s[8:11], s3 offen lds
    s_add_u32 m0, s31, 28800
    s_mov_b32 s3, 291840
    buffer_load_dwordx4 v22, s[8:11], s3 offen lds
    s_mov_b64 exec, -1
L_PO2:
    s_cmp_lg_u32 s4, 3
    s_cbranch_scc1 L_PO3
    s_mov_b32 exec_hi, 0xff
    s_add_u32 m0, s31, 30720
    s_mov_b32 s3, 307200
    buffer_load_dwordx4 v22, s[8:11], s3 offen lds
    s_add_u32 m0, s31, 31360
    s_mov_b32 s3, 317440
    buffer_load_dwordx4 v22, s[8:11], s3 offen lds
    s_add_u32 m0, s31, 33280
    s_mov_b32 s3, 332800
    buffer_load_dwordx4 v22, s[8:11], s3 offen lds
    s_add_u32 m0, s31, 33920
    s_mov_b32 s3, 343040
    buffer_load_dwordx4 v22, s[8:11], s3 offen lds
    s_add_u32 m0, s31, 35840
    s_mov_b32 s3, 358400
    buffer_load_dwordx4 v22, s[8:11], s3 offen lds
    s_add_u32 m0, s31, 36480
    s_mov_b32 s3, 368640
    buffer_load_dwordx4 v22, s[8:11], s3 offen lds
    s_add_u32 m0, s31, 38400
    s_mov_b32 s3, 384000
    buffer_load_dwordx4 v22, s[8:11], s3 offen lds
    s_add_u32 m0, s31, 39040
    s_mov_b32 s3, 394240
    buffer_load_dwordx4 v22, s[8:11], s3 offen lds
    s_mov_b64 exec, -1
L_PO3:
    s_cmp_ge_u32 s20, 6
    s_cbranch_scc1 L_WOH
    s_mov_b64 exec, 15
    s_mov_b32 s3, 0
L_F1POLL:
    s_add_u32 s3, s3, 1
    s_cmp_gt_u32 s3, 2097152
    s_cbranch_scc1 L_END
    buffer_load_dword v4, v85, s[16:19], 0 offen sc1
    s_waitcnt vmcnt(0)
    v_cmp_ne_u32 s[6:7], 1, v4
    s_nop 0
    s_and_b64 vcc, s[6:7], 3
    s_cbranch_vccz L_F1POLL_OK
    s_sleep 4
    s_branch L_F1POLL
L_F1POLL_OK:
    s_mov_b64 exec, -1
    s_add_u32 m0, s71, 0
    v_add_u32 v4, 0, v82
    buffer_load_dwordx4 v4, s[12:15], 0 offen offset:0 sc1 lds
    buffer_load_dwordx4 v4, s[12:15], 0 offen offset:1024 sc1 lds
    buffer_load_dwordx4 v4, s[12:15], 0 offen offset:2048 sc1 lds
    buffer_load_dwordx4 v4, s[12:15], 0 offen offset:3072 sc1 lds
    s_add_u32 m0, s71, 4096
    v_add_u32 v4, 4096, v82
    buffer_load_dwordx4 v4, s[12:15], 0 offen offset:0 sc1 lds
    buffer_load_dwordx4 v4, s[12:15], 0 offen offset:1024 sc1 lds
    buffer_load_dwordx4 v4, s[12:15], 0 offen offset:2048 sc1 lds
    buffer_load_dwordx4 v4, s[12:15], 0 offen offset:3072 sc1 lds
    s_add_u32 m0, s71, 8192
    v_add_u32 v4, 8192, v82
    buffer_load_dwordx4 v4, s[12:15], 0 offen offset:0 sc1 lds
    buffer_load_dwordx4 v4, s[12:15], 0 offen offset:1024 sc1 lds
    s_cmp_eq_u32 s6, 0
    s_cbranch_scc1 L_QPOLL_OK
L_WOH:
    s_mov_b64 exec, 12
    s_mov_b32 s3, 0
L_QPOLL:
    s_add_u32 s3, s3, 1
    s_cmp_gt_u32 s3, 2097152
    s_cbranch_scc1 L_END
    buffer_load_dword v4, v85, s[16:19], 0 offen sc1
    s_waitcnt vmcnt(0)
    v_cmp_ne_u32 vcc, 1, v4
    s_cbranch_vccz L_QPOLL_OK
    s_sleep 4
    s_branch L_QPOLL
L_QPOLL_OK:
    s_mov_b64 exec, -1
    buffer_load_dwordx4 v[16:19], v80, s[16:19], 0 offen sc1
    s_mov_b32 exec_hi, 0
    buffer_load_dwordx2 v[20:21], v81, s[16:19], 0 offen offset:1024 sc1
    s_mov_b64 exec, -1
    v_and_b32 v4, 15, v0
    v_bfe_u32 v5, v0, 4, 2
    s_lshl_b32 s3, s23, 6
    s_lshl_b32 s4, s26, 4
    s_add_u32 s3, s3, s4
    v_add_u32 v4, s3, v4
    v_mul_u32_u24 v4, 1280, v4
    v_mul_u32_u24 v5, 40, v5
    s_mul_i32 s3, s24, 160
    v_add_u32 v5, s3, v5
    v_add_u32 v4, v5, v4
    s_cmp_lg_u32 s27, 0
    s_cbranch_scc1 L_EL0_H
    s_branch L_EL0_D
L_EL0_H:
    v_lshlrev_b32 v4, 2, v1
    global_load_dword v224, v4, s[72:73] offset:0
    global_load_dword v225, v4, s[72:73] offset:256
    global_load_dword v226, v4, s[72:73] offset:512
    global_load_dword v227, v4, s[72:73] offset:768
    global_load_dword v228, v4, s[72:73] offset:1024
L_EL0_D:
    s_waitcnt vmcnt(0)
    s_barrier
    ds_read_b128 v[176:179], v11 offset:20480
    ds_read_b64 v[180:181], v12 offset:20480
    ds_read_b128 v[182:185], v11 offset:0
    ds_read_b64 v[186:187], v12 offset:0
    ds_read_b128 v[188:191], v11 offset:17920
    ds_read_b64 v[192:193], v12 offset:17920
    s_mov_b64 exec, s[28:29]
    ds_read_b128 v[24:27], v13 offset:20480
    ds_read_b128 v[28:31], v13 offset:21760
    s_mov_b64 exec, -1
    s_cmp_gt_i32 s30, 0
    s_cselect_b64 exec, -1, s[28:29]
    ds_read_b128 v[48:51], v13 offset:0
    ds_read_b128 v[52:55], v13 offset:1280
    s_mov_b64 exec, -1
    s_cmp_gt_i32 s30, 7
    s_cselect_b64 exec, -1, s[28:29]
    ds_read_b128 v[32:35], v13 offset:17920
    ds_read_b128 v[36:39], v13 offset:19200
    s_mov_b64 exec, -1
    s_waitcnt lgkmcnt(10)
    v_mfma_f32_32x32x16_bf16 v[128:143], v[176:179], v[16:19], 0
    v_mfma_f32_32x32x8_bf16 v[128:143], v[180:181], v[20:21], v[128:143]
    s_waitcnt lgkmcnt(8)
    v_mfma_f32_32x32x16_bf16 v[144:159], v[182:185], v[16:19], 0
    v_mfma_f32_32x32x8_bf16 v[144:159], v[186:187], v[20:21], v[144:159]
    ds_read_b128 v[176:179], v11 offset:15360
    ds_read_b64 v[180:181], v12 offset:15360
    v_and_b32 v4, 15, v0
    v_bfe_u32 v5, v0, 4, 2
    s_lshl_b32 s3, s23, 6
    s_lshl_b32 s4, s26, 4
    s_add_u32 s3, s3, s4
    v_add_u32 v4, s3, v4
    v_mul_u32_u24 v4, 1280, v4
    v_mul_u32_u24 v5, 40, v5
    s_mul_i32 s3, s24, 160
    v_add_u32 v5, s3, v5
    v_add_u32 v4, v5, v4
    s_cmp_lg_u32 s27, 0
    s_cbranch_scc1 L_EL_H
    global_load_dwordx4 v[224:227], v4, s[64:65]
    global_load_dwordx4 v[228:231], v4, s[64:65] offset:16
    global_load_dwordx2 v[232:233], v4, s[64:65] offset:32
    global_load_dwordx4 v[234:237], v5, s[72:73]
    global_load_dwordx4 v[238:241], v5, s[72:73] offset:16
    global_load_dwordx2 v[242:243], v5, s[72:73] offset:32
    s_branch L_EL_D
L_EL_H:
    v_lshlrev_b32 v4, 2, v1
L_EL_D:
    s_cmp_lg_u32 s27, 1
    s_cbranch_scc1 L_GUB
    s_cmp_ge_u32 s25, 32
    s_cbranch_scc1 L_GUB
    s_cmp_ge_u32 s26, 2
    s_cselect_b32 s4, s76, s74
    s_cselect_b32 s5, s77, s75
    s_and_b32 s3, s26, 1
    s_mul_i32 s3, s3, 138240
    v_add_u32 v4, s3, v86
    global_load_dwordx4 v[56:59], v4, s[4:5] nt
    v_add_u32 v4, 27648, v4
    global_load_dwordx4 v[60:63], v4, s[4:5] nt
    v_add_u32 v4, 27648, v4
    global_load_dwordx4 v[64:67], v4, s[4:5] nt
    v_add_u32 v4, 27648, v4
    global_load_dwordx4 v[68:71], v4, s[4:5] nt
    v_add_u32 v4, 27648, v4
    global_load_dwordx4 v[72:75], v4, s[4:5] nt
L_GUB:
    s_and_b32 s3, s2, 7
    s_cmp_lt_u32 s3, 5
    s_cselect_b32 s3, 108, 0
    v_subrev_u32 v4, 384, v0
    v_cmp_gt_u32 vcc, s3, v4
    s_nop 0
    s_and_saveexec_b64 s[6:7], vcc
    s_cbranch_execz L_TD
    global_load_dword v9, v10, s[78:79]
L_TD:
    s_mov_b64 exec, -1
    s_waitcnt lgkmcnt(8)
    v_mfma_f32_32x32x16_bf16 v[160:175], v[188:191], v[16:19], 0
    v_mfma_f32_32x32x8_bf16 v[160:175], v[192:193], v[20:21], v[160:175]
    ds_read_b128 v[182:185], v11 offset:12800
    ds_read_b64 v[186:187], v12 offset:12800
    v_cndmask_b32 v144, v128, v144, s[32:33]
    v_cndmask_b32 v145, v129, v145, s[34:35]
    v_cndmask_b32 v146, v130, v146, s[36:37]
    v_cndmask_b32 v147, v131, v147, s[38:39]
    v_cndmask_b32 v148, v132, v148, s[40:41]
    v_cndmask_b32 v149, v133, v149, s[42:43]
    v_cndmask_b32 v150, v134, v150, s[44:45]
    v_cndmask_b32 v151, v135, v151, s[46:47]
    v_cndmask_b32 v152, v136, v152, s[48:49]
    v_cndmask_b32 v153, v137, v153, s[50:51]
    v_cndmask_b32 v154, v138, v154, s[52:53]
    v_cndmask_b32 v155, v139, v155, s[54:55]
    v_cndmask_b32 v156, v140, v156, s[56:57]
    v_cndmask_b32 v157, v141, v157, s[58:59]
    v_cndmask_b32 v158, v142, v158, s[60:61]
    v_cndmask_b32 v159, v143, v159, s[62:63]
    v_exp_f32 v144, v144
    v_exp_f32 v145, v145
    v_exp_f32 v146, v146
    v_exp_f32 v147, v147
    s_waitcnt lgkmcnt(2)
    v_mfma_f32_32x32x16_bf16 v[128:143], v[176:179], v[16:19], 0
    v_exp_f32 v148, v148
    v_exp_f32 v149, v149
    v_exp_f32 v150, v150
    v_exp_f32 v151, v151
    v_mfma_f32_32x32x8_bf16 v[128:143], v[180:181], v[20:21], v[128:143]
    v_cvt_pk_bf16_f32 v200, v144, v145
    v_cvt_pk_bf16_f32 v201, v146, v147
    v_exp_f32 v152, v152
    v_exp_f32 v153, v153
    v_exp_f32 v154, v154
    v_exp_f32 v155, v155
    ds_read_b128 v[188:191], v11 offset:10240
    ds_read_b64 v[192:193], v12 offset:10240
    s_cmp_gt_i32 s30, 6
    s_cselect_b64 exec, -1, s[28:29]
    ds_read_b128 v[40:43], v13 offset:15360
    ds_read_b128 v[44:47], v13 offset:16640
    s_mov_b64 exec, -1
    v_cvt_pk_bf16_f32 v202, v148, v149
    v_cvt_pk_bf16_f32 v203, v150, v151
    v_exp_f32 v156, v156
    v_exp_f32 v157, v157
    v_exp_f32 v158, v158
    v_exp_f32 v159, v159
    v_cvt_pk_bf16_f32 v204, v152, v153
    v_cvt_pk_bf16_f32 v205, v154, v155
    v_cvt_pk_bf16_f32 v206, v156, v157
    v_cvt_pk_bf16_f32 v207, v158, v159
    v_and_b32 v216, v88, v200
    v_and_b32 v217, v89, v201
    v_and_b32 v218, v90, v202
    v_and_b32 v219, v91, v203
    v_and_b32 v220, v92, v204
    v_and_b32 v221, v93, v205
    v_and_b32 v222, v94, v206
    v_and_b32 v223, v95, v207
    v_xor_b32 v200, v216, v200
    v_xor_b32 v201, v217, v201
    v_xor_b32 v202, v218, v202
    v_xor_b32 v203, v219, v203
    v_xor_b32 v204, v220, v204
    v_xor_b32 v205, v221, v205
    v_xor_b32 v206, v222, v206
    v_xor_b32 v207, v223, v207
    v_mfma_f32_32x32x16_bf16 v[96:111], v[48:51], v[216:219], 0
    v_mfma_f32_32x32x16_bf16 v[96:111], v[52:55], v[220:223], v[96:111]
    v_exp_f32 v160, v160
    v_exp_f32 v161, v161
    v_exp_f32 v162, v162
    v_exp_f32 v163, v163
    s_waitcnt lgkmcnt(0)
    v_mfma_f32_32x32x16_bf16 v[96:111], v[24:27], v[200:203], v[96:111]
    v_exp_f32 v164, v164
    v_exp_f32 v165, v165
    v_exp_f32 v166, v166
    v_exp_f32 v167, v167
    v_mfma_f32_32x32x16_bf16 v[96:111], v[28:31], v[204:207], v[96:111]
    v_cvt_pk_bf16_f32 v208, v160, v161
    v_cvt_pk_bf16_f32 v209, v162, v163
    v_exp_f32 v168, v168
    v_exp_f32 v169, v169
    v_exp_f32 v170, v170
    v_exp_f32 v171, v171
    v_mfma_f32_32x32x16_bf16 v[144:159], v[182:185], v[16:19], 0
    v_cvt_pk_bf16_f32 v210, v164, v165
    v_cvt_pk_bf16_f32 v211, v166, v167
    v_exp_f32 v172, v172
    v_exp_f32 v173, v173
    v_exp_f32 v174, v174
    v_exp_f32 v175, v175
    v_mfma_f32_32x32x8_bf16 v[144:159], v[186:187], v[20:21], v[144:159]
    v_cvt_pk_bf16_f32 v212, v168, v169
    v_cvt_pk_bf16_f32 v213, v170, v171
    v_cvt_pk_bf16_f32 v214, v172, v173
    v_cvt_pk_bf16_f32 v215, v174, v175
    ds_read_b128 v[176:179], v11 offset:7680
    ds_read_b64 v[180:181], v12 offset:7680
    s_cmp_gt_i32 s30, 5
    s_cselect_b64 exec, -1, s[28:29]
    ds_read_b128 v[24:27], v13 offset:12800
    ds_read_b128 v[28:31], v13 offset:14080
    s_mov_b64 exec, -1
    v_exp_f32 v128, v128
    v_exp_f32 v129, v129
    v_exp_f32 v130, v130
    v_exp_f32 v131, v131
    s_waitcnt lgkmcnt(0)
    v_mfma_f32_32x32x16_bf16 v[96:111], v[32:35], v[208:211], v[96:111]
    v_exp_f32 v132, v132
    v_exp_f32 v133, v133
    v_exp_f32 v134, v134
    v_exp_f32 v135, v135
    v_mfma_f32_32x32x16_bf16 v[96:111], v[36:39], v[212:215], v[96:111]
    v_cvt_pk_bf16_f32 v200, v128, v129
    v_cvt_pk_bf16_f32 v201, v130, v131
    v_exp_f32 v136, v136
    v_exp_f32 v137, v137
    v_exp_f32 v138, v138
    v_exp_f32 v139, v139
    v_mfma_f32_32x32x16_bf16 v[160:175], v[188:191], v[16:19], 0
    v_cvt_pk_bf16_f32 v202, v132, v133
    v_cvt_pk_bf16_f32 v203, v134, v135
    v_exp_f32 v140, v140
    v_exp_f32 v141, v141
    v_exp_f32 v142, v142
    v_exp_f32 v143, v143
    v_mfma_f32_32x32x8_bf16 v[160:175], v[192:193], v[20:21], v[160:175]
    v_cvt_pk_bf16_f32 v204, v136, v137
    v_cvt_pk_bf16_f32 v205, v138, v139
    v_cvt_pk_bf16_f32 v206, v140, v141
    v_cvt_pk_bf16_f32 v207, v142, v143
    ds_read_b128 v[182:185], v11 offset:5120
    ds_read_b64 v[186:187], v12 offset:5120
    s_cmp_gt_i32 s30, 4
    s_cselect_b64 exec, -1, s[28:29]
    ds_read_b128 v[32:35], v13 offset:10240
    ds_read_b128 v[36:39], v13 offset:11520
    s_mov_b64 exec, -1
    v_exp_f32 v144, v144
    v_exp_f32 v145, v145
    v_exp_f32 v146, v146
    v_exp_f32 v147, v147
    s_waitcnt lgkmcnt(0)
    v_mfma_f32_32x32x16_bf16 v[96:111], v[40:43], v[200:203], v[96:111]
    v_exp_f32 v148, v148
    v_exp_f32 v149, v149
    v_exp_f32 v150, v150
    v_exp_f32 v151, v151
    v_mfma_f32_32x32x16_bf16 v[96:111], v[44:47], v[204:207], v[96:111]
    v_cvt_pk_bf16_f32 v208, v144, v145
    v_cvt_pk_bf16_f32 v209, v146, v147
    v_exp_f32 v152, v152
    v_exp_f32 v153, v153
    v_exp_f32 v154, v154
    v_exp_f32 v155, v155
    v_mfma_f32_32x32x16_bf16 v[128:143], v[176:179], v[16:19], 0
    v_cvt_pk_bf16_f32 v210, v148, v149
    v_cvt_pk_bf16_f32 v211, v150, v151
    v_exp_f32 v156, v156
    v_exp_f32 v157, v157
    v_exp_f32 v158, v158
    v_exp_f32 v159, v159
    v_mfma_f32_32x32x8_bf16 v[128:143], v[180:181], v[20:21], v[128:143]
    v_cvt_pk_bf16_f32 v212, v152, v153
    v_cvt_pk_bf16_f32 v213, v154, v155
    v_cvt_pk_bf16_f32 v214, v156, v157
    v_cvt_pk_bf16_f32 v215, v158, v159
    ds_read_b128 v[188:191], v11 offset:2560
    ds_read_b64 v[192:193], v12 offset:2560
    s_cmp_gt_i32 s30, 3
    s_cselect_b64 exec, -1, s[28:29]
    ds_read_b128 v[40:43], v13 offset:7680
    ds_read_b128 v[44:47], v13 offset:8960
    s_mov_b64 exec, -1
    v_exp_f32 v160, v160
    v_exp_f32 v161, v161
    v_exp_f32 v162, v162
    v_exp_f32 v163, v163
    s_waitcnt lgkmcnt(0)
    v_mfma_f32_32x32x16_bf16 v[96:111], v[24:27], v[208:211], v[96:111]
    v_exp_f32 v164, v164
    v_exp_f32 v165, v165
    v_exp_f32 v166, v166
    v_exp_f32 v167, v167
    v_mfma_f32_32x32x16_bf16 v[96:111], v[28:31], v[212:215], v[96:111]
    v_cvt_pk_bf16_f32 v200, v160, v161
    v_cvt_pk_bf16_f32 v201, v162, v163
    v_exp_f32 v168, v168
    v_exp_f32 v169, v169
    v_exp_f32 v170, v170
    v_exp_f32 v171, v171
    v_mfma_f32_32x32x16_bf16 v[144:159], v[182:185], v[16:19], 0
    v_cvt_pk_bf16_f32 v202, v164, v165
    v_cvt_pk_bf16_f32 v203, v166, v167
    v_exp_f32 v172, v172
    v_exp_f32 v173, v173
    v_exp_f32 v174, v174
    v_exp_f32 v175, v175
    v_mfma_f32_32x32x8_bf16 v[144:159], v[186:187], v[20:21], v[144:159]
    v_cvt_pk_bf16_f32 v204, v168, v169
    v_cvt_pk_bf16_f32 v205, v170, v171
    v_cvt_pk_bf16_f32 v206, v172, v173
    v_cvt_pk_bf16_f32 v207, v174, v175
    s_cmp_gt_i32 s30, 2
    s_cselect_b64 exec, -1, s[28:29]
    ds_read_b128 v[24:27], v13 offset:5120
    ds_read_b128 v[28:31], v13 offset:6400
    s_mov_b64 exec, -1
    v_exp_f32 v128, v128
    v_exp_f32 v129, v129
    v_exp_f32 v130, v130
    v_exp_f32 v131, v131
    s_waitcnt lgkmcnt(0)
    v_mfma_f32_32x32x16_bf16 v[96:111], v[32:35], v[200:203], v[96:111]
    v_exp_f32 v132, v132
    v_exp_f32 v133, v133
    v_exp_f32 v134, v134
    v_exp_f32 v135, v135
    v_mfma_f32_32x32x16_bf16 v[96:111], v[36:39], v[204:207], v[96:111]
    v_cvt_pk_bf16_f32 v208, v128, v129
    v_cvt_pk_bf16_f32 v209, v130, v131
    v_exp_f32 v136, v136
    v_exp_f32 v137, v137
    v_exp_f32 v138, v138
    v_exp_f32 v139, v139
    v_mfma_f32_32x32x16_bf16 v[160:175], v[188:191], v[16:19], 0
    v_cvt_pk_bf16_f32 v210, v132, v133
    v_cvt_pk_bf16_f32 v211, v134, v135
    v_exp_f32 v140, v140
    v_exp_f32 v141, v141
    v_exp_f32 v142, v142
    v_exp_f32 v143, v143
    v_mfma_f32_32x32x8_bf16 v[160:175], v[192:193], v[20:21], v[160:175]
    v_cvt_pk_bf16_f32 v212, v136, v137
    v_cvt_pk_bf16_f32 v213, v138, v139
    v_cvt_pk_bf16_f32 v214, v140, v141
    v_cvt_pk_bf16_f32 v215, v142, v143
    s_cmp_gt_i32 s30, 1
    s_cselect_b64 exec, -1, s[28:29]
    ds_read_b128 v[32:35], v13 offset:2560
    ds_read_b128 v[36:39], v13 offset:3840
    s_mov_b64 exec, -1
    v_exp_f32 v144, v144
    v_exp_f32 v145, v145
    v_exp_f32 v146, v146
    v_exp_f32 v147, v147
    s_waitcnt lgkmcnt(0)
    v_mfma_f32_32x32x16_bf16 v[96:111], v[40:43], v[208:211], v[96:111]
    v_exp_f32 v148, v148
    v_exp_f32 v149, v149
    v_exp_f32 v150, v150
    v_exp_f32 v151, v151
    v_mfma_f32_32x32x16_bf16 v[96:111], v[44:47], v[212:215], v[96:111]
    v_cvt_pk_bf16_f32 v200, v144, v145
    v_cvt_pk_bf16_f32 v201, v146, v147
    v_exp_f32 v152, v152
    v_exp_f32 v153, v153
    v_exp_f32 v154, v154
    v_exp_f32 v155, v155
    v_cvt_pk_bf16_f32 v202, v148, v149
    v_cvt_pk_bf16_f32 v203, v150, v151
    v_exp_f32 v156, v156
    v_exp_f32 v157, v157
    v_exp_f32 v158, v158
    v_exp_f32 v159, v159
    v_cvt_pk_bf16_f32 v204, v152, v153
    v_cvt_pk_bf16_f32 v205, v154, v155
    v_cvt_pk_bf16_f32 v206, v156, v157
    v_cvt_pk_bf16_f32 v207, v158, v159
    v_exp_f32 v160, v160
    v_exp_f32 v161, v161
    v_exp_f32 v162, v162
    v_exp_f32 v163, v163
    s_waitcnt lgkmcnt(0)
    v_mfma_f32_32x32x16_bf16 v[96:111], v[24:27], v[200:203], v[96:111]
    v_exp_f32 v164, v164
    v_exp_f32 v165, v165
    v_exp_f32 v166, v166
    v_exp_f32 v167, v167
    v_mfma_f32_32x32x16_bf16 v[96:111], v[28:31], v[204:207], v[96:111]
    v_cvt_pk_bf16_f32 v208, v160, v161
    v_cvt_pk_bf16_f32 v209, v162, v163
    v_exp_f32 v168, v168
    v_exp_f32 v169, v169
    v_exp_f32 v170, v170
    v_exp_f32 v171, v171
    v_cvt_pk_bf16_f32 v210, v164, v165
    v_cvt_pk_bf16_f32 v211, v166, v167
    v_exp_f32 v172, v172
    v_exp_f32 v173, v173
    v_exp_f32 v174, v174
    v_exp_f32 v175, v175
    v_cvt_pk_bf16_f32 v212, v168, v169
    v_cvt_pk_bf16_f32 v213, v170, v171
    v_cvt_pk_bf16_f32 v214, v172, v173
    v_cvt_pk_bf16_f32 v215, v174, v175
    s_waitcnt lgkmcnt(0)
    v_mfma_f32_32x32x16_bf16 v[96:111], v[32:35], v[208:211], v[96:111]
    v_mfma_f32_32x32x16_bf16 v[96:111], v[36:39], v[212:215], v[96:111]
    s_nop 11
    v_max3_f32 v4, abs(v96), abs(v97), abs(v98)
    v_max3_f32 v5, abs(v99), abs(v100), abs(v101)
    v_max3_f32 v4, abs(v102), abs(v103), v4
    v_max3_f32 v5, abs(v104), abs(v105), v5
    v_max3_f32 v4, abs(v106), abs(v107), v4
    v_max_f32 v4, v4, v5
    v_cmp_nlt_f32 vcc, 0x21800000, v108
    s_nop 0
    s_mov_b64 s[4:5], vcc
    v_cmp_ngt_f32 vcc, 0x5d800000, v108
    s_nop 0
    s_or_b64 s[4:5], s[4:5], vcc
    v_cmp_ngt_f32 vcc, 0x7b800000, v4
    s_nop 0
    s_or_b64 vcc, s[4:5], vcc
    s_cbranch_vccnz L_FALLBACK
L_BDONE:
    v_rcp_f32 v4, v108
    s_nop 0
    v_pk_mul_f32 v[96:97], v[96:97], v[4:5] op_sel_hi:[1,0]
    v_pk_mul_f32 v[98:99], v[98:99], v[4:5] op_sel_hi:[1,0]
    v_pk_mul_f32 v[100:101], v[100:101], v[4:5] op_sel_hi:[1,0]
    v_pk_mul_f32 v[102:103], v[102:103], v[4:5] op_sel_hi:[1,0]
    v_pk_mul_f32 v[104:105], v[104:105], v[4:5] op_sel_hi:[1,0]
    v_pk_mul_f32 v[106:107], v[106:107], v[4:5] op_sel_hi:[1,0]
    v_cvt_pk_bf16_f32 v24, v96, v97
    v_cvt_pk_bf16_f32 v25, v98, v99
    v_cvt_pk_bf16_f32 v26, v100, v101
    v_cvt_pk_bf16_f32 v27, v102, v103
    v_cvt_pk_bf16_f32 v28, v104, v105
    v_cvt_pk_bf16_f32 v29, v106, v107
    buffer_store_dwordx4 v[24:27], v14, s[16:19], 0 offen sc1
    s_mov_b32 exec_hi, 0
    buffer_store_dwordx2 v[28:29], v15, s[16:19], 0 offen sc1
    s_mov_b64 exec, -1
    s_lshr_b32 s4, s20, 1
    s_mov_b32 exec_hi, 0xff
    s_cmp_lg_u32 s4, 0
    s_cbranch_scc1 L_EW0
    s_add_u32 m0, s31, 61440
    s_mov_b32 s3, 512000
    buffer_load_dwordx4 v22, s[8:11], s3 offen lds
    s_add_u32 m0, s31, 62080
    s_mov_b32 s3, 522240
    buffer_load_dwordx4 v22, s[8:11], s3 offen lds
    s_add_u32 m0, s31, 64000
    s_mov_b32 s3, 537600
    buffer_load_dwordx4 v22, s[8:11], s3 offen lds
    s_add_u32 m0, s31, 64640
    s_mov_b32 s3, 547840
    buffer_load_dwordx4 v22, s[8:11], s3 offen lds
    s_add_u32 m0, s31, 66560
    s_mov_b32 s3, 563200
    buffer_load_dwordx4 v22, s[8:11], s3 offen lds
    s_add_u32 m0, s31, 67200
    s_mov_b32 s3, 573440
    buffer_load_dwordx4 v22, s[8:11], s3 offen lds
    s_add_u32 m0, s31, 69120
    s_mov_b32 s3, 588800
    buffer_load_dwordx4 v22, s[8:11], s3 offen lds
    s_add_u32 m0, s31, 69760
    s_mov_b32 s3, 599040
    buffer_load_dwordx4 v22, s[8:11], s3 offen lds
    s_add_u32 m0, s31, 81920
    s_mov_b32 s3, 716800
    buffer_load_dwordx4 v22, s[8:11], s3 offen lds
    s_add_u32 m0, s31, 82560
    s_mov_b32 s3, 727040
    buffer_load_dwordx4 v22, s[8:11], s3 offen lds
    s_add_u32 m0, s31, 84480
    s_mov_b32 s3, 742400
    buffer_load_dwordx4 v22, s[8:11], s3 offen lds
    s_add_u32 m0, s31, 85120
    s_mov_b32 s3, 752640
    buffer_load_dwordx4 v22, s[8:11], s3 offen lds
    s_add_u32 m0, s31, 87040
    s_mov_b32 s3, 768000
    buffer_load_dwordx4 v22, s[8:11], s3 offen lds
    s_add_u32 m0, s31, 87680
    s_mov_b32 s3, 778240
    buffer_load_dwordx4 v22, s[8:11], s3 offen lds
    s_add_u32 m0, s31, 89600
    s_mov_b32 s3, 793600
    buffer_load_dwordx4 v22, s[8:11], s3 offen lds
    s_add_u32 m0, s31, 90240
    s_mov_b32 s3, 803840
    buffer_load_dwordx4 v22, s[8:11], s3 offen lds
L_EW0:
    s_cmp_lg_u32 s4, 1
    s_cbranch_scc1 L_EW1
    s_add_u32 m0, s31, 71680
    s_mov_b32 s3, 614400
    buffer_load_dwordx4 v22, s[8:11], s3 offen lds
    s_add_u32 m0, s31, 72320
    s_mov_b32 s3, 624640
    buffer_load_dwordx4 v22, s[8:11], s3 offen lds
    s_add_u32 m0, s31, 74240
    s_mov_b32 s3, 640000
    buffer_load_dwordx4 v22, s[8:11], s3 offen lds
    s_add_u32 m0, s31, 74880
    s_mov_b32 s3, 650240
    buffer_load_dwordx4 v22, s[8:11], s3 offen lds
    s_add_u32 m0, s31, 76800
    s_mov_b32 s3, 665600
    buffer_load_dwordx4 v22, s[8:11], s3 offen lds
    s_add_u32 m0, s31, 77440
    s_mov_b32 s3, 675840
    buffer_load_dwordx4 v22, s[8:11], s3 offen lds
    s_add_u32 m0, s31, 79360
    s_mov_b32 s3, 691200
    buffer_load_dwordx4 v22, s[8:11], s3 offen lds
    s_add_u32 m0, s31, 80000
    s_mov_b32 s3, 701440
    buffer_load_dwordx4 v22, s[8:11], s3 offen lds
    s_add_u32 m0, s31, 92160
    s_mov_b32 s3, 409600
    buffer_load_dwordx4 v23, s[8:11], s3 offen lds
    s_add_u32 m0, s31, 92800
    s_mov_b32 s3, 460800
    buffer_load_dwordx4 v23, s[8:11], s3 offen lds
    s_add_u32 m0, s31, 94720
    s_mov_b32 s3, 512000
    buffer_load_dwordx4 v23, s[8:11], s3 offen lds
    s_add_u32 m0, s31, 95360
    s_mov_b32 s3, 563200
    buffer_load_dwordx4 v23, s[8:11], s3 offen lds
    s_add_u32 m0, s31, 97280
    s_mov_b32 s3, 614400
    buffer_load_dwordx4 v23, s[8:11], s3 offen lds
    s_add_u32 m0, s31, 97920
    s_mov_b32 s3, 665600
    buffer_load_dwordx4 v23, s[8:11], s3 offen lds
    s_add_u32 m0, s31, 99840
    s_mov_b32 s3, 716800
    buffer_load_dwordx4 v23, s[8:11], s3 offen lds
    s_add_u32 m0, s31, 100480
    s_mov_b32 s3, 768000
    buffer_load_dwordx4 v23, s[8:11], s3 offen lds
L_EW1:
    s_mov_b64 exec, -1
    v_mov_b32 v19, v87
    v_and_b32 v2, 15, v0
    v_lshrrev_b32 v3, 4, v1
    s_lshl_b32 s3, s23, 6
    s_lshl_b32 s4, s26, 4
    s_add_u32 s3, s3, s4
    v_add_u32 v20, s3, v2
    v_mul_u32_u24 v4, 1280, v20
    v_mul_u32_u24 v17, 40, v3
    s_mul_i32 s3, s24, 160
    v_add3_u32 v16, v17, v4, s3
    v_bfe_u32 v21, v1, 2, 2
    v_and_b32 v5, 1, v3
    v_lshl_or_b32 v21, v5, 2, v21
    v_lshrrev_b32 v5, 1, v3
    v_lshl_or_b32 v21, v5, 4, v21
    v_mul_u32_u24 v4, 160, v21
    v_and_b32 v5, 3, v1
    v_lshlrev_b32 v21, 5, v21
    v_lshl_add_u32 v21, v5, 3, v21
    v_mul_u32_u24 v5, 40, v5
    s_mul_i32 s3, s27, 51200
    v_add3_u32 v18, v4, v5, s3
    s_lshl_b32 s3, s23, 1
    s_lshr_b32 s4, s26, 1
    s_add_u32 s3, s3, s4
    s_mul_i32 s3, s3, 40960
    s_add_u32 s3, s3, 7864320
    s_lshl_b32 s4, s27, 14
    s_add_u32 s29, s3, s4
    s_lshl_b32 s4, s27, 12
    s_add_u32 s33, s3, s4
    s_add_u32 s33, s33, 32768
    s_and_b32 s4, s26, 1
    s_lshl_b32 s4, s4, 4
    v_add_u32 v4, s4, v2
    v_lshlrev_b32 v5, 9, v3
    v_lshl_add_u32 v15, v4, 4, v5
    v_lshl_add_u32 v14, v4, 3, v5
    s_lshl_b32 s30, s25, 3
    s_add_u32 s30, s30, s24
    s_lshl_b32 s32, s20, 10
    s_mul_i32 s3, s26, 5120
    s_add_u32 s34, s3, 133120
    v_lshl_add_u32 v13, v1, 4, s34
    s_lshl_b32 s3, s23, 13
    s_lshl_b32 s4, s26, 8
    s_add_u32 s3, s3, s4
    s_add_u32 s37, s3, 12582912
    v_lshlrev_b32 v10, 4, v2
    s_add_u32 s3, s24, 0
    s_and_b32 s3, s3, 7
    s_lshl_b32 s4, s3, 11
    s_add_u32 s40, s29, s4
    s_mul_i32 s4, s3, 5120
    v_add_u32 v246, s4, v18
    s_add_u32 s3, s24, 1
    s_and_b32 s3, s3, 7
    s_lshl_b32 s4, s3, 11
    s_add_u32 s41, s29, s4
    s_mul_i32 s4, s3, 5120
    v_add_u32 v247, s4, v18
    s_add_u32 s3, s24, 2
    s_and_b32 s3, s3, 7
    s_lshl_b32 s4, s3, 11
    s_add_u32 s42, s29, s4
    s_mul_i32 s4, s3, 5120
    v_add_u32 v248, s4, v18
    s_add_u32 s3, s24, 3
    s_and_b32 s3, s3, 7
    s_lshl_b32 s4, s3, 11
    s_add_u32 s43, s29, s4
    s_mul_i32 s4, s3, 5120
    v_add_u32 v249, s4, v18
    s_add_u32 s3, s24, 4
    s_and_b32 s3, s3, 7
    s_lshl_b32 s4, s3, 11
    s_add_u32 s44, s29, s4
    s_mul_i32 s4, s3, 5120
    v_add_u32 v250, s4, v18
    s_add_u32 s3, s24, 5
    s_and_b32 s3, s3, 7
    s_lshl_b32 s4, s3, 11
    s_add_u32 s45, s29, s4
    s_mul_i32 s4, s3, 5120
    v_add_u32 v251, s4, v18
    s_add_u32 s3, s24, 6
    s_and_b32 s3, s3, 7
    s_lshl_b32 s4, s3, 11
    s_add_u32 s46, s29, s4
    s_mul_i32 s4, s3, 5120
    v_add_u32 v252, s4, v18
    s_add_u32 s3, s24, 7
    s_and_b32 s3, s3, 7
    s_lshl_b32 s4, s3, 11
    s_add_u32 s47, s29, s4
    s_mul_i32 s4, s3, 5120
    v_add_u32 v253, s4, v18
    s_waitcnt vmcnt(18)
    v_mov_b32 v76, 0
    v_mov_b32 v77, 0
    v_mov_b32 v78, 0
    v_mov_b32 v79, 0
    v_mov_b32 v80, 0
    v_mov_b32 v81, 0
    v_mov_b32 v82, 0
    v_mov_b32 v83, 0
    v_mov_b32 v84, 0
    v_mov_b32 v85, 0
    v_mov_b32 v86, 0
    v_mov_b32 v87, 0
    v_mov_b32 v88, 0
    v_mov_b32 v89, 0
    v_mov_b32 v90, 0
    v_mov_b32 v91, 0
    s_cmp_lg_u32 s27, 0
    s_cbranch_scc1 L_CB
    v_lshlrev_b32 v72, 16, v224
    v_and_b32 v73, 0xffff0000, v224
    v_lshlrev_b32 v196, 16, v234
    v_and_b32 v197, 0xffff0000, v234
    v_lshlrev_b32 v74, 16, v225
    v_and_b32 v75, 0xffff0000, v225
    v_lshlrev_b32 v198, 16, v235
    v_and_b32 v199, 0xffff0000, v235
    v_lshlrev_b32 v76, 16, v226
    v_and_b32 v77, 0xffff0000, v226
    v_lshlrev_b32 v200, 16, v236
    v_and_b32 v201, 0xffff0000, v236
    v_lshlrev_b32 v78, 16, v227
    v_and_b32 v79, 0xffff0000, v227
    v_lshlrev_b32 v202, 16, v237
    v_and_b32 v203, 0xffff0000, v237
    v_lshlrev_b32 v80, 16, v228
    v_and_b32 v81, 0xffff0000, v228
    v_lshlrev_b32 v204, 16, v238
    v_and_b32 v205, 0xffff0000, v238
    v_lshlrev_b32 v82, 16, v229
    v_and_b32 v83, 0xffff0000, v229
    v_lshlrev_b32 v206, 16, v239
    v_and_b32 v207, 0xffff0000, v239
    v_lshlrev_b32 v84, 16, v230
    v_and_b32 v85, 0xffff0000, v230
    v_lshlrev_b32 v208, 16, v240
    v_and_b32 v209, 0xffff0000, v240
    v_lshlrev_b32 v86, 16, v231
    v_and_b32 v87, 0xffff0000, v231
    v_lshlrev_b32 v210, 16, v241
    v_and_b32 v211, 0xffff0000, v241
    v_lshlrev_b32 v88, 16, v232
    v_and_b32 v89, 0xffff0000, v232
    v_lshlrev_b32 v212, 16, v242
    v_and_b32 v213, 0xffff0000, v242
    v_lshlrev_b32 v90, 16, v233
    v_and_b32 v91, 0xffff0000, v233
    v_lshlrev_b32 v214, 16, v243
    v_and_b32 v215, 0xffff0000, v243
    s_waitcnt vmcnt(16)
    s_branch L_CB2
L_CB:
    s_waitcnt vmcnt(0)
L_CB2:
    v_mov_b32 v4, s101
    v_mov_b32 v5, 1
    s_barrier
    s_cmp_lg_u32 s20, 7
    s_cbranch_scc1 L_NOF2
    s_mov_b64 exec, 1
    buffer_store_dword v5, v4, s[16:19], 0 offen offset:32 sc1
    s_mov_b64 exec, -1
L_NOF2:
    v_mov_b32 v22, v19
    s_cmp_ge_u32 s25, 32
    s_cbranch_scc1 L_NORP
    s_cmp_lg_u32 s27, 1
    s_cbranch_scc1 L_NORP
    s_mul_i32 s3, s25, 163840
    s_mul_i32 s4, s24, 1280
    s_add_u32 s3, s3, s4
    s_lshr_b32 s4, s26, 1
    s_mul_i32 s4, s4, 10240
    s_add_u32 s3, s3, s4
    s_and_b32 s4, s26, 1
    s_mul_i32 s4, s4, 640
    s_add_u32 s3, s3, s4
    s_add_u32 s3, s3, 13762560
    v_lshrrev_b32 v8, 3, v1
    v_mul_u32_u24 v8, 20352, v8
    v_lshl_add_u32 v8, v1, 4, v8
    v_and_b32 v4, 7, v1
    v_lshrrev_b32 v5, 3, v1
    v_lshl_add_u32 v4, v4, 3, v5
    v_lshlrev_b32 v4, 2, v4
    s_waitcnt vmcnt(63) lgkmcnt(0)
    ds_bpermute_b32 v56, v4, v56
    ds_bpermute_b32 v57, v4, v57
    ds_bpermute_b32 v58, v4, v58
    ds_bpermute_b32 v59, v4, v59
    ds_bpermute_b32 v60, v4, v60
    ds_bpermute_b32 v61, v4, v61
    ds_bpermute_b32 v62, v4, v62
    ds_bpermute_b32 v63, v4, v63
    ds_bpermute_b32 v64, v4, v64
    ds_bpermute_b32 v65, v4, v65
    ds_bpermute_b32 v66, v4, v66
    ds_bpermute_b32 v67, v4, v67
    ds_bpermute_b32 v68, v4, v68
    ds_bpermute_b32 v69, v4, v69
    ds_bpermute_b32 v70, v4, v70
    ds_bpermute_b32 v71, v4, v71
    ds_bpermute_b32 v72, v4, v72
    ds_bpermute_b32 v73, v4, v73
    ds_bpermute_b32 v74, v4, v74
    ds_bpermute_b32 v75, v4, v75
    s_waitcnt lgkmcnt(0)
    buffer_store_dwordx4 v[56:59], v8, s[16:19], s3 offen offset:0 sc1
    buffer_store_dwordx4 v[60:63], v8, s[16:19], s3 offen offset:128 sc1
    buffer_store_dwordx4 v[64:67], v8, s[16:19], s3 offen offset:256 sc1
    buffer_store_dwordx4 v[68:71], v8, s[16:19], s3 offen offset:384 sc1
    buffer_store_dwordx4 v[72:75], v8, s[16:19], s3 offen offset:512 sc1
L_NORP:
    s_cmp_eq_u32 s27, 0
    s_cbranch_scc1 L_NZ
    v_mov_b32 v72, 0
    v_mov_b32 v73, 0
    v_mov_b32 v74, 0
    v_mov_b32 v75, 0
    s_branch L_NZ2
L_NZ:
    s_waitcnt vmcnt(0)
L_NZ2:
    s_barrier
    s_cmp_lt_u32 s25, 32
    s_cbranch_scc1 L_NWD1
    s_sub_u32 s3, s30, 256
    s_lshl_b32 s3, s3, 5
    v_lshrrev_b32 v5, 1, v1
    v_and_b32 v6, 0x13, v5
    v_and_b32 v4, 4, v5
    v_lshl_or_b32 v6, v4, 1, v6
    v_and_b32 v4, 8, v5
    v_lshrrev_b32 v4, 1, v4
    v_or_b32 v6, v6, v4
    v_mul_u32_u24 v6, 1280, v6
    v_and_b32 v4, 1, v1
    v_lshl_add_u32 v6, v4, 4, v6
    v_add_u32 v6, s3, v6
    s_mul_i32 s4, s20, 40960
    s_mov_b32 s12, s78
    s_and_b32 s13, s79, 0xffff
    s_mov_b32 s14, 2211840
    s_mov_b32 s15, 0x00020000
    s_add_u32 m0, s32, 102400
    s_add_u32 s3, s4, 0
    buffer_load_dwordx4 v6, s[12:15], s3 offen lds
    s_add_u32 m0, s32, 110592
    s_add_u32 s3, s4, 327680
    buffer_load_dwordx4 v6, s[12:15], s3 offen lds
    s_add_u32 m0, s32, 153600
    s_add_u32 s3, s4, 655360
    buffer_load_dwordx4 v6, s[12:15], s3 offen lds
L_NWD1:
    ds_read_b64_tr_b16 v[92:93], v246 offset:0
    ds_read_b64_tr_b16 v[94:95], v246 offset:1280
    ds_read_b64_tr_b16 v[96:97], v246 offset:8
    ds_read_b64_tr_b16 v[98:99], v246 offset:1288
    ds_read_b64_tr_b16 v[100:101], v246 offset:16
    ds_read_b64_tr_b16 v[102:103], v246 offset:1296
    ds_read_b64_tr_b16 v[104:105], v246 offset:24
    ds_read_b64_tr_b16 v[106:107], v246 offset:1304
    ds_read_b64_tr_b16 v[108:109], v246 offset:32
    ds_read_b64_tr_b16 v[110:111], v246 offset:1312
    ds_read_b64_tr_b16 v[112:113], v247 offset:0
    ds_read_b64_tr_b16 v[114:115], v247 offset:1280
    ds_read_b64_tr_b16 v[116:117], v247 offset:8
    ds_read_b64_tr_b16 v[118:119], v247 offset:1288
    ds_read_b64_tr_b16 v[120:121], v247 offset:16
    ds_read_b64_tr_b16 v[122:123], v247 offset:1296
    ds_read_b64_tr_b16 v[124:125], v247 offset:24
    ds_read_b64_tr_b16 v[126:127], v247 offset:1304
    ds_read_b64_tr_b16 v[128:129], v247 offset:32
    ds_read_b64_tr_b16 v[130:131], v247 offset:1312
    ds_read_b64_tr_b16 v[132:133], v248 offset:0
    ds_read_b64_tr_b16 v[134:135], v248 offset:1280
    ds_read_b64_tr_b16 v[136:137], v248 offset:8
    ds_read_b64_tr_b16 v[138:139], v248 offset:1288
    ds_read_b64_tr_b16 v[140:141], v248 offset:16
    ds_read_b64_tr_b16 v[142:143], v248 offset:1296
    ds_read_b64_tr_b16 v[144:145], v248 offset:24
    ds_read_b64_tr_b16 v[146:147], v248 offset:1304
    ds_read_b64_tr_b16 v[148:149], v248 offset:32
    ds_read_b64_tr_b16 v[150:151], v248 offset:1312
    ds_read_b64_tr_b16 v[152:153], v249 offset:0
    ds_read_b64_tr_b16 v[154:155], v249 offset:1280
    ds_read_b64_tr_b16 v[156:157], v249 offset:8
    ds_read_b64_tr_b16 v[158:159], v249 offset:1288
    ds_read_b64_tr_b16 v[160:161], v249 offset:16
    ds_read_b64_tr_b16 v[162:163], v249 offset:1296
    ds_read_b64_tr_b16 v[164:165], v249 offset:24
    ds_read_b64_tr_b16 v[166:167], v249 offset:1304
    ds_read_b64_tr_b16 v[168:169], v249 offset:32
    ds_read_b64_tr_b16 v[170:171], v249 offset:1312
    s_mov_b64 exec, 0xff
    s_mov_b32 s3, 0
L_F2POLL:
    s_add_u32 s3, s3, 1
    s_cmp_gt_u32 s3, 2097152
    s_cbranch_scc1 L_END
    buffer_load_dword v4, v22, s[16:19], 0 offen sc1
    s_waitcnt vmcnt(0)
    v_cmp_ne_u32 s[56:57], 1, v4
    s_nop 0
    s_and_b64 vcc, s[56:57], 0xff
    s_cbranch_vccz L_F2POLL_OK
    s_sleep 4
    s_branch L_F2POLL
L_F2POLL_OK:
    s_mov_b64 exec, -1
    s_mov_b32 s56, 1
    buffer_load_dwordx4 v[32:35], v15, s[16:19], s40 offen sc1
    buffer_load_dwordx4 v[36:39], v15, s[16:19], s41 offen sc1
    buffer_load_dwordx4 v[40:43], v15, s[16:19], s42 offen sc1
    buffer_load_dwordx4 v[44:47], v15, s[16:19], s43 offen sc1
    buffer_load_dwordx4 v[48:51], v15, s[16:19], s44 offen sc1
    buffer_load_dwordx4 v[52:55], v15, s[16:19], s45 offen sc1
    buffer_load_dwordx4 v[56:59], v15, s[16:19], s46 offen sc1
    buffer_load_dwordx4 v[60:63], v15, s[16:19], s47 offen sc1
    buffer_load_dwordx2 v[64:65], v14, s[16:19], s33 offen offset:0 sc1
    buffer_load_dwordx2 v[66:67], v14, s[16:19], s33 offen offset:256 sc1
    buffer_load_dwordx2 v[68:69], v14, s[16:19], s33 offen offset:2048 sc1
    buffer_load_dwordx2 v[70:71], v14, s[16:19], s33 offen offset:2304 sc1
    s_waitcnt vmcnt(11) lgkmcnt(0)
    v_mfma_f32_16x16x32_bf16 v[72:75], v[92:95], v[32:35], v[72:75]
    v_mfma_f32_16x16x32_bf16 v[76:79], v[96:99], v[32:35], v[76:79]
    v_mfma_f32_16x16x32_bf16 v[80:83], v[100:103], v[32:35], v[80:83]
    v_mfma_f32_16x16x32_bf16 v[84:87], v[104:107], v[32:35], v[84:87]
    v_mfma_f32_16x16x32_bf16 v[88:91], v[108:111], v[32:35], v[88:91]
    s_waitcnt vmcnt(10) lgkmcnt(10)
    ds_read_b64_tr_b16 v[92:93], v250 offset:0
    ds_read_b64_tr_b16 v[94:95], v250 offset:1280
    v_mfma_f32_16x16x32_bf16 v[72:75], v[112:115], v[36:39], v[72:75]
    ds_read_b64_tr_b16 v[96:97], v250 offset:8
    ds_read_b64_tr_b16 v[98:99], v250 offset:1288
    v_mfma_f32_16x16x32_bf16 v[76:79], v[116:119], v[36:39], v[76:79]
    ds_read_b64_tr_b16 v[100:101], v250 offset:16
    ds_read_b64_tr_b16 v[102:103], v250 offset:1296
    v_mfma_f32_16x16x32_bf16 v[80:83], v[120:123], v[36:39], v[80:83]
    ds_read_b64_tr_b16 v[104:105], v250 offset:24
    ds_read_b64_tr_b16 v[106:107], v250 offset:1304
    v_mfma_f32_16x16x32_bf16 v[84:87], v[124:127], v[36:39], v[84:87]
    ds_read_b64_tr_b16 v[108:109], v250 offset:32
    ds_read_b64_tr_b16 v[110:111], v250 offset:1312
    v_mfma_f32_16x16x32_bf16 v[88:91], v[128:131], v[36:39], v[88:91]
    s_waitcnt vmcnt(9) lgkmcnt(10)
    ds_read_b64_tr_b16 v[112:113], v251 offset:0
    ds_read_b64_tr_b16 v[114:115], v251 offset:1280
    v_mfma_f32_16x16x32_bf16 v[72:75], v[132:135], v[40:43], v[72:75]
    ds_read_b64_tr_b16 v[116:117], v251 offset:8
    ds_read_b64_tr_b16 v[118:119], v251 offset:1288
    v_mfma_f32_16x16x32_bf16 v[76:79], v[136:139], v[40:43], v[76:79]
    ds_read_b64_tr_b16 v[120:121], v251 offset:16
    ds_read_b64_tr_b16 v[122:123], v251 offset:1296
    v_mfma_f32_16x16x32_bf16 v[80:83], v[140:143], v[40:43], v[80:83]
    ds_read_b64_tr_b16 v[124:125], v251 offset:24
    ds_read_b64_tr_b16 v[126:127], v251 offset:1304
    v_mfma_f32_16x16x32_bf16 v[84:87], v[144:147], v[40:43], v[84:87]
    ds_read_b64_tr_b16 v[128:129], v251 offset:32
    ds_read_b64_tr_b16 v[130:131], v251 offset:1312
    v_mfma_f32_16x16x32_bf16 v[88:91], v[148:151], v[40:43], v[88:91]
    s_waitcnt vmcnt(8) lgkmcnt(10)
    ds_read_b64_tr_b16 v[132:133], v252 offset:0
    ds_read_b64_tr_b16 v[134:135], v252 offset:1280
    v_mfma_f32_16x16x32_bf16 v[72:75], v[152:155], v[44:47], v[72:75]
    ds_read_b64_tr_b16 v[136:137], v252 offset:8
    ds_read_b64_tr_b16 v[138:139], v252 offset:1288
    v_mfma_f32_16x16x32_bf16 v[76:79], v[156:159], v[44:47], v[76:79]
    ds_read_b64_tr_b16 v[140:141], v252 offset:16
    ds_read_b64_tr_b16 v[142:143], v252 offset:1296
    v_mfma_f32_16x16x32_bf16 v[80:83], v[160:163], v[44:47], v[80:83]
    ds_read_b64_tr_b16 v[144:145], v252 offset:24
    ds_read_b64_tr_b16 v[146:147], v252 offset:1304
    v_mfma_f32_16x16x32_bf16 v[84:87], v[164:167], v[44:47], v[84:87]
    ds_read_b64_tr_b16 v[148:149], v252 offset:32
    ds_read_b64_tr_b16 v[150:151], v252 offset:1312
    v_mfma_f32_16x16x32_bf16 v[88:91], v[168:171], v[44:47], v[88:91]
    s_waitcnt vmcnt(7) lgkmcnt(10)
    ds_read_b64_tr_b16 v[152:153], v253 offset:0
    ds_read_b64_tr_b16 v[154:155], v253 offset:1280
    v_mfma_f32_16x16x32_bf16 v[72:75], v[92:95], v[48:51], v[72:75]
    ds_read_b64_tr_b16 v[156:157], v253 offset:8
    ds_read_b64_tr_b16 v[158:159], v253 offset:1288
    v_mfma_f32_16x16x32_bf16 v[76:79], v[96:99], v[48:51], v[76:79]
    ds_read_b64_tr_b16 v[160:161], v253 offset:16
    ds_read_b64_tr_b16 v[162:163], v253 offset:1296
    v_mfma_f32_16x16x32_bf16 v[80:83], v[100:103], v[48:51], v[80:83]
    ds_read_b64_tr_b16 v[164:165], v253 offset:24
    ds_read_b64_tr_b16 v[166:167], v253 offset:1304
    v_mfma_f32_16x16x32_bf16 v[84:87], v[104:107], v[48:51], v[84:87]
    ds_read_b64_tr_b16 v[168:169], v253 offset:32
    ds_read_b64_tr_b16 v[170:171], v253 offset:1312
    v_mfma_f32_16x16x32_bf16 v[88:91], v[108:111], v[48:51], v[88:91]
    s_waitcnt vmcnt(6) lgkmcnt(10)
    ds_read_b64_tr_b16 v[92:93], v18 offset:40960
    ds_read_b64_tr_b16 v[94:95], v18 offset:42240
    v_mfma_f32_16x16x32_bf16 v[72:75], v[112:115], v[52:55], v[72:75]
    ds_read_b64_tr_b16 v[96:97], v18 offset:40968
    ds_read_b64_tr_b16 v[98:99], v18 offset:42248
    v_mfma_f32_16x16x32_bf16 v[76:79], v[116:119], v[52:55], v[76:79]
    ds_read_b64_tr_b16 v[100:101], v18 offset:40976
    ds_read_b64_tr_b16 v[102:103], v18 offset:42256
    v_mfma_f32_16x16x32_bf16 v[80:83], v[120:123], v[52:55], v[80:83]
    ds_read_b64_tr_b16 v[104:105], v18 offset:40984
    ds_read_b64_tr_b16 v[106:107], v18 offset:42264
    v_mfma_f32_16x16x32_bf16 v[84:87], v[124:127], v[52:55], v[84:87]
    ds_read_b64_tr_b16 v[108:109], v18 offset:40992
    ds_read_b64_tr_b16 v[110:111], v18 offset:42272
    v_mfma_f32_16x16x32_bf16 v[88:91], v[128:131], v[52:55], v[88:91]
    s_waitcnt vmcnt(5) lgkmcnt(10)
    ds_read_b64_tr_b16 v[112:113], v18 offset:46080
    ds_read_b64_tr_b16 v[114:115], v18 offset:47360
    v_mfma_f32_16x16x32_bf16 v[72:75], v[132:135], v[56:59], v[72:75]
    ds_read_b64_tr_b16 v[116:117], v18 offset:46088
    ds_read_b64_tr_b16 v[118:119], v18 offset:47368
    v_mfma_f32_16x16x32_bf16 v[76:79], v[136:139], v[56:59], v[76:79]
    ds_read_b64_tr_b16 v[120:121], v18 offset:46096
    ds_read_b64_tr_b16 v[122:123], v18 offset:47376
    v_mfma_f32_16x16x32_bf16 v[80:83], v[140:143], v[56:59], v[80:83]
    ds_read_b64_tr_b16 v[124:125], v18 offset:46104
    ds_read_b64_tr_b16 v[126:127], v18 offset:47384
    v_mfma_f32_16x16x32_bf16 v[84:87], v[144:147], v[56:59], v[84:87]
    ds_read_b64_tr_b16 v[128:129], v18 offset:46112
    ds_read_b64_tr_b16 v[130:131], v18 offset:47392
    v_mfma_f32_16x16x32_bf16 v[88:91], v[148:151], v[56:59], v[88:91]
    s_waitcnt vmcnt(4) lgkmcnt(10)
    v_mfma_f32_16x16x32_bf16 v[72:75], v[152:155], v[60:63], v[72:75]
    v_mfma_f32_16x16x32_bf16 v[76:79], v[156:159], v[60:63], v[76:79]
    v_mfma_f32_16x16x32_bf16 v[80:83], v[160:163], v[60:63], v[80:83]
    v_mfma_f32_16x16x32_bf16 v[84:87], v[164:167], v[60:63], v[84:87]
    v_mfma_f32_16x16x32_bf16 v[88:91], v[168:171], v[60:63], v[88:91]
    s_waitcnt vmcnt(2) lgkmcnt(10)
    v_mfma_f32_16x16x32_bf16 v[72:75], v[92:95], v[64:67], v[72:75]
    v_mfma_f32_16x16x32_bf16 v[76:79], v[96:99], v[64:67], v[76:79]
    v_mfma_f32_16x16x32_bf16 v[80:83], v[100:103], v[64:67], v[80:83]
    v_mfma_f32_16x16x32_bf16 v[84:87], v[104:107], v[64:67], v[84:87]
    v_mfma_f32_16x16x32_bf16 v[88:91], v[108:111], v[64:67], v[88:91]
    s_waitcnt vmcnt(0) lgkmcnt(0)
    v_mfma_f32_16x16x32_bf16 v[72:75], v[112:115], v[68:71], v[72:75]
    v_mfma_f32_16x16x32_bf16 v[76:79], v[116:119], v[68:71], v[76:79]
    v_mfma_f32_16x16x32_bf16 v[80:83], v[120:123], v[68:71], v[80:83]
    v_mfma_f32_16x16x32_bf16 v[84:87], v[124:127], v[68:71], v[84:87]
    v_mfma_f32_16x16x32_bf16 v[88:91], v[128:131], v[68:71], v[88:91]
L_CDONE2:
    s_cmp_lg_u32 s27, 0
    s_cbranch_scc0 L_CLO
    s_nop 1
    ds_write_b128 v13, v[72:75] offset:0
    ds_write_b128 v13, v[76:79] offset:1024
    ds_write_b128 v13, v[80:83] offset:2048
    ds_write_b128 v13, v[84:87] offset:3072
    ds_write_b128 v13, v[88:91] offset:4096
    v_mov_b32 v24, 0
    v_mov_b32 v25, 0
    v_mov_b32 v26, 0
    v_mov_b32 v27, 0
    s_waitcnt lgkmcnt(0)
    s_barrier
    s_setprio 0
    v_and_b32 v12, 255, v0
    v_lshlrev_b32 v12, 4, v12
    v_add_u32 v14, 122880, v12
    ds_write_b128 v14, v[24:27] offset:0
    ds_write_b128 v14, v[24:27] offset:4096
    v_lshl_add_u32 v11, v3, 10, v10
    s_add_u32 s38, s37, 4096
    s_add_u32 s39, s37, 262144
    s_add_u32 s35, s37, 266240
    v_mov_b32 v8, 0
    v_lshlrev_b32 v5, 16, v224
    v_and_b32 v6, 0xffff0000, v224
    v_add_f32 v8, v8, v5
    v_add_f32 v8, v8, v6
    v_lshlrev_b32 v5, 16, v225
    v_and_b32 v6, 0xffff0000, v225
    v_add_f32 v8, v8, v5
    v_add_f32 v8, v8, v6
    v_lshlrev_b32 v5, 16, v226
    v_and_b32 v6, 0xffff0000, v226
    v_add_f32 v8, v8, v5
    v_add_f32 v8, v8, v6
    v_lshlrev_b32 v5, 16, v227
    v_and_b32 v6, 0xffff0000, v227
    v_add_f32 v8, v8, v5
    v_add_f32 v8, v8, v6
    v_lshlrev_b32 v5, 16, v228
    v_and_b32 v6, 0xffff0000, v228
    v_add_f32 v8, v8, v5
    v_add_f32 v8, v8, v6
    s_nop 1
    v_add_f32_dpp v8, v8, v8 row_shr:1 row_mask:0xf bank_mask:0xf
    s_nop 1
    v_add_f32_dpp v8, v8, v8 row_shr:2 row_mask:0xf bank_mask:0xf
    s_nop 1
    v_add_f32_dpp v8, v8, v8 row_shr:4 row_mask:0xf bank_mask:0xf
    s_nop 1
    v_add_f32_dpp v8, v8, v8 row_shr:8 row_mask:0xf bank_mask:0xf
    s_nop 1
    v_add_f32_dpp v8, v8, v8 row_bcast:15 row_mask:0xa bank_mask:0xf
    s_nop 1
    v_add_f32_dpp v8, v8, v8 row_bcast:31 row_mask:0xc bank_mask:0xf
    s_nop 0
    v_readlane_b32 s36, v8, 63
    v_sub_u32 v23, 2047, v20
    v_lshlrev_b32 v23, 2, v23
    s_lshl_b32 s3, s23, 2
    s_add_u32 s3, s3, s26
    s_lshl_b32 s3, s3, 7
    s_add_u32 s4, s3, 13697024
    s_lshl_b32 s3, s26, 8
    s_add_u32 s3, s3, 131584
    v_lshl_add_u32 v9, v2, 4, s3
    s_mov_b32 s6, 0xffffe000
    v_lshlrev_b32 v12, 7, v1
    s_barrier
    s_mov_b32 s3, 0
L_PPOLL:
    s_add_u32 s3, s3, 1
    s_cmp_gt_u32 s3, 2097152
    s_cbranch_scc1 L_END
    buffer_load_dwordx4 v[64:67], v11, s[16:19], s37 offen sc1
    buffer_load_dwordx4 v[68:71], v11, s[16:19], s38 offen sc1
    s_waitcnt vmcnt(0)
    v_max3_u32 v5, v64, v65, v66
    v_max3_u32 v6, v68, v69, v70
    v_max_u32 v5, v5, v6
    v_cmp_eq_u32 vcc, -1, v5
    s_cbranch_vccz L_PPOLL_OK
    s_and_b32 s28, s3, 15
    s_cmp_lg_u32 s28, 0
    s_cbranch_scc1 L_PPOLL
    buffer_load_dwordx4 v[64:67], v11, s[16:19], s39 offen sc1
    buffer_load_dwordx4 v[68:71], v11, s[16:19], s35 offen sc1
    s_waitcnt vmcnt(0)
    v_max3_u32 v5, v64, v65, v66
    v_max3_u32 v6, v68, v69, v70
    v_max_u32 v5, v5, v6
    v_cmp_eq_u32 vcc, -1, v5
    s_cbranch_vccnz L_PPOLL
L_PPOLL_OK:
    v_add_f32 v40, v64, v68
    v_add_f32 v41, v65, v69
    v_add_f32 v42, v66, v70
    v_mov_b32 v44, v40
    v_mov_b32 v45, v41
    v_mov_b32 v46, v42
    v_permlane16_swap_b32 v40, v44
    v_permlane16_swap_b32 v41, v45
    v_permlane16_swap_b32 v42, v46
    v_add_f32 v40, v40, v44
    v_add_f32 v41, v41, v45
    v_add_f32 v42, v42, v46
    v_mov_b32 v44, v40
    v_mov_b32 v45, v41
    v_mov_b32 v46, v42
    v_permlane32_swap_b32 v40, v44
    v_permlane32_swap_b32 v41, v45
    v_permlane32_swap_b32 v42, v46
    v_add_f32 v40, v40, v44
    v_add_f32 v41, v41, v45
    v_add_f32 v42, v42, v46
    v_mul_f32 v40, 0x3acccccd, v40
    v_mul_f32 v41, 0x3acccccd, v41
    v_fma_f32 v41, -v40, v40, v41
    v_max_f32 v41, 0, v41
    v_cvt_pk_bf16_f32 v41, v40, v41
    v_lshlrev_b32 v40, 16, v41
    v_and_b32 v41, 0xffff0000, v41
    v_add_f32 v41, 0x3727c5ac, v41
    v_cvt_pk_bf16_f32 v41, v41, v41
    v_lshlrev_b32 v41, 16, v41
    v_sqrt_f32 v41, v41
    s_nop 0
    v_cvt_pk_bf16_f32 v41, v41, v41
    v_lshlrev_b32 v41, 16, v41
    v_rcp_f32 v41, v41
    v_fma_f32 v42, -v40, s36, v42
    v_mul_f32 v42, v42, v41
    v_ashrrev_i32 v4, 31, v42
    v_or_b32 v4, 0x80000000, v4
    v_xor_b32 v4, v4, v42
    v_and_or_b32 v4, v4, s6, v23
    v_min_u32 v42, -2, v42
    v_mov_b32 v5, v4
    v_mov_b32 v7, 0
    s_nop 0
    v_mov_b32_dpp v5, v4 row_ror:4 row_mask:0x2 bank_mask:0xf
    s_nop 1
    v_mov_b32_dpp v5, v4 row_ror:8 row_mask:0x4 bank_mask:0xf
    s_nop 1
    v_mov_b32_dpp v5, v4 row_ror:12 row_mask:0x8 bank_mask:0xf
    s_nop 1
    v_mov_b32_dpp v44, v5 row_ror:1 row_mask:0xf bank_mask:0xf
    v_mov_b32_dpp v45, v5 row_ror:2 row_mask:0xf bank_mask:0xf
    v_mov_b32_dpp v46, v5 row_ror:3 row_mask:0xf bank_mask:0xf
    v_cmp_gt_u32 s[40:41], v5, v4
    v_cmp_gt_u32 s[42:43], v44, v4
    v_cmp_gt_u32 s[44:45], v45, v4
    v_cmp_gt_u32 s[46:47], v46, v4
    v_addc_co_u32 v7, vcc, 0, v7, s[40:41]
    v_addc_co_u32 v7, vcc, 0, v7, s[42:43]
    v_addc_co_u32 v7, vcc, 0, v7, s[44:45]
    v_addc_co_u32 v7, vcc, 0, v7, s[46:47]
    v_mov_b32 v6, v7
    s_nop 1
    v_permlane16_swap_b32 v7, v6
    v_add_u32 v7, v7, v6
    v_mov_b32 v6, v7
    s_nop 1
    v_permlane32_swap_b32 v7, v6
    v_add_u32 v7, v7, v6
    v_min_u32 v6, 2, v7
    v_or_b32 v43, v4, v6
    v_lshlrev_b32 v7, 2, v7
    s_mov_b64 exec, 0xffff
    s_cmp_lg_u32 s24, 0
    s_cbranch_scc1 L_NOKEY
    buffer_store_dword v43, v7, s[16:19], s4 offen sc1
L_NOKEY:
    ds_write_b128 v9, v[40:43]
    s_mov_b64 exec, -1
    s_waitcnt lgkmcnt(0)
    s_barrier
    s_cmp_lg_u32 s20, 7
    s_cbranch_scc1 L_SELW
    v_and_b32 v150, 7, v1
    v_lshlrev_b32 v150, 2, v150
    v_add_u32 v150, 131264, v150
    v_lshrrev_b32 v4, 3, v1
    v_lshlrev_b32 v153, 8, v4
    v_lshlrev_b32 v4, 2, v4
    v_add_u32 v151, 131264, v4
    v_bfe_u32 v4, v1, 1, 3
    v_lshlrev_b32 v154, 8, v4
    v_lshlrev_b32 v4, 2, v4
    v_add_u32 v152, 131264, v4
    v_bfe_u32 v4, v1, 4, 1
    v_mul_u32_u24 v6, 2560, v4
    v_lshlrev_b32 v7, 4, v2
    v_sub_u32 v160, 135680, v6
    v_add_u32 v160, v160, v7
    s_lshl_b32 s3, s24, 11
    s_lshl_b32 s4, s20, 8
    s_add_u32 s3, s3, s4
    s_add_u32 s3, s3, 13664256
    v_lshl_add_u32 v161, v4, 14, v7
    v_add_u32 v161, s3, v161
    s_lshl_b32 s3, s20, 11
    s_sub_u32 s3, s3, s4
    s_add_u32 s3, s3, 557056
    v_add_u32 v153, s3, v153
    v_add_u32 v154, s3, v154
    s_add_u32 s58, s4, 13107200
    v_and_b32 v4, 7, v1
    v_lshlrev_b32 v155, 4, v4
    v_and_b32 v4, 1, v1
    v_lshlrev_b32 v156, 4, v4
    v_add_u32 v156, 128, v156
    v_mov_b32 v157, 131264
    s_mul_i32 s59, s20, 1280
    s_add_u32 s5, s59, 102400
    s_add_u32 s59, s59, 77824
    v_and_b32 v4, 7, v2
    v_lshlrev_b32 v6, 4, v3
    v_lshl_add_u32 v158, v4, 7, v6
    v_add_u32 v158, s59, v158
    v_and_b32 v6, 16, v6
    v_lshl_add_u32 v159, v4, 5, v6
    v_add_u32 v159, s59, v159
    v_bfe_u32 v4, v1, 2, 2
    v_lshl_add_u32 v4, v3, 3, v4
    v_lshlrev_b32 v4, 4, v4
    v_and_b32 v6, 1, v1
    v_lshl_add_u32 v4, v6, 3, v4
    v_bfe_u32 v6, v1, 1, 1
    v_mul_u32_u24 v6, 10240, v6
    v_add3_u32 v162, v4, v6, s5
    s_add_u32 s3, s32, 65536
    v_lshl_add_u32 v163, v1, 4, s3
    s_mov_b32 s8, s80
    s_and_b32 s9, s81, 0xffff
    s_mov_b32 s10, 2621440
    s_mov_b32 s11, 0x00020000
    s_mov_b32 s4, 13697024
    s_mov_b32 s5, 13705216
    s_mov_b32 s28, 122880
    s_mov_b32 s29, 0
    v_and_b32 v13, 31, v1
    v_lshlrev_b32 v13, 2, v13
    v_add_u32 v13, 122880, v13
    v_lshrrev_b32 v8, 5, v1
    v_lshlrev_b32 v8, 6, v8
    v_add_u32 v11, 122880, v8
L_KQ:
    s_mov_b32 s3, 0
L_KPOLL:
    s_add_u32 s3, s3, 1
    s_cmp_gt_u32 s3, 2097152
    s_cbranch_scc1 L_END
    buffer_load_dwordx4 v[40:43], v12, s[16:19], s4 offen sc1
    buffer_load_dwordx4 v[44:47], v12, s[16:19], s5 offen sc1
    s_waitcnt vmcnt(0)
    v_max3_u32 v4, v41, v42, v43
    v_max3_u32 v5, v45, v46, v47
    v_max_u32 v6, v40, v44
    v_max3_u32 v4, v4, v5, v6
    v_cmp_eq_u32 vcc, -1, v4
    s_cbranch_vccz L_KPOLL_OK
    s_sleep 1
    s_branch L_KPOLL
L_KPOLL_OK:
    s_cmp_lg_u32 s29, 0
    s_cbranch_scc1 L_HAVET
    v_mov_b32 v7, v6
    v_max_u32_dpp v6, v6, v6 quad_perm:[1,0,3,2] row_mask:0xf bank_mask:0xf
    s_nop 0
    v_max_u32_dpp v7, v7, v7 row_ror:8 row_mask:0xf bank_mask:0xf
    v_max_u32_dpp v6, v6, v6 quad_perm:[2,3,0,1] row_mask:0xf bank_mask:0xf
    v_mov_b32 v8, v7
    s_nop 0
    v_max_u32_dpp v6, v6, v6 row_half_mirror row_mask:0xf bank_mask:0xf
    v_permlane16_swap_b32 v7, v8
    s_nop 0
    v_min_u32_dpp v6, v6, v6 row_ror:8 row_mask:0xf bank_mask:0xf
    v_max_u32 v7, v7, v8
    v_mov_b32 v5, v6
    v_mov_b32 v8, v7
    s_nop 0
    v_permlane16_swap_b32 v6, v5
    v_permlane32_swap_b32 v7, v8
    v_min_u32 v6, v6, v5
    v_max_u32 v7, v7, v8
    v_mov_b32 v5, v6
    s_nop 0
    v_min_u32_dpp v7, v7, v7 quad_perm:[1,0,3,2] row_mask:0xf bank_mask:0xf
    v_permlane32_swap_b32 v6, v5
    s_nop 0
    v_min_u32_dpp v7, v7, v7 quad_perm:[2,3,0,1] row_mask:0xf bank_mask:0xf
    v_min_u32 v6, v6, v5
    s_nop 0
    v_min_u32_dpp v7, v7, v7 row_half_mirror row_mask:0xf bank_mask:0xf
    v_max_u32 v48, v6, v7
L_HAVET:
    v_cmp_ge_u32 s[40:41], v40, v48
    v_cmp_ge_u32 s[48:49], v44, v48
    v_cmp_ge_u32 s[42:43], v41, v48
    v_cmp_ge_u32 s[50:51], v45, v48
    v_cmp_ge_u32 s[44:45], v42, v48
    v_cmp_ge_u32 s[52:53], v46, v48
    v_cmp_ge_u32 s[46:47], v43, v48
    v_cmp_ge_u32 s[54:55], v47, v48
    v_mbcnt_lo_u32_b32 v50, s40, 0
    v_mbcnt_lo_u32_b32 v54, s48, 0
    v_mbcnt_lo_u32_b32 v51, s42, 0
    v_mbcnt_lo_u32_b32 v55, s50, 0
    v_mbcnt_lo_u32_b32 v52, s44, 0
    v_mbcnt_lo_u32_b32 v56, s52, 0
    v_mbcnt_lo_u32_b32 v53, s46, 0
    v_mbcnt_lo_u32_b32 v57, s54, 0
    v_mbcnt_hi_u32_b32 v50, s41, v50
    v_mbcnt_hi_u32_b32 v54, s49, v54
    v_mbcnt_hi_u32_b32 v51, s43, v51
    v_mbcnt_hi_u32_b32 v55, s51, v55
    v_mbcnt_hi_u32_b32 v52, s45, v52
    v_mbcnt_hi_u32_b32 v56, s53, v56
    v_mbcnt_hi_u32_b32 v53, s47, v53
    v_mbcnt_hi_u32_b32 v57, s55, v57
    v_lshl_add_u32 v50, v50, 2, s28
    s_bcnt1_i32_b64 s3, s[40:41]
    s_mov_b64 exec, s[40:41]
    ds_write_b32 v50, v40
    s_mov_b64 exec, -1
    s_lshl_b32 s3, s3, 2
    s_add_u32 s28, s28, s3
    v_lshl_add_u32 v54, v54, 2, s28
    s_bcnt1_i32_b64 s3, s[48:49]
    s_mov_b64 exec, s[48:49]
    ds_write_b32 v54, v44
    s_mov_b64 exec, -1
    s_lshl_b32 s3, s3, 2
    s_add_u32 s28, s28, s3
    s_or_b64 s[6:7], s[42:43], s[50:51]
    s_cbranch_scc0 L_CDONE
    v_lshl_add_u32 v51, v51, 2, s28
    s_bcnt1_i32_b64 s3, s[42:43]
    s_mov_b64 exec, s[42:43]
    ds_write_b32 v51, v41
    s_mov_b64 exec, -1
    s_lshl_b32 s3, s3, 2
    s_add_u32 s28, s28, s3
    v_lshl_add_u32 v55, v55, 2, s28
    s_bcnt1_i32_b64 s3, s[50:51]
    s_mov_b64 exec, s[50:51]
    ds_write_b32 v55, v45
    s_mov_b64 exec, -1
    s_lshl_b32 s3, s3, 2
    s_add_u32 s28, s28, s3
    s_or_b64 s[6:7], s[44:45], s[52:53]
    s_cbranch_scc0 L_CDONE
    v_lshl_add_u32 v52, v52, 2, s28
    s_bcnt1_i32_b64 s3, s[44:45]
    s_mov_b64 exec, s[44:45]
    ds_write_b32 v52, v42
    s_mov_b64 exec, -1
    s_lshl_b32 s3, s3, 2
    s_add_u32 s28, s28, s3
    v_lshl_add_u32 v56, v56, 2, s28
    s_bcnt1_i32_b64 s3, s[52:53]
    s_mov_b64 exec, s[52:53]
    ds_write_b32 v56, v46
    s_mov_b64 exec, -1
    s_lshl_b32 s3, s3, 2
    s_add_u32 s28, s28, s3
    v_lshl_add_u32 v53, v53, 2, s28
    s_bcnt1_i32_b64 s3, s[46:47]
    s_mov_b64 exec, s[46:47]
    ds_write_b32 v53, v43
    s_mov_b64 exec, -1
    s_lshl_b32 s3, s3, 2
    s_add_u32 s28, s28, s3
    v_lshl_add_u32 v57, v57, 2, s28
    s_bcnt1_i32_b64 s3, s[54:55]
    s_mov_b64 exec, s[54:55]
    ds_write_b32 v57, v47
    s_mov_b64 exec, -1
    s_lshl_b32 s3, s3, 2
    s_add_u32 s28, s28, s3
    s_or_b64 s[6:7], s[46:47], s[54:55]
    s_cbranch_scc0 L_CDONE
    s_add_u32 s29, s29, 1
    s_add_u32 s4, s4, 16
    s_add_u32 s5, s5, 16
    s_cmp_lt_u32 s29, 4
    s_cbranch_scc1 L_KQ
L_CDONE:
    s_sub_u32 s4, s28, 122880
    s_mov_b32 s5, 0
    s_mov_b32 s28, 131264
L_OUTER:
    ds_read_b32 v6, v13
    v_mov_b32 v7, 0
    v_mov_b32 v8, v11
    s_mov_b32 s6, 0
L_INNER:
    ds_read_b128 v[44:47], v8 offset:0
    ds_read_b128 v[48:51], v8 offset:16
    ds_read_b128 v[52:55], v8 offset:32
    ds_read_b128 v[56:59], v8 offset:48
    v_add_u32 v8, 128, v8
    s_add_u32 s6, s6, 128
    v_mov_b32 v9, 0
    s_waitcnt lgkmcnt(2)
    v_cmp_gt_u32 s[40:41], v44, v6
    v_cmp_gt_u32 s[42:43], v45, v6
    v_cmp_gt_u32 s[44:45], v46, v6
    v_cmp_gt_u32 s[46:47], v47, v6
    v_cmp_gt_u32 s[48:49], v48, v6
    v_cmp_gt_u32 s[50:51], v49, v6
    v_cmp_gt_u32 s[52:53], v50, v6
    v_cmp_gt_u32 s[54:55], v51, v6
    v_addc_co_u32 v7, vcc, 0, v7, s[40:41]
    v_addc_co_u32 v9, vcc, 0, v9, s[42:43]
    v_addc_co_u32 v7, vcc, 0, v7, s[44:45]
    v_addc_co_u32 v9, vcc, 0, v9, s[46:47]
    v_addc_co_u32 v7, vcc, 0, v7, s[48:49]
    v_addc_co_u32 v9, vcc, 0, v9, s[50:51]
    v_addc_co_u32 v7, vcc, 0, v7, s[52:53]
    v_addc_co_u32 v9, vcc, 0, v9, s[54:55]
    s_waitcnt lgkmcnt(0)
    v_cmp_gt_u32 s[40:41], v52, v6
    v_cmp_gt_u32 s[42:43], v53, v6
    v_cmp_gt_u32 s[44:45], v54, v6
    v_cmp_gt_u32 s[46:47], v55, v6
    v_cmp_gt_u32 s[48:49], v56, v6
    v_cmp_gt_u32 s[50:51], v57, v6
    v_cmp_gt_u32 s[52:53], v58, v6
    v_cmp_gt_u32 s[54:55], v59, v6
    v_addc_co_u32 v7, vcc, 0, v7, s[40:41]
    v_addc_co_u32 v9, vcc, 0, v9, s[42:43]
    v_addc_co_u32 v7, vcc, 0, v7, s[44:45]
    v_addc_co_u32 v9, vcc, 0, v9, s[46:47]
    v_addc_co_u32 v7, vcc, 0, v7, s[48:49]
    v_addc_co_u32 v9, vcc, 0, v9, s[50:51]
    v_addc_co_u32 v7, vcc, 0, v7, s[52:53]
    v_addc_co_u32 v9, vcc, 0, v9, s[54:55]
    v_add_u32 v7, v7, v9
    s_cmp_lt_u32 s6, s4
    s_cbranch_scc1 L_INNER
    v_mov_b32 v8, v7
    v_not_b32 v6, v6
    v_and_b32 v6, 0x1fff, v6
    v_permlane32_swap_b32 v7, v8
    v_add_u32 v7, v7, v8
    v_cmp_gt_u32 vcc, 8, v7
    v_lshl_add_u32 v7, v7, 2, s28
    s_and_saveexec_b64 s[6:7], vcc
    ds_write_b32 v7, v6
    s_mov_b64 exec, -1
    v_add_u32 v13, 128, v13
    s_add_u32 s5, s5, 128
    s_cmp_lt_u32 s5, s4
    s_cbranch_scc1 L_OUTER
    s_branch L_SELB
L_CLO:
    s_lshl_b32 s4, s24, 10
    s_add_u32 s35, s4, s37
    s_add_u32 s38, s35, 262144
    v_mul_u32_u24 v5, 160, v2
    v_add3_u32 v12, v5, v17, s34
    v_lshlrev_b32 v7, 4, v1
    v_mov_b32 v47, 0
    s_barrier
    ds_read_b128 v[92:95], v13 offset:0
    ds_read_b128 v[96:99], v13 offset:1024
    ds_read_b128 v[100:103], v13 offset:2048
    ds_read_b128 v[104:107], v13 offset:3072
    ds_read_b128 v[108:111], v13 offset:4096
    s_waitcnt lgkmcnt(4)
    v_pk_add_f32 v[72:73], v[72:73], v[92:93]
    v_pk_add_f32 v[74:75], v[74:75], v[94:95]
    s_waitcnt lgkmcnt(3)
    v_pk_add_f32 v[76:77], v[76:77], v[96:97]
    v_pk_add_f32 v[78:79], v[78:79], v[98:99]
    s_waitcnt lgkmcnt(2)
    v_pk_add_f32 v[80:81], v[80:81], v[100:101]
    v_pk_add_f32 v[82:83], v[82:83], v[102:103]
    s_waitcnt lgkmcnt(1)
    v_pk_add_f32 v[84:85], v[84:85], v[104:105]
    v_pk_add_f32 v[86:87], v[86:87], v[106:107]
    s_waitcnt lgkmcnt(0)
    v_pk_add_f32 v[88:89], v[88:89], v[108:109]
    v_pk_add_f32 v[90:91], v[90:91], v[110:111]
    v_pk_add_f32 v[50:51], v[72:73], v[76:77]
    v_pk_mul_f32 v[52:53], v[72:73], v[72:73]
    v_pk_mul_f32 v[54:55], v[72:73], v[196:197]
    v_pk_add_f32 v[56:57], v[74:75], v[78:79]
    v_pk_mul_f32 v[58:59], v[74:75], v[74:75]
    v_pk_mul_f32 v[60:61], v[74:75], v[198:199]
    v_pk_fma_f32 v[52:53], v[76:77], v[76:77], v[52:53]
    v_pk_fma_f32 v[54:55], v[76:77], v[200:201], v[54:55]
    v_pk_fma_f32 v[58:59], v[78:79], v[78:79], v[58:59]
    v_pk_fma_f32 v[60:61], v[78:79], v[202:203], v[60:61]
    v_pk_add_f32 v[50:51], v[50:51], v[80:81]
    v_pk_fma_f32 v[52:53], v[80:81], v[80:81], v[52:53]
    v_pk_fma_f32 v[54:55], v[80:81], v[204:205], v[54:55]
    v_pk_add_f32 v[56:57], v[56:57], v[82:83]
    v_pk_fma_f32 v[58:59], v[82:83], v[82:83], v[58:59]
    v_pk_fma_f32 v[60:61], v[82:83], v[206:207], v[60:61]
    v_pk_add_f32 v[50:51], v[50:51], v[84:85]
    v_pk_fma_f32 v[52:53], v[84:85], v[84:85], v[52:53]
    v_pk_fma_f32 v[54:55], v[84:85], v[208:209], v[54:55]
    v_pk_add_f32 v[56:57], v[56:57], v[86:87]
    v_pk_fma_f32 v[58:59], v[86:87], v[86:87], v[58:59]
    v_pk_fma_f32 v[60:61], v[86:87], v[210:211], v[60:61]
    v_pk_add_f32 v[50:51], v[50:51], v[88:89]
    v_pk_fma_f32 v[52:53], v[88:89], v[88:89], v[52:53]
    v_pk_fma_f32 v[54:55], v[88:89], v[212:213], v[54:55]
    v_pk_add_f32 v[56:57], v[56:57], v[90:91]
    v_pk_fma_f32 v[58:59], v[90:91], v[90:91], v[58:59]
    v_pk_fma_f32 v[60:61], v[90:91], v[214:215], v[60:61]
    v_pk_add_f32 v[50:51], v[50:51], v[56:57]
    v_pk_add_f32 v[52:53], v[52:53], v[58:59]
    v_pk_add_f32 v[54:55], v[54:55], v[60:61]
    v_add_f32 v44, v50, v51
    v_add_f32 v45, v52, v53
    v_add_f32 v46, v54, v55
    v_mov_b32 v40, v44
    v_mov_b32 v41, v45
    v_mov_b32 v42, v46
    v_permlane16_swap_b32 v44, v40
    v_permlane16_swap_b32 v45, v41
    v_permlane16_swap_b32 v46, v42
    v_add_f32 v44, v44, v40
    v_add_f32 v45, v45, v41
    v_add_f32 v46, v46, v42
    v_mov_b32 v40, v44
    v_mov_b32 v41, v45
    v_mov_b32 v42, v46
    v_permlane32_swap_b32 v44, v40
    v_permlane32_swap_b32 v45, v41
    v_permlane32_swap_b32 v46, v42
    v_add_f32 v44, v44, v40
    v_add_f32 v45, v45, v41
    v_add_f32 v46, v46, v42
    v_min_u32 v44, -2, v44
    v_min_u32 v45, -2, v45
    v_min_u32 v46, -2, v46
    s_mov_b64 exec, 0xffff
    buffer_store_dwordx4 v[44:47], v10, s[16:19], s35 offen
    buffer_store_dwordx4 v[44:47], v10, s[16:19], s38 offen sc1
    s_mov_b64 exec, -1
    s_barrier
    v_cvt_pk_bf16_f32 v216, v72, v73
    v_cvt_pk_bf16_f32 v217, v74, v75
    v_cvt_pk_bf16_f32 v218, v76, v77
    v_cvt_pk_bf16_f32 v219, v78, v79
    v_cvt_pk_bf16_f32 v220, v80, v81
    v_cvt_pk_bf16_f32 v221, v82, v83
    v_cvt_pk_bf16_f32 v222, v84, v85
    v_cvt_pk_bf16_f32 v223, v86, v87
    v_cvt_pk_bf16_f32 v224, v88, v89
    v_cvt_pk_bf16_f32 v225, v90, v91
    v_min_u32 v216, -2, v216
    v_min_u32 v217, -2, v217
    v_min_u32 v218, -2, v218
    v_min_u32 v219, -2, v219
    v_min_u32 v220, -2, v220
    v_min_u32 v221, -2, v221
    v_min_u32 v222, -2, v222
    v_min_u32 v223, -2, v223
    v_min_u32 v224, -2, v224
    v_min_u32 v225, -2, v225
    v_lshlrev_b32 v72, 16, v216
    v_and_b32 v73, 0xffff0000, v216
    v_lshlrev_b32 v74, 16, v217
    v_and_b32 v75, 0xffff0000, v217
    v_lshlrev_b32 v76, 16, v218
    v_and_b32 v77, 0xffff0000, v218
    v_lshlrev_b32 v78, 16, v219
    v_and_b32 v79, 0xffff0000, v219
    v_lshlrev_b32 v80, 16, v220
    v_and_b32 v81, 0xffff0000, v220
    v_lshlrev_b32 v82, 16, v221
    v_and_b32 v83, 0xffff0000, v221
    v_lshlrev_b32 v84, 16, v222
    v_and_b32 v85, 0xffff0000, v222
    v_lshlrev_b32 v86, 16, v223
    v_and_b32 v87, 0xffff0000, v223
    v_lshlrev_b32 v88, 16, v224
    v_and_b32 v89, 0xffff0000, v224
    v_lshlrev_b32 v90, 16, v225
    v_and_b32 v91, 0xffff0000, v225
    ds_write_b64 v12, v[216:217] offset:0
    ds_write_b64 v12, v[218:219] offset:8
    ds_write_b64 v12, v[220:221] offset:16
    ds_write_b64 v12, v[222:223] offset:24
    ds_write_b64 v12, v[224:225] offset:32
    s_lshl_b32 s3, s26, 8
    s_add_u32 s3, s3, 131584
    v_lshl_add_u32 v9, v2, 4, s3
    s_lshl_b32 s3, s23, 2
    s_add_u32 s3, s3, s26
    s_lshl_b32 s3, s3, 12
    s_lshl_b32 s4, s24, 8
    s_add_u32 s3, s3, s4
    s_add_u32 s28, s3, 13107200
    v_lshl_add_u32 v11, v3, 11, v10
    s_barrier
    ds_read_b64 v[40:41], v9
    ds_read_b32 v22, v9 offset:12
    s_waitcnt lgkmcnt(0)
    v_pk_add_f32 v[176:177], v[72:73], v[40:41] op_sel_hi:[1,0] neg_lo:[0,1] neg_hi:[0,1]
    v_pk_add_f32 v[178:179], v[74:75], v[40:41] op_sel_hi:[1,0] neg_lo:[0,1] neg_hi:[0,1]
    v_pk_add_f32 v[180:181], v[76:77], v[40:41] op_sel_hi:[1,0] neg_lo:[0,1] neg_hi:[0,1]
    v_pk_add_f32 v[182:183], v[78:79], v[40:41] op_sel_hi:[1,0] neg_lo:[0,1] neg_hi:[0,1]
    v_pk_add_f32 v[184:185], v[80:81], v[40:41] op_sel_hi:[1,0] neg_lo:[0,1] neg_hi:[0,1]
    v_pk_add_f32 v[186:187], v[82:83], v[40:41] op_sel_hi:[1,0] neg_lo:[0,1] neg_hi:[0,1]
    v_pk_add_f32 v[188:189], v[84:85], v[40:41] op_sel_hi:[1,0] neg_lo:[0,1] neg_hi:[0,1]
    v_pk_add_f32 v[190:191], v[86:87], v[40:41] op_sel_hi:[1,0] neg_lo:[0,1] neg_hi:[0,1]
    v_pk_add_f32 v[192:193], v[88:89], v[40:41] op_sel_hi:[1,0] neg_lo:[0,1] neg_hi:[0,1]
    v_pk_add_f32 v[194:195], v[90:91], v[40:41] op_sel_hi:[1,0] neg_lo:[0,1] neg_hi:[0,1]
    v_cvt_pk_bf16_f32 v228, v176, v177
    v_cvt_pk_bf16_f32 v229, v178, v179
    v_cvt_pk_bf16_f32 v230, v180, v181
    v_cvt_pk_bf16_f32 v231, v182, v183
    v_cvt_pk_bf16_f32 v232, v184, v185
    v_cvt_pk_bf16_f32 v233, v186, v187
    v_cvt_pk_bf16_f32 v234, v188, v189
    v_cvt_pk_bf16_f32 v235, v190, v191
    v_cvt_pk_bf16_f32 v236, v192, v193
    v_cvt_pk_bf16_f32 v237, v194, v195
    v_lshlrev_b32 v176, 16, v228
    v_and_b32 v177, 0xffff0000, v228
    v_lshlrev_b32 v178, 16, v229
    v_and_b32 v179, 0xffff0000, v229
    v_lshlrev_b32 v180, 16, v230
    v_and_b32 v181, 0xffff0000, v230
    v_lshlrev_b32 v182, 16, v231
    v_and_b32 v183, 0xffff0000, v231
    v_lshlrev_b32 v184, 16, v232
    v_and_b32 v185, 0xffff0000, v232
    v_lshlrev_b32 v186, 16, v233
    v_and_b32 v187, 0xffff0000, v233
    v_lshlrev_b32 v188, 16, v234
    v_and_b32 v189, 0xffff0000, v234
    v_lshlrev_b32 v190, 16, v235
    v_and_b32 v191, 0xffff0000, v235
    v_lshlrev_b32 v192, 16, v236
    v_and_b32 v193, 0xffff0000, v236
    v_lshlrev_b32 v194, 16, v237
    v_and_b32 v195, 0xffff0000, v237
    v_mov_b32 v42, v41
    v_pk_mul_f32 v[176:177], v[176:177], v[42:43] op_sel_hi:[1,0]
    v_pk_mul_f32 v[178:179], v[178:179], v[42:43] op_sel_hi:[1,0]
    v_pk_mul_f32 v[180:181], v[180:181], v[42:43] op_sel_hi:[1,0]
    v_pk_mul_f32 v[182:183], v[182:183], v[42:43] op_sel_hi:[1,0]
    v_pk_mul_f32 v[184:185], v[184:185], v[42:43] op_sel_hi:[1,0]
    v_pk_mul_f32 v[186:187], v[186:187], v[42:43] op_sel_hi:[1,0]
    v_pk_mul_f32 v[188:189], v[188:189], v[42:43] op_sel_hi:[1,0]
    v_pk_mul_f32 v[190:191], v[190:191], v[42:43] op_sel_hi:[1,0]
    v_pk_mul_f32 v[192:193], v[192:193], v[42:43] op_sel_hi:[1,0]
    v_pk_mul_f32 v[194:195], v[194:195], v[42:43] op_sel_hi:[1,0]
    v_cvt_pk_bf16_f32 v228, v176, v177
    v_cvt_pk_bf16_f32 v229, v178, v179
    v_cvt_pk_bf16_f32 v230, v180, v181
    v_cvt_pk_bf16_f32 v231, v182, v183
    v_cvt_pk_bf16_f32 v232, v184, v185
    v_cvt_pk_bf16_f32 v233, v186, v187
    v_cvt_pk_bf16_f32 v234, v188, v189
    v_cvt_pk_bf16_f32 v235, v190, v191
    v_cvt_pk_bf16_f32 v236, v192, v193
    v_cvt_pk_bf16_f32 v237, v194, v195
    v_min_u32 v228, -2, v228
    v_min_u32 v229, -2, v229
    v_min_u32 v230, -2, v230
    v_min_u32 v231, -2, v231
    v_min_u32 v232, -2, v232
    v_min_u32 v233, -2, v233
    v_min_u32 v234, -2, v234
    v_min_u32 v235, -2, v235
    v_min_u32 v236, -2, v236
    v_min_u32 v237, -2, v237
    ds_write_b64 v12, v[228:229] offset:2560
    ds_write_b64 v12, v[230:231] offset:2568
    ds_write_b64 v12, v[232:233] offset:2576
    ds_write_b64 v12, v[234:235] offset:2584
    ds_write_b64 v12, v[236:237] offset:2592
    v_and_b32 v4, 3, v22
    v_cmp_eq_u32 s[4:5], 0, v4
    v_cmp_eq_u32 s[6:7], 1, v4
    s_ff1_i32_b32 s4, s4
    s_ff1_i32_b32 s6, s6
    s_mul_i32 s4, s4, 160
    s_mul_i32 s6, s6, 160
    v_mov_b32 v4, s4
    v_mov_b32 v5, s6
    v_cmp_eq_u32 vcc, 1, v3
    s_nop 1
    v_cndmask_b32 v4, v4, v5, vcc
    v_add3_u32 v4, v4, v10, s34
    s_mov_b64 exec, 0x03ff03ff
    ds_read_b128 v[52:55], v4 offset:2560
    s_waitcnt lgkmcnt(0)
    buffer_store_dwordx4 v[52:55], v11, s[16:19], s28 offen sc1
    s_mov_b64 exec, -1
    s_cmp_ge_u32 s25, 32
    s_cbranch_scc1 L_RP2
    s_cmp_eq_u32 s56, 0
    s_cbranch_scc1 L_RP2
    s_mul_i32 s3, s30, 20480
    s_mul_i32 s4, s26, 5120
    s_add_u32 s3, s3, s4
    s_add_u32 s3, s3, 13762560
    s_add_u32 m0, s4, 102400
    v_lshlrev_b32 v7, 4, v1
    buffer_load_dwordx4 v7, s[16:19], s3 offen offset:0 sc1 lds
    buffer_load_dwordx4 v7, s[16:19], s3 offen offset:1024 sc1 lds
    buffer_load_dwordx4 v7, s[16:19], s3 offen offset:2048 sc1 lds
    buffer_load_dwordx4 v7, s[16:19], s3 offen offset:3072 sc1 lds
    s_add_u32 m0, s4, 106496
    s_add_u32 s3, s3, 4096
    buffer_load_dwordx4 v7, s[16:19], s3 offen sc1 lds
L_RP2:
    s_cmp_lt_u32 s25, 32
    s_cbranch_scc1 L_NWD2
    s_sub_u32 s3, s30, 256
    s_lshl_b32 s3, s3, 5
    v_lshrrev_b32 v5, 1, v1
    v_and_b32 v6, 0x13, v5
    v_and_b32 v4, 4, v5
    v_lshl_or_b32 v6, v4, 1, v6
    v_and_b32 v4, 8, v5
    v_lshrrev_b32 v4, 1, v4
    v_or_b32 v6, v6, v4
    v_mul_u32_u24 v6, 1280, v6
    v_and_b32 v4, 1, v1
    v_lshl_add_u32 v6, v4, 4, v6
    v_add_u32 v6, s3, v6
    s_mul_i32 s4, s20, 40960
    s_mov_b32 s12, s78
    s_and_b32 s13, s79, 0xffff
    s_mov_b32 s14, 2211840
    s_mov_b32 s15, 0x00020000
    s_add_u32 m0, s32, 24576
    s_add_u32 s3, s4, 983040
    buffer_load_dwordx4 v6, s[12:15], s3 offen lds
    s_add_u32 m0, s32, 28672
    s_add_u32 s3, s4, 1146880
    buffer_load_dwordx4 v6, s[12:15], s3 offen lds
    s_add_u32 m0, s32, 32768
    s_add_u32 s3, s4, 1310720
    buffer_load_dwordx4 v6, s[12:15], s3 offen lds
    s_add_u32 m0, s32, 36864
    s_add_u32 s3, s4, 1474560
    buffer_load_dwordx4 v6, s[12:15], s3 offen lds
    s_add_u32 m0, s32, 40960
    s_add_u32 s3, s4, 1638400
    buffer_load_dwordx4 v6, s[12:15], s3 offen lds
    s_add_u32 m0, s32, 45056
    s_add_u32 s3, s4, 1802240
    buffer_load_dwordx4 v6, s[12:15], s3 offen lds
    s_add_u32 m0, s32, 49152
    s_add_u32 s3, s4, 1966080
    buffer_load_dwordx4 v6, s[12:15], s3 offen lds
    s_add_u32 m0, s32, 53248
    s_add_u32 s3, s4, 2129920
    buffer_load_dwordx4 v6, s[12:15], s3 offen lds
L_NWD2:
    v_lshlrev_b32 v176, 16, v228
    v_and_b32 v177, 0xffff0000, v228
    v_lshlrev_b32 v178, 16, v229
    v_and_b32 v179, 0xffff0000, v229
    v_lshlrev_b32 v180, 16, v230
    v_and_b32 v181, 0xffff0000, v230
    v_lshlrev_b32 v182, 16, v231
    v_and_b32 v183, 0xffff0000, v231
    v_lshlrev_b32 v184, 16, v232
    v_and_b32 v185, 0xffff0000, v232
    v_lshlrev_b32 v186, 16, v233
    v_and_b32 v187, 0xffff0000, v233
    v_lshlrev_b32 v188, 16, v234
    v_and_b32 v189, 0xffff0000, v234
    v_lshlrev_b32 v190, 16, v235
    v_and_b32 v191, 0xffff0000, v235
    v_lshlrev_b32 v192, 16, v236
    v_and_b32 v193, 0xffff0000, v236
    v_lshlrev_b32 v194, 16, v237
    v_and_b32 v195, 0xffff0000, v237
    v_pk_add_f32 v[176:177], v[176:177], v[72:73]
    v_pk_add_f32 v[178:179], v[178:179], v[74:75]
    v_pk_add_f32 v[180:181], v[180:181], v[76:77]
    v_pk_add_f32 v[182:183], v[182:183], v[78:79]
    v_pk_add_f32 v[184:185], v[184:185], v[80:81]
    v_pk_add_f32 v[186:187], v[186:187], v[82:83]
    v_pk_add_f32 v[188:189], v[188:189], v[84:85]
    v_pk_add_f32 v[190:191], v[190:191], v[86:87]
    v_pk_add_f32 v[192:193], v[192:193], v[88:89]
    v_pk_add_f32 v[194:195], v[194:195], v[90:91]
    v_cvt_pk_bf16_f32 v228, v176, v177
    v_cvt_pk_bf16_f32 v229, v178, v179
    v_cvt_pk_bf16_f32 v230, v180, v181
    v_cvt_pk_bf16_f32 v231, v182, v183
    v_cvt_pk_bf16_f32 v232, v184, v185
    v_cvt_pk_bf16_f32 v233, v186, v187
    v_cvt_pk_bf16_f32 v234, v188, v189
    v_cvt_pk_bf16_f32 v235, v190, v191
    v_cvt_pk_bf16_f32 v236, v192, v193
    v_cvt_pk_bf16_f32 v237, v194, v195
    v_not_b32 v22, v22
    v_and_b32 v22, 0x1fff, v22
    s_waitcnt vmcnt(0)
L_SELW:
    v_and_b32 v150, 7, v1
    v_lshlrev_b32 v150, 2, v150
    v_add_u32 v150, 131264, v150
    v_lshrrev_b32 v4, 3, v1
    v_lshlrev_b32 v153, 8, v4
    v_lshlrev_b32 v4, 2, v4
    v_add_u32 v151, 131264, v4
    v_bfe_u32 v4, v1, 1, 3
    v_lshlrev_b32 v154, 8, v4
    v_lshlrev_b32 v4, 2, v4
    v_add_u32 v152, 131264, v4
    v_bfe_u32 v4, v1, 4, 1
    v_mul_u32_u24 v6, 2560, v4
    v_lshlrev_b32 v7, 4, v2
    v_sub_u32 v160, 135680, v6
    v_add_u32 v160, v160, v7
    s_lshl_b32 s3, s24, 11
    s_lshl_b32 s4, s20, 8
    s_add_u32 s3, s3, s4
    s_add_u32 s3, s3, 13664256
    v_lshl_add_u32 v161, v4, 14, v7
    v_add_u32 v161, s3, v161
    s_lshl_b32 s3, s20, 11
    s_sub_u32 s3, s3, s4
    s_add_u32 s3, s3, 557056
    v_add_u32 v153, s3, v153
    v_add_u32 v154, s3, v154
    s_add_u32 s58, s4, 13107200
    v_and_b32 v4, 7, v1
    v_lshlrev_b32 v155, 4, v4
    v_and_b32 v4, 1, v1
    v_lshlrev_b32 v156, 4, v4
    v_add_u32 v156, 128, v156
    v_mov_b32 v157, 131264
    s_mul_i32 s59, s20, 1280
    s_add_u32 s5, s59, 102400
    s_add_u32 s59, s59, 77824
    v_and_b32 v4, 7, v2
    v_lshlrev_b32 v6, 4, v3
    v_lshl_add_u32 v158, v4, 7, v6
    v_add_u32 v158, s59, v158
    v_and_b32 v6, 16, v6
    v_lshl_add_u32 v159, v4, 5, v6
    v_add_u32 v159, s59, v159
    v_bfe_u32 v4, v1, 2, 2
    v_lshl_add_u32 v4, v3, 3, v4
    v_lshlrev_b32 v4, 4, v4
    v_and_b32 v6, 1, v1
    v_lshl_add_u32 v4, v6, 3, v4
    v_bfe_u32 v6, v1, 1, 1
    v_mul_u32_u24 v6, 10240, v6
    v_add3_u32 v162, v4, v6, s5
    s_add_u32 s3, s32, 65536
    v_lshl_add_u32 v163, v1, 4, s3
    s_mov_b32 s8, s80
    s_and_b32 s9, s81, 0xffff
    s_mov_b32 s10, 2621440
    s_mov_b32 s11, 0x00020000
L_SELB:
    s_waitcnt lgkmcnt(0)
    s_barrier
    ds_read_b32 v24, v151
    ds_read_b32 v25, v152
    ds_read_b32 v23, v150
    ds_read_b128 v[44:47], v157
    ds_read_b128 v[48:51], v157 offset:16
    s_cmp_ge_u32 s25, 32
    s_cbranch_scc1 L_E
    s_waitcnt lgkmcnt(3)
    v_not_b32 v26, v24
    v_lshrrev_b32 v24, 6, v24
    v_not_b32 v27, v25
    v_lshrrev_b32 v25, 6, v25
    v_and_b32 v26, 3, v26
    v_lshlrev_b32 v24, 12, v24
    v_and_b32 v27, 3, v27
    v_lshlrev_b32 v25, 12, v25
    v_cmp_gt_u32 s[4:5], 2, v26
    v_lshl_add_u32 v24, v26, 11, v24
    v_cmp_gt_u32 s[6:7], 2, v27
    v_lshl_add_u32 v25, v27, 11, v25
    v_cndmask_b32 v24, v153, v24, s[4:5]
    v_cndmask_b32 v25, v154, v25, s[6:7]
    v_add_u32 v24, v24, v155
    v_add_u32 v25, v25, v156
    s_mov_b32 m0, s59
    s_nop 0
    buffer_load_dwordx4 v24, s[16:19], s58 offen sc1 lds
    s_add_u32 m0, s59, 1024
    s_mov_b64 exec, 0xffff
    buffer_load_dwordx4 v25, s[16:19], s58 offen sc1 lds
    s_mov_b64 exec, -1
    s_waitcnt lgkmcnt(2)
    v_readlane_b32 s4, v23, s20
    s_nop 0
    s_lshr_b32 s5, s4, 8
    s_cmp_lg_u32 s5, s23
    s_cbranch_scc1 L_NOPUB
    s_bfe_u32 s5, s4, 0x20006
    s_mul_i32 s5, s5, 5120
    s_bfe_u32 s6, s4, 0x40002
    s_mul_i32 s6, s6, 160
    s_add_u32 s5, s5, s6
    v_add_u32 v4, s5, v160
    s_bfe_u32 s4, s4, 0x60002
    s_lshl_b32 s4, s4, 4
    s_add_u32 s4, s4, 131584
    v_mov_b32 v5, s4
    v_cmp_eq_u32 vcc, 26, v1
    s_nop 1
    v_cndmask_b32 v4, v4, v5, vcc
    s_mov_b64 exec, 0x07ff03ff
    ds_read_b128 v[52:55], v4
    s_waitcnt lgkmcnt(0)
    buffer_store_dwordx4 v[52:55], v161, s[16:19], 0 offen sc1
    s_mov_b64 exec, -1
L_NOPUB:
    ds_read_b64_tr_b16 v[80:81], v162 offset:0
    ds_read_b64_tr_b16 v[82:83], v162 offset:64
    ds_read_b64_tr_b16 v[84:85], v162 offset:512
    ds_read_b64_tr_b16 v[86:87], v162 offset:576
    ds_read_b64_tr_b16 v[88:89], v162 offset:1024
    ds_read_b64_tr_b16 v[90:91], v162 offset:1088
    v_cmp_gt_u32 s[6:7], 32, v1
    v_mov_b32 v10, v163
    s_waitcnt lgkmcnt(0)
    v_cndmask_b32 v88, 0, v88, s[6:7]
    v_cndmask_b32 v89, 0, v89, s[6:7]
    v_cndmask_b32 v90, 0, v90, s[6:7]
    v_cndmask_b32 v91, 0, v91, s[6:7]
    s_waitcnt vmcnt(0)
    ds_read_b128 v[64:67], v158
    ds_read_b128 v[68:71], v158 offset:64
    ds_read_b128 v[72:75], v159 offset:1024
    s_waitcnt lgkmcnt(2)
    v_mfma_f32_16x16x32_bf16 v[28:31], v[80:83], v[64:67], 0
    s_waitcnt lgkmcnt(1)
    v_mfma_f32_16x16x32_bf16 v[28:31], v[84:87], v[68:71], v[28:31]
    s_waitcnt lgkmcnt(0)
    v_mfma_f32_16x16x32_bf16 v[28:31], v[88:91], v[72:75], v[28:31]
    v_max3_u32 v5, v64, v65, v66
    v_max3_u32 v6, v67, v68, v69
    v_max3_u32 v5, v5, v70, v71
    v_max3_u32 v6, v6, v72, v73
    v_max3_u32 v5, v5, v74, v75
    v_max_u32 v5, v5, v6
    v_cmp_eq_u32 vcc, -1, v5
    s_cbranch_vccz L_RPOLL_OK
    s_mov_b32 s3, 0
L_RPOLL:
    s_add_u32 s3, s3, 1
    s_cmp_gt_u32 s3, 2097152
    s_cbranch_scc1 L_END
    s_mov_b32 m0, s59
    s_nop 0
    buffer_load_dwordx4 v24, s[16:19], s58 offen sc1 lds
    s_add_u32 m0, s59, 1024
    s_mov_b64 exec, 0xffff
    buffer_load_dwordx4 v25, s[16:19], s58 offen sc1 lds
    s_mov_b64 exec, -1
    s_waitcnt vmcnt(0)
    ds_read_b128 v[64:67], v158
    ds_read_b128 v[68:71], v158 offset:64
    ds_read_b128 v[72:75], v159 offset:1024
    s_waitcnt lgkmcnt(2)
    v_mfma_f32_16x16x32_bf16 v[28:31], v[80:83], v[64:67], 0
    s_waitcnt lgkmcnt(1)
    v_mfma_f32_16x16x32_bf16 v[28:31], v[84:87], v[68:71], v[28:31]
    s_waitcnt lgkmcnt(0)
    v_mfma_f32_16x16x32_bf16 v[28:31], v[88:91], v[72:75], v[28:31]
    v_max3_u32 v5, v64, v65, v66
    v_max3_u32 v6, v67, v68, v69
    v_max3_u32 v5, v5, v70, v71
    v_max3_u32 v6, v6, v72, v73
    v_max3_u32 v5, v5, v74, v75
    v_max_u32 v5, v5, v6
    v_cmp_eq_u32 vcc, -1, v5
    s_cbranch_vccz L_RPOLL_OK
    s_sleep 1
    s_branch L_RPOLL
L_RPOLL_OK:
    ds_write_b128 v10, v[28:31]
    s_waitcnt lgkmcnt(0)
    s_barrier
    s_cmp_lg_u32 s20, 7
    s_cbranch_scc1 L_DOTH
    v_subrev_u32 v10, 7168, v10
    ds_read_b128 v[64:67], v10 offset:0
    ds_read_b128 v[68:71], v10 offset:1024
    ds_read_b128 v[72:75], v10 offset:2048
    ds_read_b128 v[76:79], v10 offset:3072
    ds_read_b128 v[80:83], v10 offset:4096
    ds_read_b128 v[84:87], v10 offset:5120
    ds_read_b128 v[88:91], v10 offset:6144
    s_waitcnt lgkmcnt(6)
    v_pk_add_f32 v[28:29], v[28:29], v[64:65]
    v_pk_add_f32 v[30:31], v[30:31], v[66:67]
    s_waitcnt lgkmcnt(5)
    v_pk_add_f32 v[28:29], v[28:29], v[68:69]
    v_pk_add_f32 v[30:31], v[30:31], v[70:71]
    s_waitcnt lgkmcnt(4)
    v_pk_add_f32 v[28:29], v[28:29], v[72:73]
    v_pk_add_f32 v[30:31], v[30:31], v[74:75]
    s_waitcnt lgkmcnt(3)
    v_pk_add_f32 v[28:29], v[28:29], v[76:77]
    v_pk_add_f32 v[30:31], v[30:31], v[78:79]
    s_waitcnt lgkmcnt(2)
    v_pk_add_f32 v[28:29], v[28:29], v[80:81]
    v_pk_add_f32 v[30:31], v[30:31], v[82:83]
    s_waitcnt lgkmcnt(1)
    v_pk_add_f32 v[28:29], v[28:29], v[84:85]
    v_pk_add_f32 v[30:31], v[30:31], v[86:87]
    s_waitcnt lgkmcnt(0)
    v_pk_add_f32 v[28:29], v[28:29], v[88:89]
    v_pk_add_f32 v[30:31], v[30:31], v[90:91]
    v_cvt_pk_bf16_f32 v32, v28, v29
    v_cvt_pk_bf16_f32 v33, v30, v31
    v_mov_b32 v34, v32
    v_mov_b32 v35, v33
    s_nop 0
    v_permlane32_swap_b32 v32, v34
    v_permlane32_swap_b32 v33, v35
    v_lshlrev_b32 v40, 16, v32
    v_and_b32 v41, 0xffff0000, v32
    v_lshlrev_b32 v44, 16, v34
    v_and_b32 v45, 0xffff0000, v34
    v_lshlrev_b32 v42, 16, v33
    v_and_b32 v43, 0xffff0000, v33
    v_lshlrev_b32 v46, 16, v35
    v_and_b32 v47, 0xffff0000, v35
    v_mul_f32 v48, 0xbfb8aa3b, v40
    v_mul_f32 v49, 0xbfb8aa3b, v41
    v_mul_f32 v50, 0xbfb8aa3b, v42
    v_mul_f32 v51, 0xbfb8aa3b, v43
    v_exp_f32 v48, v48
    v_exp_f32 v49, v49
    v_exp_f32 v50, v50
    v_exp_f32 v51, v51
    v_add_f32 v48, 1.0, v48
    v_add_f32 v49, 1.0, v49
    v_add_f32 v50, 1.0, v50
    v_add_f32 v51, 1.0, v51
    v_rcp_f32 v48, v48
    v_rcp_f32 v49, v49
    v_rcp_f32 v50, v50
    v_rcp_f32 v51, v51
    v_mul_f32 v40, v40, v48
    v_mul_f32 v41, v41, v49
    v_mul_f32 v42, v42, v50
    v_mul_f32 v43, v43, v51
    v_cvt_pk_bf16_f32 v32, v40, v41
    v_cvt_pk_bf16_f32 v33, v42, v43
    v_lshlrev_b32 v40, 16, v32
    v_and_b32 v41, 0xffff0000, v32
    v_lshlrev_b32 v42, 16, v33
    v_and_b32 v43, 0xffff0000, v33
    v_pk_mul_f32 v[40:41], v[40:41], v[44:45]
    v_pk_mul_f32 v[42:43], v[42:43], v[46:47]
    v_cvt_pk_bf16_f32 v32, v40, v41
    v_cvt_pk_bf16_f32 v33, v42, v43
    v_min_u32 v32, -2, v32
    v_min_u32 v33, -2, v33
    v_mov_b32 v34, v32
    v_mov_b32 v35, v33
    v_lshlrev_b32 v4, 4, v2
    v_permlane16_swap_b32 v32, v34
    v_permlane16_swap_b32 v33, v35
    s_lshl_b32 s3, s30, 7
    s_add_u32 s3, s3, 13713408
    s_mov_b64 exec, 0xff
    buffer_store_dwordx4 v[32:35], v4, s[16:19], s3 offen sc1
    s_barrier
    s_branch L_END
L_DOTH:
    s_barrier
L_DOTH2:
    s_cmp_lg_u32 s27, 0
    s_cbranch_scc1 L_OUTD
    s_waitcnt lgkmcnt(0)
    v_cmp_ne_u32 vcc, v44, v22
    s_nop 0
    s_and_b64 exec, exec, vcc
    v_cmp_ne_u32 vcc, v45, v22
    s_nop 0
    s_and_b64 exec, exec, vcc
    v_cmp_ne_u32 vcc, v46, v22
    s_nop 0
    s_and_b64 exec, exec, vcc
    v_cmp_ne_u32 vcc, v47, v22
    s_nop 0
    s_and_b64 exec, exec, vcc
    v_cmp_ne_u32 vcc, v48, v22
    s_nop 0
    s_and_b64 exec, exec, vcc
    v_cmp_ne_u32 vcc, v49, v22
    s_nop 0
    s_and_b64 exec, exec, vcc
    v_cmp_ne_u32 vcc, v50, v22
    s_nop 0
    s_and_b64 exec, exec, vcc
    v_cmp_ne_u32 vcc, v51, v22
    s_nop 0
    s_and_b64 exec, exec, vcc
    s_cbranch_execz L_OUTD
    buffer_store_dwordx4 v[228:231], v16, s[8:11], 0 offen
    buffer_store_dwordx4 v[232:235], v16, s[8:11], 0 offen offset:16
    buffer_store_dwordx2 v[236:237], v16, s[8:11], 0 offen offset:32
L_OUTD:
    s_mov_b64 exec, -1
    s_branch L_END
L_E:
    s_waitcnt lgkmcnt(2)
    v_readlane_b32 s4, v23, s20
    s_nop 0
    s_lshr_b32 s5, s4, 8
    s_cmp_lg_u32 s5, s23
    s_cbranch_scc1 L_NOPUBE
    s_bfe_u32 s5, s4, 0x20006
    s_mul_i32 s5, s5, 5120
    s_bfe_u32 s6, s4, 0x40002
    s_mul_i32 s6, s6, 160
    s_add_u32 s5, s5, s6
    v_add_u32 v4, s5, v160
    s_bfe_u32 s4, s4, 0x60002
    s_lshl_b32 s4, s4, 4
    s_add_u32 s4, s4, 131584
    v_mov_b32 v5, s4
    v_cmp_eq_u32 vcc, 26, v1
    s_nop 1
    v_cndmask_b32 v4, v4, v5, vcc
    s_mov_b64 exec, 0x07ff03ff
    ds_read_b128 v[52:55], v4
    s_waitcnt lgkmcnt(0)
    buffer_store_dwordx4 v[52:55], v161, s[16:19], 0 offen sc1
    s_mov_b64 exec, -1
L_NOPUBE:
    v_lshrrev_b32 v23, 2, v23
    s_sub_u32 s30, s30, 256
    s_mul_i32 s4, s30, 52
    s_lshr_b32 s4, s4, 8
    s_lshl_b32 s5, s4, 11
    s_add_u32 s35, s5, 13680800
    s_mul_i32 s4, s4, 1888
    s_lshl_b32 s30, s30, 5
    s_add_u32 s4, s4, s30
    s_add_u32 s33, s4, 13664256
    s_add_u32 s34, s33, 16384
    v_and_b32 v17, 7, v2
    v_lshlrev_b32 v17, 8, v17
    v_lshl_add_u32 v19, v3, 3, v17
    v_add_u32 v11, s32, v21
    v_add_u32 v14, 102400, v11
    s_waitcnt lgkmcnt(0)
    s_cmp_lg_u32 s27, 0
    s_cbranch_scc1 L_OUTE
    s_waitcnt lgkmcnt(0)
    v_cmp_ne_u32 vcc, v44, v22
    s_nop 0
    s_and_b64 exec, exec, vcc
    v_cmp_ne_u32 vcc, v45, v22
    s_nop 0
    s_and_b64 exec, exec, vcc
    v_cmp_ne_u32 vcc, v46, v22
    s_nop 0
    s_and_b64 exec, exec, vcc
    v_cmp_ne_u32 vcc, v47, v22
    s_nop 0
    s_and_b64 exec, exec, vcc
    v_cmp_ne_u32 vcc, v48, v22
    s_nop 0
    s_and_b64 exec, exec, vcc
    v_cmp_ne_u32 vcc, v49, v22
    s_nop 0
    s_and_b64 exec, exec, vcc
    v_cmp_ne_u32 vcc, v50, v22
    s_nop 0
    s_and_b64 exec, exec, vcc
    v_cmp_ne_u32 vcc, v51, v22
    s_nop 0
    s_and_b64 exec, exec, vcc
    s_cbranch_execz L_OUTE
    buffer_store_dwordx4 v[228:231], v16, s[8:11], 0 offen
    buffer_store_dwordx4 v[232:235], v16, s[8:11], 0 offen offset:16
    buffer_store_dwordx2 v[236:237], v16, s[8:11], 0 offen offset:32
L_OUTE:
    s_mov_b64 exec, -1
    s_mov_b32 s12, s84
    s_and_b32 s13, s85, 0xffff
    s_mov_b32 s14, 13741056
    s_mov_b32 s15, 0x00020000
    v_and_b32 v4, 7, v2
    v_lshlrev_b32 v12, 4, v4
    v_lshl_add_u32 v12, v3, 7, v12
    s_lshl_b32 s4, s20, 9
    s_add_u32 s4, s4, 13713408
    v_mul_u32_u24 v13, 1280, v23
    v_lshl_add_u32 v13, v3, 3, v13
    v_add_u32 v13, s30, v13
    s_add_u32 s3, s32, 65536
    v_lshl_add_u32 v10, v1, 4, s3
    s_cmp_lg_u32 s20, 7
    s_cbranch_scc1 L_ENOH
L_ENOH:
    s_waitcnt vmcnt(0)
    ds_read_b64_tr_b16 v[96:97], v14 offset:0
    ds_read_b64_tr_b16 v[98:99], v14 offset:256
    ds_read_b64_tr_b16 v[100:101], v14 offset:8192
    ds_read_b64_tr_b16 v[102:103], v14 offset:8448
    ds_read_b64_tr_b16 v[104:105], v14 offset:51200
    ds_read_b64_tr_b16 v[106:107], v14 offset:51456
    ds_read_b64_tr_b16 v[108:109], v11 offset:24576
    ds_read_b64_tr_b16 v[110:111], v11 offset:24832
    ds_read_b64_tr_b16 v[112:113], v11 offset:32768
    ds_read_b64_tr_b16 v[114:115], v11 offset:33024
    ds_read_b64_tr_b16 v[116:117], v11 offset:40960
    ds_read_b64_tr_b16 v[118:119], v11 offset:41216
    ds_read_b64_tr_b16 v[120:121], v11 offset:49152
    ds_read_b64_tr_b16 v[122:123], v11 offset:49408
    v_mov_b32 v64, 0
    v_mov_b32 v65, 0
    v_mov_b32 v66, 0
    v_mov_b32 v67, 0
    v_mov_b32 v68, 0
    v_mov_b32 v69, 0
    v_mov_b32 v70, 0
    v_mov_b32 v71, 0
    v_mov_b32 v72, 0
    v_mov_b32 v73, 0
    v_mov_b32 v74, 0
    v_mov_b32 v75, 0
    v_mov_b32 v76, 0
    v_mov_b32 v77, 0
    v_mov_b32 v78, 0
    v_mov_b32 v79, 0
    v_mov_b32 v80, 0
    v_mov_b32 v81, 0
    v_mov_b32 v82, 0
    v_mov_b32 v83, 0
    v_mov_b32 v84, 0
    v_mov_b32 v85, 0
    v_mov_b32 v86, 0
    v_mov_b32 v87, 0
    v_mov_b32 v88, 0
    v_mov_b32 v89, 0
    v_mov_b32 v90, 0
    v_mov_b32 v91, 0
    s_barrier
    s_mov_b32 s3, 0
L_APOLL:
    s_add_u32 s3, s3, 1
    s_cmp_gt_u32 s3, 2097152
    s_cbranch_scc1 L_END
    s_mov_b32 exec_lo, 0x00ff00ff
    s_mov_b32 exec_hi, 0x00ff00ff
    s_add_u32 s5, s4, 0
    buffer_load_dwordx4 v[64:67], v12, s[12:15], s5 offen sc1
    s_add_u32 s5, s4, 4096
    buffer_load_dwordx4 v[68:71], v12, s[12:15], s5 offen sc1
    s_add_u32 s5, s4, 8192
    buffer_load_dwordx4 v[72:75], v12, s[12:15], s5 offen sc1
    s_add_u32 s5, s4, 12288
    buffer_load_dwordx4 v[76:79], v12, s[12:15], s5 offen sc1
    s_add_u32 s5, s4, 16384
    buffer_load_dwordx4 v[80:83], v12, s[12:15], s5 offen sc1
    s_add_u32 s5, s4, 20480
    buffer_load_dwordx4 v[84:87], v12, s[12:15], s5 offen sc1
    s_add_u32 s5, s4, 24576
    buffer_load_dwordx4 v[88:91], v12, s[12:15], s5 offen sc1
    s_mov_b64 exec, -1
    s_cmp_lg_u32 s20, 7
    s_cbranch_scc1 L_NH
    buffer_load_dwordx2 v[136:137], v19, s[16:19], s33 offen sc1
    buffer_load_dwordx2 v[130:131], v19, s[16:19], s34 offen sc1
    buffer_load_dword v134, v17, s[16:19], s35 offen offset:8 sc1
L_NH:
    s_waitcnt vmcnt(0) lgkmcnt(0)
    v_mfma_f32_16x16x32_bf16 v[24:27], v[96:99], v[64:67], 0
    v_max_u32 v5, v64, v65
    v_max3_u32 v5, v5, v66, v67
    v_mfma_f32_16x16x32_bf16 v[24:27], v[100:103], v[68:71], v[24:27]
    v_max3_u32 v5, v5, v68, v69
    v_max3_u32 v5, v5, v70, v71
    v_mfma_f32_16x16x32_bf16 v[24:27], v[104:107], v[72:75], v[24:27]
    v_max3_u32 v5, v5, v72, v73
    v_max3_u32 v5, v5, v74, v75
    v_mfma_f32_16x16x32_bf16 v[24:27], v[108:111], v[76:79], v[24:27]
    v_max3_u32 v5, v5, v76, v77
    v_max3_u32 v5, v5, v78, v79
    v_mfma_f32_16x16x32_bf16 v[24:27], v[112:115], v[80:83], v[24:27]
    v_max3_u32 v5, v5, v80, v81
    v_max3_u32 v5, v5, v82, v83
    v_mfma_f32_16x16x32_bf16 v[24:27], v[116:119], v[84:87], v[24:27]
    v_max3_u32 v5, v5, v84, v85
    v_max3_u32 v5, v5, v86, v87
    v_mfma_f32_16x16x32_bf16 v[24:27], v[120:123], v[88:91], v[24:27]
    v_max3_u32 v5, v5, v88, v89
    v_max3_u32 v5, v5, v90, v91
    v_cmp_eq_u32 vcc, -1, v5
    s_cbranch_vccz L_APOLL_OK
    s_sleep 1
    s_branch L_APOLL
L_APOLL_OK:
    s_nop 3
    ds_write_b128 v10, v[24:27]
    s_cmp_lg_u32 s20, 7
    s_cbranch_scc1 L_NH2
    v_max3_u32 v5, v130, v131, v134
    v_max3_u32 v5, v5, v136, v137
    v_cmp_eq_u32 vcc, -1, v5
    s_cbranch_vccz L_HPOLL_OK
    s_mov_b32 s3, 0
L_HPOLL:
    s_add_u32 s3, s3, 1
    s_cmp_gt_u32 s3, 2097152
    s_cbranch_scc1 L_END
    buffer_load_dwordx2 v[136:137], v19, s[16:19], s33 offen sc1
    buffer_load_dwordx2 v[130:131], v19, s[16:19], s34 offen sc1
    buffer_load_dword v134, v17, s[16:19], s35 offen offset:8 sc1
    s_waitcnt vmcnt(0)
    v_max3_u32 v5, v130, v131, v134
    v_max3_u32 v5, v5, v136, v137
    v_cmp_eq_u32 vcc, -1, v5
    s_cbranch_vccz L_HPOLL_OK
    s_sleep 2
    s_branch L_HPOLL
L_HPOLL_OK:
    v_cvt_pk_bf16_f32 v134, v134, v134
    v_lshlrev_b32 v134, 16, v134
    v_mul_f32 v15, 0xbfb8aa3b, v134
    v_exp_f32 v15, v15
    s_nop 0
    v_add_f32 v15, 1.0, v15
    v_rcp_f32 v15, v15
    s_nop 0
    v_cvt_pk_bf16_f32 v15, v15, v15
    v_lshlrev_b32 v15, 16, v15
    v_mov_b32 v16, v15
    v_lshlrev_b32 v140, 16, v136
    v_and_b32 v141, 0xffff0000, v136
    v_lshlrev_b32 v144, 16, v130
    v_and_b32 v145, 0xffff0000, v130
    v_lshlrev_b32 v142, 16, v137
    v_and_b32 v143, 0xffff0000, v137
    v_lshlrev_b32 v146, 16, v131
    v_and_b32 v147, 0xffff0000, v131
L_NH2:
    s_waitcnt lgkmcnt(0)
    s_barrier
    s_cmp_lg_u32 s20, 7
    s_cbranch_scc1 L_END
    v_subrev_u32 v10, 7168, v10
    ds_read_b128 v[32:35], v10 offset:0
    ds_read_b128 v[36:39], v10 offset:1024
    ds_read_b128 v[40:43], v10 offset:2048
    ds_read_b128 v[44:47], v10 offset:3072
    ds_read_b128 v[48:51], v10 offset:4096
    ds_read_b128 v[52:55], v10 offset:5120
    ds_read_b128 v[56:59], v10 offset:6144
    s_waitcnt lgkmcnt(6)
    v_pk_add_f32 v[24:25], v[24:25], v[32:33]
    v_pk_add_f32 v[26:27], v[26:27], v[34:35]
    s_waitcnt lgkmcnt(5)
    v_pk_add_f32 v[24:25], v[24:25], v[36:37]
    v_pk_add_f32 v[26:27], v[26:27], v[38:39]
    s_waitcnt lgkmcnt(4)
    v_pk_add_f32 v[24:25], v[24:25], v[40:41]
    v_pk_add_f32 v[26:27], v[26:27], v[42:43]
    s_waitcnt lgkmcnt(3)
    v_pk_add_f32 v[24:25], v[24:25], v[44:45]
    v_pk_add_f32 v[26:27], v[26:27], v[46:47]
    s_waitcnt lgkmcnt(2)
    v_pk_add_f32 v[24:25], v[24:25], v[48:49]
    v_pk_add_f32 v[26:27], v[26:27], v[50:51]
    s_waitcnt lgkmcnt(1)
    v_pk_add_f32 v[24:25], v[24:25], v[52:53]
    v_pk_add_f32 v[26:27], v[26:27], v[54:55]
    s_waitcnt lgkmcnt(0)
    v_pk_add_f32 v[24:25], v[24:25], v[56:57]
    v_pk_add_f32 v[26:27], v[26:27], v[58:59]
    v_cvt_pk_bf16_f32 v28, v24, v25
    v_cvt_pk_bf16_f32 v29, v26, v27
    v_lshlrev_b32 v24, 16, v28
    v_and_b32 v25, 0xffff0000, v28
    v_lshlrev_b32 v26, 16, v29
    v_and_b32 v27, 0xffff0000, v29
    v_pk_mul_f32 v[24:25], v[24:25], v[16:17] op_sel_hi:[1,0]
    v_pk_mul_f32 v[26:27], v[26:27], v[16:17] op_sel_hi:[1,0]
    v_cvt_pk_bf16_f32 v28, v24, v25
    v_cvt_pk_bf16_f32 v29, v26, v27
    v_lshlrev_b32 v24, 16, v28
    v_and_b32 v25, 0xffff0000, v28
    v_lshlrev_b32 v26, 16, v29
    v_and_b32 v27, 0xffff0000, v29
    v_pk_add_f32 v[24:25], v[24:25], v[140:141]
    v_pk_add_f32 v[26:27], v[26:27], v[142:143]
    v_cvt_pk_bf16_f32 v28, v24, v25
    v_cvt_pk_bf16_f32 v29, v26, v27
    v_lshlrev_b32 v24, 16, v28
    v_and_b32 v25, 0xffff0000, v28
    v_lshlrev_b32 v26, 16, v29
    v_and_b32 v27, 0xffff0000, v29
    v_pk_add_f32 v[24:25], v[24:25], v[144:145]
    v_pk_add_f32 v[26:27], v[26:27], v[146:147]
    v_cvt_pk_bf16_f32 v24, v24, v25
    v_cvt_pk_bf16_f32 v25, v26, v27
    s_mov_b32 exec_lo, 0x00ff00ff
    s_mov_b32 exec_hi, 0x00ff00ff
    buffer_store_dwordx2 v[24:25], v13, s[8:11], 0 offen
L_END:
L_EXIT:
    s_endpgm
L_FALLBACK:
    s_waitcnt vmcnt(0)
    s_nop 7
    s_nop 7
    ds_read_b128 v[24:27], v11 offset:0
    ds_read_b64 v[28:29], v12 offset:0
    ds_read_b128 v[30:33], v11 offset:2560
    ds_read_b64 v[34:35], v12 offset:2560
    ds_read_b128 v[36:39], v11 offset:5120
    ds_read_b64 v[40:41], v12 offset:5120
    ds_read_b128 v[42:45], v11 offset:7680
    ds_read_b64 v[46:47], v12 offset:7680
    s_waitcnt lgkmcnt(0)
    ds_read_b128 v[48:51], v11 offset:10240
    ds_read_b64 v[52:53], v12 offset:10240
    ds_read_b128 v[54:57], v11 offset:12800
    ds_read_b64 v[58:59], v12 offset:12800
    ds_read_b128 v[60:63], v11 offset:15360
    ds_read_b64 v[64:65], v12 offset:15360
    ds_read_b128 v[66:69], v11 offset:17920
    ds_read_b64 v[70:71], v12 offset:17920
    s_waitcnt lgkmcnt(0)
    ds_read_b128 v[72:75], v11 offset:20480
    ds_read_b64 v[76:77], v12 offset:20480
    s_waitcnt lgkmcnt(0)
    v_mfma_f32_32x32x16_bf16 v[112:127], v[24:27], v[16:19], 0
    v_mfma_f32_32x32x8_bf16 v[112:127], v[28:29], v[20:21], v[112:127]
    v_mfma_f32_32x32x16_bf16 v[128:143], v[30:33], v[16:19], 0
    v_mfma_f32_32x32x8_bf16 v[128:143], v[34:35], v[20:21], v[128:143]
    v_mfma_f32_32x32x16_bf16 v[144:159], v[36:39], v[16:19], 0
    v_mfma_f32_32x32x8_bf16 v[144:159], v[40:41], v[20:21], v[144:159]
    v_mfma_f32_32x32x16_bf16 v[160:175], v[42:45], v[16:19], 0
    v_mfma_f32_32x32x8_bf16 v[160:175], v[46:47], v[20:21], v[160:175]
    v_mfma_f32_32x32x16_bf16 v[176:191], v[48:51], v[16:19], 0
    v_mfma_f32_32x32x8_bf16 v[176:191], v[52:53], v[20:21], v[176:191]
    v_mfma_f32_32x32x16_bf16 v[192:207], v[54:57], v[16:19], 0
    v_mfma_f32_32x32x8_bf16 v[192:207], v[58:59], v[20:21], v[192:207]
    v_mfma_f32_32x32x16_bf16 v[208:223], v[60:63], v[16:19], 0
    v_mfma_f32_32x32x8_bf16 v[208:223], v[64:65], v[20:21], v[208:223]
    v_mfma_f32_32x32x16_bf16 v[224:239], v[66:69], v[16:19], 0
    v_mfma_f32_32x32x8_bf16 v[224:239], v[70:71], v[20:21], v[224:239]
    v_mfma_f32_32x32x16_bf16 v[240:255], v[72:75], v[16:19], 0
    v_mfma_f32_32x32x8_bf16 v[240:255], v[76:77], v[20:21], v[240:255]
    v_mov_b32 v78, 0x3f803f80
    v_mov_b32 v79, 0x3f803f80
    v_mov_b32 v80, 0x3f803f80
    v_mov_b32 v81, 0x3f803f80
    v_mov_b32 v82, 0x3f803f80
    v_mov_b32 v83, 0x3f803f80
    v_mov_b32 v84, 0x3f803f80
    v_mov_b32 v85, 0x3f803f80
    s_nop 7
    s_nop 7
    s_cmp_gt_i32 s30, 0
    s_cbranch_scc0 L_VALID
    v_mov_b32 v112, 0xff800000
    v_mov_b32 v113, 0xff800000
    v_mov_b32 v114, 0xff800000
    v_mov_b32 v115, 0xff800000
    v_mov_b32 v116, 0xff800000
    v_mov_b32 v117, 0xff800000
    v_mov_b32 v118, 0xff800000
    v_mov_b32 v119, 0xff800000
    v_mov_b32 v120, 0xff800000
    v_mov_b32 v121, 0xff800000
    v_mov_b32 v122, 0xff800000
    v_mov_b32 v123, 0xff800000
    v_mov_b32 v124, 0xff800000
    v_mov_b32 v125, 0xff800000
    v_mov_b32 v126, 0xff800000
    v_mov_b32 v127, 0xff800000
    s_cmp_gt_i32 s30, 1
    s_cbranch_scc0 L_VALID
    v_mov_b32 v128, 0xff800000
    v_mov_b32 v129, 0xff800000
    v_mov_b32 v130, 0xff800000
    v_mov_b32 v131, 0xff800000
    v_mov_b32 v132, 0xff800000
    v_mov_b32 v133, 0xff800000
    v_mov_b32 v134, 0xff800000
    v_mov_b32 v135, 0xff800000
    v_mov_b32 v136, 0xff800000
    v_mov_b32 v137, 0xff800000
    v_mov_b32 v138, 0xff800000
    v_mov_b32 v139, 0xff800000
    v_mov_b32 v140, 0xff800000
    v_mov_b32 v141, 0xff800000
    v_mov_b32 v142, 0xff800000
    v_mov_b32 v143, 0xff800000
    s_cmp_gt_i32 s30, 2
    s_cbranch_scc0 L_VALID
    v_mov_b32 v144, 0xff800000
    v_mov_b32 v145, 0xff800000
    v_mov_b32 v146, 0xff800000
    v_mov_b32 v147, 0xff800000
    v_mov_b32 v148, 0xff800000
    v_mov_b32 v149, 0xff800000
    v_mov_b32 v150, 0xff800000
    v_mov_b32 v151, 0xff800000
    v_mov_b32 v152, 0xff800000
    v_mov_b32 v153, 0xff800000
    v_mov_b32 v154, 0xff800000
    v_mov_b32 v155, 0xff800000
    v_mov_b32 v156, 0xff800000
    v_mov_b32 v157, 0xff800000
    v_mov_b32 v158, 0xff800000
    v_mov_b32 v159, 0xff800000
    s_cmp_gt_i32 s30, 3
    s_cbranch_scc0 L_VALID
    v_mov_b32 v160, 0xff800000
    v_mov_b32 v161, 0xff800000
    v_mov_b32 v162, 0xff800000
    v_mov_b32 v163, 0xff800000
    v_mov_b32 v164, 0xff800000
    v_mov_b32 v165, 0xff800000
    v_mov_b32 v166, 0xff800000
    v_mov_b32 v167, 0xff800000
    v_mov_b32 v168, 0xff800000
    v_mov_b32 v169, 0xff800000
    v_mov_b32 v170, 0xff800000
    v_mov_b32 v171, 0xff800000
    v_mov_b32 v172, 0xff800000
    v_mov_b32 v173, 0xff800000
    v_mov_b32 v174, 0xff800000
    v_mov_b32 v175, 0xff800000
    s_cmp_gt_i32 s30, 4
    s_cbranch_scc0 L_VALID
    v_mov_b32 v176, 0xff800000
    v_mov_b32 v177, 0xff800000
    v_mov_b32 v178, 0xff800000
    v_mov_b32 v179, 0xff800000
    v_mov_b32 v180, 0xff800000
    v_mov_b32 v181, 0xff800000
    v_mov_b32 v182, 0xff800000
    v_mov_b32 v183, 0xff800000
    v_mov_b32 v184, 0xff800000
    v_mov_b32 v185, 0xff800000
    v_mov_b32 v186, 0xff800000
    v_mov_b32 v187, 0xff800000
    v_mov_b32 v188, 0xff800000
    v_mov_b32 v189, 0xff800000
    v_mov_b32 v190, 0xff800000
    v_mov_b32 v191, 0xff800000
    s_cmp_gt_i32 s30, 5
    s_cbranch_scc0 L_VALID
    v_mov_b32 v192, 0xff800000
    v_mov_b32 v193, 0xff800000
    v_mov_b32 v194, 0xff800000
    v_mov_b32 v195, 0xff800000
    v_mov_b32 v196, 0xff800000
    v_mov_b32 v197, 0xff800000
    v_mov_b32 v198, 0xff800000
    v_mov_b32 v199, 0xff800000
    v_mov_b32 v200, 0xff800000
    v_mov_b32 v201, 0xff800000
    v_mov_b32 v202, 0xff800000
    v_mov_b32 v203, 0xff800000
    v_mov_b32 v204, 0xff800000
    v_mov_b32 v205, 0xff800000
    v_mov_b32 v206, 0xff800000
    v_mov_b32 v207, 0xff800000
    s_cmp_gt_i32 s30, 6
    s_cbranch_scc0 L_VALID
    v_mov_b32 v208, 0xff800000
    v_mov_b32 v209, 0xff800000
    v_mov_b32 v210, 0xff800000
    v_mov_b32 v211, 0xff800000
    v_mov_b32 v212, 0xff800000
    v_mov_b32 v213, 0xff800000
    v_mov_b32 v214, 0xff800000
    v_mov_b32 v215, 0xff800000
    v_mov_b32 v216, 0xff800000
    v_mov_b32 v217, 0xff800000
    v_mov_b32 v218, 0xff800000
    v_mov_b32 v219, 0xff800000
    v_mov_b32 v220, 0xff800000
    v_mov_b32 v221, 0xff800000
    v_mov_b32 v222, 0xff800000
    v_mov_b32 v223, 0xff800000
    s_cmp_gt_i32 s30, 7
    s_cbranch_scc0 L_VALID
    v_mov_b32 v224, 0xff800000
    v_mov_b32 v225, 0xff800000
    v_mov_b32 v226, 0xff800000
    v_mov_b32 v227, 0xff800000
    v_mov_b32 v228, 0xff800000
    v_mov_b32 v229, 0xff800000
    v_mov_b32 v230, 0xff800000
    v_mov_b32 v231, 0xff800000
    v_mov_b32 v232, 0xff800000
    v_mov_b32 v233, 0xff800000
    v_mov_b32 v234, 0xff800000
    v_mov_b32 v235, 0xff800000
    v_mov_b32 v236, 0xff800000
    v_mov_b32 v237, 0xff800000
    v_mov_b32 v238, 0xff800000
    v_mov_b32 v239, 0xff800000
L_VALID:
    v_cndmask_b32 v112, v240, v112, s[32:33]
    v_cndmask_b32 v113, v241, v113, s[34:35]
    v_cndmask_b32 v114, v242, v114, s[36:37]
    v_cndmask_b32 v115, v243, v115, s[38:39]
    v_cndmask_b32 v116, v244, v116, s[40:41]
    v_cndmask_b32 v117, v245, v117, s[42:43]
    v_cndmask_b32 v118, v246, v118, s[44:45]
    v_cndmask_b32 v119, v247, v119, s[46:47]
    v_cndmask_b32 v120, v248, v120, s[48:49]
    v_cndmask_b32 v121, v249, v121, s[50:51]
    v_cndmask_b32 v122, v250, v122, s[52:53]
    v_cndmask_b32 v123, v251, v123, s[54:55]
    v_cndmask_b32 v124, v252, v124, s[56:57]
    v_cndmask_b32 v125, v253, v125, s[58:59]
    v_cndmask_b32 v126, v254, v126, s[60:61]
    v_cndmask_b32 v127, v255, v127, s[62:63]
    v_max_f32 v4, v112, v113
    v_max3_f32 v4, v114, v115, v4
    v_max3_f32 v4, v116, v117, v4
    v_max3_f32 v4, v118, v119, v4
    v_max3_f32 v4, v120, v121, v4
    v_max3_f32 v4, v122, v123, v4
    v_max3_f32 v4, v124, v125, v4
    v_max3_f32 v4, v126, v127, v4
    v_max3_f32 v4, v128, v129, v4
    v_max3_f32 v4, v130, v131, v4
    v_max3_f32 v4, v132, v133, v4
    v_max3_f32 v4, v134, v135, v4
    v_max3_f32 v4, v136, v137, v4
    v_max3_f32 v4, v138, v139, v4
    v_max3_f32 v4, v140, v141, v4
    v_max3_f32 v4, v142, v143, v4
    v_max3_f32 v4, v144, v145, v4
    v_max3_f32 v4, v146, v147, v4
    v_max3_f32 v4, v148, v149, v4
    v_max3_f32 v4, v150, v151, v4
    v_max3_f32 v4, v152, v153, v4
    v_max3_f32 v4, v154, v155, v4
    v_max3_f32 v4, v156, v157, v4
    v_max3_f32 v4, v158, v159, v4
    v_max3_f32 v4, v160, v161, v4
    v_max3_f32 v4, v162, v163, v4
    v_max3_f32 v4, v164, v165, v4
    v_max3_f32 v4, v166, v167, v4
    v_max3_f32 v4, v168, v169, v4
    v_max3_f32 v4, v170, v171, v4
    v_max3_f32 v4, v172, v173, v4
    v_max3_f32 v4, v174, v175, v4
    v_max3_f32 v4, v176, v177, v4
    v_max3_f32 v4, v178, v179, v4
    v_max3_f32 v4, v180, v181, v4
    v_max3_f32 v4, v182, v183, v4
    v_max3_f32 v4, v184, v185, v4
    v_max3_f32 v4, v186, v187, v4
    v_max3_f32 v4, v188, v189, v4
    v_max3_f32 v4, v190, v191, v4
    v_max3_f32 v4, v192, v193, v4
    v_max3_f32 v4, v194, v195, v4
    v_max3_f32 v4, v196, v197, v4
    v_max3_f32 v4, v198, v199, v4
    v_max3_f32 v4, v200, v201, v4
    v_max3_f32 v4, v202, v203, v4
    v_max3_f32 v4, v204, v205, v4
    v_max3_f32 v4, v206, v207, v4
    v_max3_f32 v4, v208, v209, v4
    v_max3_f32 v4, v210, v211, v4
    v_max3_f32 v4, v212, v213, v4
    v_max3_f32 v4, v214, v215, v4
    v_max3_f32 v4, v216, v217, v4
    v_max3_f32 v4, v218, v219, v4
    v_max3_f32 v4, v220, v221, v4
    v_max3_f32 v4, v222, v223, v4
    v_max3_f32 v4, v224, v225, v4
    v_max3_f32 v4, v226, v227, v4
    v_max3_f32 v4, v228, v229, v4
    v_max3_f32 v4, v230, v231, v4
    v_max3_f32 v4, v232, v233, v4
    v_max3_f32 v4, v234, v235, v4
    v_max3_f32 v4, v236, v237, v4
    v_max3_f32 v4, v238, v239, v4
    v_mov_b32 v5, v4
    s_nop 1
    v_permlane32_swap_b32 v4, v5
    v_max_f32 v4, v4, v5
    v_sub_f32 v112, v112, v4
    v_sub_f32 v113, v113, v4
    v_sub_f32 v114, v114, v4
    v_sub_f32 v115, v115, v4
    v_sub_f32 v116, v116, v4
    v_sub_f32 v117, v117, v4
    v_sub_f32 v118, v118, v4
    v_sub_f32 v119, v119, v4
    v_sub_f32 v120, v120, v4
    v_sub_f32 v121, v121, v4
    v_sub_f32 v122, v122, v4
    v_sub_f32 v123, v123, v4
    v_sub_f32 v124, v124, v4
    v_sub_f32 v125, v125, v4
    v_sub_f32 v126, v126, v4
    v_sub_f32 v127, v127, v4
    v_exp_f32 v112, v112
    v_exp_f32 v113, v113
    v_exp_f32 v114, v114
    v_exp_f32 v115, v115
    v_exp_f32 v116, v116
    v_exp_f32 v117, v117
    v_exp_f32 v118, v118
    v_exp_f32 v119, v119
    v_exp_f32 v120, v120
    v_exp_f32 v121, v121
    v_exp_f32 v122, v122
    v_exp_f32 v123, v123
    v_exp_f32 v124, v124
    v_exp_f32 v125, v125
    v_exp_f32 v126, v126
    v_exp_f32 v127, v127
    v_cvt_pk_bf16_f32 v112, v112, v113
    v_cvt_pk_bf16_f32 v113, v114, v115
    v_cvt_pk_bf16_f32 v114, v116, v117
    v_cvt_pk_bf16_f32 v115, v118, v119
    v_cvt_pk_bf16_f32 v116, v120, v121
    v_cvt_pk_bf16_f32 v117, v122, v123
    v_cvt_pk_bf16_f32 v118, v124, v125
    v_cvt_pk_bf16_f32 v119, v126, v127
    v_sub_f32 v128, v128, v4
    v_sub_f32 v129, v129, v4
    v_sub_f32 v130, v130, v4
    v_sub_f32 v131, v131, v4
    v_sub_f32 v132, v132, v4
    v_sub_f32 v133, v133, v4
    v_sub_f32 v134, v134, v4
    v_sub_f32 v135, v135, v4
    v_sub_f32 v136, v136, v4
    v_sub_f32 v137, v137, v4
    v_sub_f32 v138, v138, v4
    v_sub_f32 v139, v139, v4
    v_sub_f32 v140, v140, v4
    v_sub_f32 v141, v141, v4
    v_sub_f32 v142, v142, v4
    v_sub_f32 v143, v143, v4
    v_exp_f32 v128, v128
    v_exp_f32 v129, v129
    v_exp_f32 v130, v130
    v_exp_f32 v131, v131
    v_exp_f32 v132, v132
    v_exp_f32 v133, v133
    v_exp_f32 v134, v134
    v_exp_f32 v135, v135
    v_exp_f32 v136, v136
    v_exp_f32 v137, v137
    v_exp_f32 v138, v138
    v_exp_f32 v139, v139
    v_exp_f32 v140, v140
    v_exp_f32 v141, v141
    v_exp_f32 v142, v142
    v_exp_f32 v143, v143
    v_cvt_pk_bf16_f32 v128, v128, v129
    v_cvt_pk_bf16_f32 v129, v130, v131
    v_cvt_pk_bf16_f32 v130, v132, v133
    v_cvt_pk_bf16_f32 v131, v134, v135
    v_cvt_pk_bf16_f32 v132, v136, v137
    v_cvt_pk_bf16_f32 v133, v138, v139
    v_cvt_pk_bf16_f32 v134, v140, v141
    v_cvt_pk_bf16_f32 v135, v142, v143
    v_sub_f32 v144, v144, v4
    v_sub_f32 v145, v145, v4
    v_sub_f32 v146, v146, v4
    v_sub_f32 v147, v147, v4
    v_sub_f32 v148, v148, v4
    v_sub_f32 v149, v149, v4
    v_sub_f32 v150, v150, v4
    v_sub_f32 v151, v151, v4
    v_sub_f32 v152, v152, v4
    v_sub_f32 v153, v153, v4
    v_sub_f32 v154, v154, v4
    v_sub_f32 v155, v155, v4
    v_sub_f32 v156, v156, v4
    v_sub_f32 v157, v157, v4
    v_sub_f32 v158, v158, v4
    v_sub_f32 v159, v159, v4
    v_exp_f32 v144, v144
    v_exp_f32 v145, v145
    v_exp_f32 v146, v146
    v_exp_f32 v147, v147
    v_exp_f32 v148, v148
    v_exp_f32 v149, v149
    v_exp_f32 v150, v150
    v_exp_f32 v151, v151
    v_exp_f32 v152, v152
    v_exp_f32 v153, v153
    v_exp_f32 v154, v154
    v_exp_f32 v155, v155
    v_exp_f32 v156, v156
    v_exp_f32 v157, v157
    v_exp_f32 v158, v158
    v_exp_f32 v159, v159
    v_cvt_pk_bf16_f32 v144, v144, v145
    v_cvt_pk_bf16_f32 v145, v146, v147
    v_cvt_pk_bf16_f32 v146, v148, v149
    v_cvt_pk_bf16_f32 v147, v150, v151
    v_cvt_pk_bf16_f32 v148, v152, v153
    v_cvt_pk_bf16_f32 v149, v154, v155
    v_cvt_pk_bf16_f32 v150, v156, v157
    v_cvt_pk_bf16_f32 v151, v158, v159
    v_sub_f32 v160, v160, v4
    v_sub_f32 v161, v161, v4
    v_sub_f32 v162, v162, v4
    v_sub_f32 v163, v163, v4
    v_sub_f32 v164, v164, v4
    v_sub_f32 v165, v165, v4
    v_sub_f32 v166, v166, v4
    v_sub_f32 v167, v167, v4
    v_sub_f32 v168, v168, v4
    v_sub_f32 v169, v169, v4
    v_sub_f32 v170, v170, v4
    v_sub_f32 v171, v171, v4
    v_sub_f32 v172, v172, v4
    v_sub_f32 v173, v173, v4
    v_sub_f32 v174, v174, v4
    v_sub_f32 v175, v175, v4
    v_exp_f32 v160, v160
    v_exp_f32 v161, v161
    v_exp_f32 v162, v162
    v_exp_f32 v163, v163
    v_exp_f32 v164, v164
    v_exp_f32 v165, v165
    v_exp_f32 v166, v166
    v_exp_f32 v167, v167
    v_exp_f32 v168, v168
    v_exp_f32 v169, v169
    v_exp_f32 v170, v170
    v_exp_f32 v171, v171
    v_exp_f32 v172, v172
    v_exp_f32 v173, v173
    v_exp_f32 v174, v174
    v_exp_f32 v175, v175
    v_cvt_pk_bf16_f32 v160, v160, v161
    v_cvt_pk_bf16_f32 v161, v162, v163
    v_cvt_pk_bf16_f32 v162, v164, v165
    v_cvt_pk_bf16_f32 v163, v166, v167
    v_cvt_pk_bf16_f32 v164, v168, v169
    v_cvt_pk_bf16_f32 v165, v170, v171
    v_cvt_pk_bf16_f32 v166, v172, v173
    v_cvt_pk_bf16_f32 v167, v174, v175
    v_sub_f32 v176, v176, v4
    v_sub_f32 v177, v177, v4
    v_sub_f32 v178, v178, v4
    v_sub_f32 v179, v179, v4
    v_sub_f32 v180, v180, v4
    v_sub_f32 v181, v181, v4
    v_sub_f32 v182, v182, v4
    v_sub_f32 v183, v183, v4
    v_sub_f32 v184, v184, v4
    v_sub_f32 v185, v185, v4
    v_sub_f32 v186, v186, v4
    v_sub_f32 v187, v187, v4
    v_sub_f32 v188, v188, v4
    v_sub_f32 v189, v189, v4
    v_sub_f32 v190, v190, v4
    v_sub_f32 v191, v191, v4
    v_exp_f32 v176, v176
    v_exp_f32 v177, v177
    v_exp_f32 v178, v178
    v_exp_f32 v179, v179
    v_exp_f32 v180, v180
    v_exp_f32 v181, v181
    v_exp_f32 v182, v182
    v_exp_f32 v183, v183
    v_exp_f32 v184, v184
    v_exp_f32 v185, v185
    v_exp_f32 v186, v186
    v_exp_f32 v187, v187
    v_exp_f32 v188, v188
    v_exp_f32 v189, v189
    v_exp_f32 v190, v190
    v_exp_f32 v191, v191
    v_cvt_pk_bf16_f32 v176, v176, v177
    v_cvt_pk_bf16_f32 v177, v178, v179
    v_cvt_pk_bf16_f32 v178, v180, v181
    v_cvt_pk_bf16_f32 v179, v182, v183
    v_cvt_pk_bf16_f32 v180, v184, v185
    v_cvt_pk_bf16_f32 v181, v186, v187
    v_cvt_pk_bf16_f32 v182, v188, v189
    v_cvt_pk_bf16_f32 v183, v190, v191
    v_sub_f32 v192, v192, v4
    v_sub_f32 v193, v193, v4
    v_sub_f32 v194, v194, v4
    v_sub_f32 v195, v195, v4
    v_sub_f32 v196, v196, v4
    v_sub_f32 v197, v197, v4
    v_sub_f32 v198, v198, v4
    v_sub_f32 v199, v199, v4
    v_sub_f32 v200, v200, v4
    v_sub_f32 v201, v201, v4
    v_sub_f32 v202, v202, v4
    v_sub_f32 v203, v203, v4
    v_sub_f32 v204, v204, v4
    v_sub_f32 v205, v205, v4
    v_sub_f32 v206, v206, v4
    v_sub_f32 v207, v207, v4
    v_exp_f32 v192, v192
    v_exp_f32 v193, v193
    v_exp_f32 v194, v194
    v_exp_f32 v195, v195
    v_exp_f32 v196, v196
    v_exp_f32 v197, v197
    v_exp_f32 v198, v198
    v_exp_f32 v199, v199
    v_exp_f32 v200, v200
    v_exp_f32 v201, v201
    v_exp_f32 v202, v202
    v_exp_f32 v203, v203
    v_exp_f32 v204, v204
    v_exp_f32 v205, v205
    v_exp_f32 v206, v206
    v_exp_f32 v207, v207
    v_cvt_pk_bf16_f32 v192, v192, v193
    v_cvt_pk_bf16_f32 v193, v194, v195
    v_cvt_pk_bf16_f32 v194, v196, v197
    v_cvt_pk_bf16_f32 v195, v198, v199
    v_cvt_pk_bf16_f32 v196, v200, v201
    v_cvt_pk_bf16_f32 v197, v202, v203
    v_cvt_pk_bf16_f32 v198, v204, v205
    v_cvt_pk_bf16_f32 v199, v206, v207
    v_sub_f32 v208, v208, v4
    v_sub_f32 v209, v209, v4
    v_sub_f32 v210, v210, v4
    v_sub_f32 v211, v211, v4
    v_sub_f32 v212, v212, v4
    v_sub_f32 v213, v213, v4
    v_sub_f32 v214, v214, v4
    v_sub_f32 v215, v215, v4
    v_sub_f32 v216, v216, v4
    v_sub_f32 v217, v217, v4
    v_sub_f32 v218, v218, v4
    v_sub_f32 v219, v219, v4
    v_sub_f32 v220, v220, v4
    v_sub_f32 v221, v221, v4
    v_sub_f32 v222, v222, v4
    v_sub_f32 v223, v223, v4
    v_exp_f32 v208, v208
    v_exp_f32 v209, v209
    v_exp_f32 v210, v210
    v_exp_f32 v211, v211
    v_exp_f32 v212, v212
    v_exp_f32 v213, v213
    v_exp_f32 v214, v214
    v_exp_f32 v215, v215
    v_exp_f32 v216, v216
    v_exp_f32 v217, v217
    v_exp_f32 v218, v218
    v_exp_f32 v219, v219
    v_exp_f32 v220, v220
    v_exp_f32 v221, v221
    v_exp_f32 v222, v222
    v_exp_f32 v223, v223
    v_cvt_pk_bf16_f32 v208, v208, v209
    v_cvt_pk_bf16_f32 v209, v210, v211
    v_cvt_pk_bf16_f32 v210, v212, v213
    v_cvt_pk_bf16_f32 v211, v214, v215
    v_cvt_pk_bf16_f32 v212, v216, v217
    v_cvt_pk_bf16_f32 v213, v218, v219
    v_cvt_pk_bf16_f32 v214, v220, v221
    v_cvt_pk_bf16_f32 v215, v222, v223
    v_sub_f32 v224, v224, v4
    v_sub_f32 v225, v225, v4
    v_sub_f32 v226, v226, v4
    v_sub_f32 v227, v227, v4
    v_sub_f32 v228, v228, v4
    v_sub_f32 v229, v229, v4
    v_sub_f32 v230, v230, v4
    v_sub_f32 v231, v231, v4
    v_sub_f32 v232, v232, v4
    v_sub_f32 v233, v233, v4
    v_sub_f32 v234, v234, v4
    v_sub_f32 v235, v235, v4
    v_sub_f32 v236, v236, v4
    v_sub_f32 v237, v237, v4
    v_sub_f32 v238, v238, v4
    v_sub_f32 v239, v239, v4
    v_exp_f32 v224, v224
    v_exp_f32 v225, v225
    v_exp_f32 v226, v226
    v_exp_f32 v227, v227
    v_exp_f32 v228, v228
    v_exp_f32 v229, v229
    v_exp_f32 v230, v230
    v_exp_f32 v231, v231
    v_exp_f32 v232, v232
    v_exp_f32 v233, v233
    v_exp_f32 v234, v234
    v_exp_f32 v235, v235
    v_exp_f32 v236, v236
    v_exp_f32 v237, v237
    v_exp_f32 v238, v238
    v_exp_f32 v239, v239
    v_cvt_pk_bf16_f32 v224, v224, v225
    v_cvt_pk_bf16_f32 v225, v226, v227
    v_cvt_pk_bf16_f32 v226, v228, v229
    v_cvt_pk_bf16_f32 v227, v230, v231
    v_cvt_pk_bf16_f32 v228, v232, v233
    v_cvt_pk_bf16_f32 v229, v234, v235
    v_cvt_pk_bf16_f32 v230, v236, v237
    v_cvt_pk_bf16_f32 v231, v238, v239
    v_and_b32 v120, v88, v112
    v_and_b32 v121, v89, v113
    v_and_b32 v122, v90, v114
    v_and_b32 v123, v91, v115
    v_and_b32 v124, v92, v116
    v_and_b32 v125, v93, v117
    v_and_b32 v126, v94, v118
    v_and_b32 v127, v95, v119
    v_xor_b32 v240, v120, v112
    v_xor_b32 v241, v121, v113
    v_xor_b32 v242, v122, v114
    v_xor_b32 v243, v123, v115
    v_xor_b32 v244, v124, v116
    v_xor_b32 v245, v125, v117
    v_xor_b32 v246, v126, v118
    v_xor_b32 v247, v127, v119
    s_mov_b64 exec, s[28:29]
    ds_read_b128 v[78:81], v13 offset:0
    ds_read_b128 v[82:85], v13 offset:1280
    s_mov_b64 exec, -1
    s_waitcnt lgkmcnt(0)
    v_mfma_f32_32x32x16_bf16 v[96:111], v[78:81], v[120:123], 0
    v_mfma_f32_32x32x16_bf16 v[96:111], v[82:85], v[124:127], v[96:111]
    s_nop 7
    s_mov_b64 exec, s[28:29]
    ds_read_b128 v[78:81], v13 offset:2560
    ds_read_b128 v[82:85], v13 offset:3840
    s_mov_b64 exec, -1
    s_waitcnt lgkmcnt(0)
    v_mfma_f32_32x32x16_bf16 v[96:111], v[78:81], v[128:131], v[96:111]
    v_mfma_f32_32x32x16_bf16 v[96:111], v[82:85], v[132:135], v[96:111]
    s_nop 7
    s_mov_b64 exec, s[28:29]
    ds_read_b128 v[78:81], v13 offset:5120
    ds_read_b128 v[82:85], v13 offset:6400
    s_mov_b64 exec, -1
    s_waitcnt lgkmcnt(0)
    v_mfma_f32_32x32x16_bf16 v[96:111], v[78:81], v[144:147], v[96:111]
    v_mfma_f32_32x32x16_bf16 v[96:111], v[82:85], v[148:151], v[96:111]
    s_nop 7
    s_mov_b64 exec, s[28:29]
    ds_read_b128 v[78:81], v13 offset:7680
    ds_read_b128 v[82:85], v13 offset:8960
    s_mov_b64 exec, -1
    s_waitcnt lgkmcnt(0)
    v_mfma_f32_32x32x16_bf16 v[96:111], v[78:81], v[160:163], v[96:111]
    v_mfma_f32_32x32x16_bf16 v[96:111], v[82:85], v[164:167], v[96:111]
    s_nop 7
    s_mov_b64 exec, s[28:29]
    ds_read_b128 v[78:81], v13 offset:10240
    ds_read_b128 v[82:85], v13 offset:11520
    s_mov_b64 exec, -1
    s_waitcnt lgkmcnt(0)
    v_mfma_f32_32x32x16_bf16 v[96:111], v[78:81], v[176:179], v[96:111]
    v_mfma_f32_32x32x16_bf16 v[96:111], v[82:85], v[180:183], v[96:111]
    s_nop 7
    s_mov_b64 exec, s[28:29]
    ds_read_b128 v[78:81], v13 offset:12800
    ds_read_b128 v[82:85], v13 offset:14080
    s_mov_b64 exec, -1
    s_waitcnt lgkmcnt(0)
    v_mfma_f32_32x32x16_bf16 v[96:111], v[78:81], v[192:195], v[96:111]
    v_mfma_f32_32x32x16_bf16 v[96:111], v[82:85], v[196:199], v[96:111]
    s_nop 7
    s_mov_b64 exec, s[28:29]
    ds_read_b128 v[78:81], v13 offset:15360
    ds_read_b128 v[82:85], v13 offset:16640
    s_mov_b64 exec, -1
    s_waitcnt lgkmcnt(0)
    v_mfma_f32_32x32x16_bf16 v[96:111], v[78:81], v[208:211], v[96:111]
    v_mfma_f32_32x32x16_bf16 v[96:111], v[82:85], v[212:215], v[96:111]
    s_nop 7
    s_mov_b64 exec, s[28:29]
    ds_read_b128 v[78:81], v13 offset:17920
    ds_read_b128 v[82:85], v13 offset:19200
    s_mov_b64 exec, -1
    s_waitcnt lgkmcnt(0)
    v_mfma_f32_32x32x16_bf16 v[96:111], v[78:81], v[224:227], v[96:111]
    v_mfma_f32_32x32x16_bf16 v[96:111], v[82:85], v[228:231], v[96:111]
    s_nop 7
    s_mov_b64 exec, s[28:29]
    ds_read_b128 v[78:81], v13 offset:20480
    ds_read_b128 v[82:85], v13 offset:21760
    s_mov_b64 exec, -1
    s_waitcnt lgkmcnt(0)
    v_mfma_f32_32x32x16_bf16 v[96:111], v[78:81], v[240:243], v[96:111]
    v_mfma_f32_32x32x16_bf16 v[96:111], v[82:85], v[244:247], v[96:111]
    s_nop 7
    s_nop 7
    v_and_b32 v4, 15, v0
    v_bfe_u32 v5, v0, 4, 2
    s_lshl_b32 s3, s23, 6
    s_lshl_b32 s4, s26, 4
    s_add_u32 s3, s3, s4
    v_add_u32 v4, s3, v4
    v_mul_u32_u24 v4, 1280, v4
    v_mul_u32_u24 v5, 40, v5
    s_mul_i32 s3, s24, 160
    v_add_u32 v5, s3, v5
    v_add_u32 v4, v5, v4
    s_cmp_lg_u32 s27, 0
    s_cbranch_scc1 L_EL2_H
    global_load_dwordx4 v[224:227], v4, s[64:65]
    global_load_dwordx4 v[228:231], v4, s[64:65] offset:16
    global_load_dwordx2 v[232:233], v4, s[64:65] offset:32
    global_load_dwordx4 v[234:237], v5, s[72:73]
    global_load_dwordx4 v[238:241], v5, s[72:73] offset:16
    global_load_dwordx2 v[242:243], v5, s[72:73] offset:32
    s_branch L_EL2_D
L_EL2_H:
    v_lshlrev_b32 v4, 2, v1
    global_load_dword v224, v4, s[72:73] offset:0
    global_load_dword v225, v4, s[72:73] offset:256
    global_load_dword v226, v4, s[72:73] offset:512
    global_load_dword v227, v4, s[72:73] offset:768
    global_load_dword v228, v4, s[72:73] offset:1024
L_EL2_D:
    s_cmp_lg_u32 s27, 1
    s_cbranch_scc1 L_GU2
    s_cmp_ge_u32 s25, 32
    s_cbranch_scc1 L_GU2
    s_cmp_ge_u32 s26, 2
    s_cselect_b32 s4, s76, s74
    s_cselect_b32 s5, s77, s75
    s_and_b32 s3, s26, 1
    s_mul_i32 s3, s3, 138240
    v_add_u32 v4, s3, v86
    global_load_dwordx4 v[56:59], v4, s[4:5] nt
    v_add_u32 v4, 27648, v4
    global_load_dwordx4 v[60:63], v4, s[4:5] nt
    v_add_u32 v4, 27648, v4
    global_load_dwordx4 v[64:67], v4, s[4:5] nt
    v_add_u32 v4, 27648, v4
    global_load_dwordx4 v[68:71], v4, s[4:5] nt
    v_add_u32 v4, 27648, v4
    global_load_dwordx4 v[72:75], v4, s[4:5] nt
L_GU2:
    s_branch L_BDONE

CODE_END:
s_endpgm
.section .rodata,"a"
.p2align 6
.amdhsa_kernel sequential_preLN__sliding_block__moe_arch_mod__prompt_kernel
  .amdhsa_next_free_vgpr 256
  .amdhsa_next_free_sgpr 102
  .amdhsa_accum_offset 256
  .amdhsa_group_segment_fixed_size 0
  .amdhsa_kernarg_size 88
  .amdhsa_user_sgpr_count 2
  .amdhsa_user_sgpr_kernarg_segment_ptr 1
  .amdhsa_system_sgpr_workgroup_id_x 1
.end_amdhsa_kernel
```
